```python
import torch

def _softmax(x, axis=-1):
    return torch.softmax(x, dim=axis)
def _gelu(x):
    return torch.nn.functional.gelu(x, approximate="tanh")
def _silu(x):
    return torch.nn.functional.silu(x)
def _sigmoid(x):
    return torch.sigmoid(x)
def _layernorm(x, axis=-1, eps=1e-5):
    m = x.mean(dim=axis, keepdim=True)
    v = x.var(dim=axis, keepdim=True, unbiased=False)
    return (x - m) / torch.sqrt(v + eps)
def _scatter_add(tgt, idx, src, axis=0):
    return tgt.clone().index_add_(axis, idx, src)
def _segment_sum(src, seg, n):
    out = torch.zeros((n,) + src.shape[1:], dtype=src.dtype)
    return out.index_add_(0, seg, src)
def _pad(x, pw):
    flat = tuple(v for pair in reversed(pw) for v in pair)
    return torch.nn.functional.pad(x, flat)

kernel_name = 'sequential_preLN__ssm_conv_h3__glu_gated_reglu__prompt'

def setup_inputs():

    _w = (lambda a: (lambda t: t.to(torch.bfloat16) if t.is_floating_point() else t)(torch.as_tensor(a)))
    def _A_setup():
        B, S, D = 1, 2048, 512
        ks = 4
        return {
            "q": _w((lambda *s: torch.randn(*s, dtype=torch.bfloat16) * 0.05)(B, S, D)),
            "k": _w((lambda *s: torch.randn(*s, dtype=torch.bfloat16) * 0.2)(B, S, D)),
            "v": _w((lambda *s: torch.randn(*s, dtype=torch.bfloat16) * 0.2)(B, S, D)),
            "shift_k": _w((lambda *s: torch.randn(*s, dtype=torch.bfloat16) * 0.2)(D, ks) * 0.5),
            "ssm_k": _w((lambda *s: torch.randn(*s, dtype=torch.bfloat16) * 0.4)(D, S) * (1.0 / S ** 0.5)),
            "ssm_D": _w((lambda *s: torch.randn(*s, dtype=torch.bfloat16) * 0.2)(D)),
        }
    _A_in = _A_setup()

    def _B_setup():
        B, S, D, F = 1, 2048, 512, 1376
        return {
            "x": _w((lambda *s: torch.randn(*s, dtype=torch.bfloat16) * 0.05)(B, S, D)),
            "W_gate": _w((lambda *s: torch.randn(*s, dtype=torch.bfloat16) * 0.2)(D, F) * (2.0 / D) ** 0.5),
            "W_up": _w((lambda *s: torch.randn(*s, dtype=torch.bfloat16) * 0.2)(D, F) * (2.0 / D) ** 0.5),
            "W_down": _w((lambda *s: torch.randn(*s, dtype=torch.bfloat16) * 0.2)(F, D) * (1.0 / F) ** 0.5),
        }
    _B_in = _B_setup()

    return {
        "A_q": _A_in["q"],
        "A_k": _A_in["k"],
        "A_v": _A_in["v"],
        "A_shift_k": _A_in["shift_k"],
        "A_ssm_k": _A_in["ssm_k"],
        "A_ssm_D": _A_in["ssm_D"],
        "B_x": _B_in["x"],
        "B_W_gate": _B_in["W_gate"],
        "B_W_up": _B_in["W_up"],
        "B_W_down": _B_in["W_down"],
    }

def reference(A_q, A_k, A_v, A_shift_k, A_ssm_k, A_ssm_D, B_x, B_W_gate, B_W_up, B_W_down):
    def _A_ref(q, k, v, shift_k, ssm_k, ssm_D):
        B, S, D = q.shape
        ks = shift_k.shape[-1]
        k_pad = _pad(k, ((0, 0), (ks - 1, 0), (0, 0)))
        k_shift = torch.zeros_like(k)
        for t in range(ks):
            k_shift = k_shift + k_pad[:, t:t + S, :] * shift_k[:, ks - 1 - t][None, None, :]
        kv = k_shift * v
        L = 2 * S
        kv_pad = _pad(kv, ((0, 0), (0, S), (0, 0)))
        kf_pad = _pad(ssm_k, ((0, 0), (0, S)))
        kv_f = (lambda x, axes=(-2,-1): torch.fft.rfft2(x.float(), dim=axes))(kv_pad[:, None, :, :], axes=(1, 2))
        kf_f = (lambda x, axes=(-2,-1): torch.fft.rfft2(x.float(), dim=axes))(kf_pad[:, None, :], axes=(1, 2))
        kf_f = (lambda x, *d: x.permute(*d))(kf_f, 1, 2, 0)
        y_f = kv_f * kf_f[None, :, :, :]
        y = (lambda x, s, axes=(-2,-1): torch.fft.irfft2(x, s=s, dim=axes).to(torch.bfloat16))(y_f, (1, L), axes=(1, 2))[:, 0, :S, :]
        y = y + kv * ssm_D[None, None, :]
        return q * y

    def _B_ref(x, W_gate, W_up, W_down):
        gate = torch.einsum("bsd,df->bsf", x, W_gate)
        up = torch.einsum("bsd,df->bsf", x, W_up)
        gate = gate * (lambda x, dt: x.to(dt))(gate > 0, gate.dtype)
        h = gate * up
        return torch.einsum("bsf,fd->bsd", h, W_down)

    x = A_q
    h = x + _A_ref(_layernorm(x, axis=-1), A_k, A_v, A_shift_k, A_ssm_k, A_ssm_D)
    h2 = h + _B_ref(_layernorm(h, axis=-1), B_W_gate, B_W_up, B_W_down)
    return h2
```

```asm
; @launch grid=(256,1,1) block=(512,1,1) lds=161024
.amdgcn_target "amdgcn-amd-amdhsa--gfx950"
.text
.globl sequential_preLN__ssm_conv_h3__glu_gated_reglu__prompt_kernel
.p2align 8
.type sequential_preLN__ssm_conv_h3__glu_gated_reglu__prompt_kernel,@function
sequential_preLN__ssm_conv_h3__glu_gated_reglu__prompt_kernel:
    s_load_dwordx8 s[8:15], s[0:1], 0
    s_cmpk_ge_u32 s2, 0x100
    s_cbranch_scc1 L_end
    v_readfirstlane_b32 s6, v0
    s_lshr_b32 s5, s2, 3
    s_and_b32 s4, s2, 7
    s_cmpk_lt_u32 s6, 0x100
    s_cbranch_scc1 L_A0
    s_getpc_b64 s[74:75]
L_pc:
    s_lshl_b32 s55, s5, 11
    v_lshl_add_u32 v10, v0, 3, s55
    v_min_u32 v10, L_codeend-L_pc+2044, v10
    s_mov_b32 exec_lo, 0x10001
    s_mov_b32 exec_hi, exec_lo
    global_load_dword v11, v10, s[74:75] offset:-2048
    s_branch L_B0
L_A0:
    s_lshl_b32 s55, s5, 9
    s_add_u32 s55, s55, s4
    s_lshl_b32 s55, s55, 7
    v_and_b32 v5, 0xb8, v0
    v_and_b32 v10, 7, v0
    v_and_b32 v7, 64, v0
    v_and_b32 v6, 56, v0
    v_add_lshl_u32 v5, v5, v6, 8
    v_lshl_add_u32 v5, v10, 3, v5
    v_add3_u32 v5, v5, v7, s55
    v_max_u32 v6, 0xc00, v5
    s_waitcnt lgkmcnt(0)
    global_load_dwordx2 v[22:23], v5, s[10:11] offset:0
    global_load_dwordx2 v[24:25], v5, s[10:11] offset:1024
    global_load_dwordx2 v[26:27], v5, s[10:11] offset:2048
    global_load_dwordx2 v[28:29], v5, s[10:11] offset:3072
    global_load_dwordx2 v[30:31], v5, s[12:13] offset:0
    global_load_dwordx2 v[32:33], v5, s[12:13] offset:1024
    global_load_dwordx2 v[34:35], v5, s[12:13] offset:2048
    global_load_dwordx2 v[36:37], v5, s[12:13] offset:3072
    global_load_dwordx2 v[16:17], v6, s[10:11] offset:-3072
    global_load_dwordx2 v[18:19], v6, s[10:11] offset:-2048
    global_load_dwordx2 v[20:21], v6, s[10:11] offset:-1024
    v_and_b32 v10, 0x3ff, v5
    v_lshlrev_b32 v10, 2, v10
    global_load_dwordx4 v[48:51], v10, s[14:15]
    global_load_dwordx4 v[52:55], v10, s[14:15] offset:16
    s_load_dwordx2 s[44:45], s[0:1], 96
    s_barrier
    s_branch L_A
L_B0:
    s_mov_b64 exec, -1
    s_load_dwordx4 s[16:19], s[0:1], 32
    s_load_dwordx2 s[44:45], s[0:1], 96
    v_and_b32 v1, 63, v0
    v_and_b32 v2, 15, v0
    v_lshrrev_b32 v4, 4, v1
    v_lshlrev_b32 v9, 4, v1
    s_bfe_u32 s3, s6, 0x20006
    s_lshl_b32 s66, s4, 5
    s_add_u32 s66, s66, s5
    s_and_b32 s99, s3, 1
    s_lshr_b32 s98, s3, 1
    v_mov_b32 v40, 0
    v_mov_b32 v41, 0
    v_mov_b32 v42, 0
    v_mov_b32 v43, 0
    v_and_b32 v12, 3, v1
    v_lshlrev_b32 v12, 4, v12
    v_add_u32 v12, 152704, v12
    ds_write_b128 v12, v[40:43]
    s_lshl_b32 s57, s2, 13
    s_lshl_b32 s56, s99, 12
    s_add_u32 s57, s57, s56
    s_lshl_b32 s56, s98, 10
    s_add_u32 s57, s57, s56
    s_lshl_b32 s61, s66, 13
    s_lshl_b32 s56, s3, 11
    s_add_u32 s61, s61, s56
    v_add_u32 v5, s57, v9
    v_add_u32 v6, s61, v9
    s_waitcnt lgkmcnt(0)
    s_barrier
    global_load_dwordx4 v[32:35], v5, s[8:9]
    global_load_dwordx4 v[36:39], v5, s[8:9] offset:2048
    global_load_dwordx4 v[24:27], v6, s[16:17]
    global_load_dwordx4 v[28:31], v6, s[16:17] offset:1024
    s_branch L_B
L_A:
    v_and_b32 v1, 63, v0
    v_and_b32 v2, 15, v0
    v_lshrrev_b32 v4, 4, v1
    v_lshlrev_b32 v9, 4, v1
    s_bfe_u32 s3, s6, 0x20006
    s_lshl_b32 s66, s4, 5
    s_add_u32 s66, s66, s5
    s_and_b32 s99, s3, 1
    s_lshr_b32 s98, s3, 1
    s_mov_b32 s85, 200000
    s_mov_b32 s65, 0xffff0000
    s_mov_b32 s46, 20971520
    s_mov_b32 s47, 0x20000
    s_waitcnt lgkmcnt(0)
    s_movk_i32 s55, 0x1000
    v_cmp_gt_u32 s[20:21], s55, v5
    v_and_b32 v133, 7, v1
    v_lshrrev_b32 v134, 3, v1
    v_xor_b32 v132, v134, v133
    v_lshl_add_u32 v132, v133, 4, v132
    v_lshlrev_b32 v132, 4, v132
    s_lshl_b32 s55, s3, 11
    s_add_u32 s55, s55, 152832
    v_add_u32 v132, s55, v132
    v_lshlrev_b32 v134, 13, v134
    v_lshl_add_u32 v134, v133, 4, v134
    v_xor_b32 v133, v1, v4
    v_lshlrev_b32 v133, 4, v133
    v_add_u32 v133, s55, v133
    v_xor_b32 v136, 64, v133
    s_lshl_b32 s55, s4, 18
    s_lshl_b32 s56, s5, 8
    s_add_u32 s55, s55, s56
    s_lshl_b32 s56, s98, 7
    s_add_u32 s55, s55, s56
    s_lshl_b32 s56, s99, 17
    s_add_u32 s55, s55, s56
    s_add_u32 s95, s55, 1048576
    s_add_u32 s97, s95, 0x10000
    s_lshl_b32 s55, s66, 7
    s_add_u32 s55, s55, 327680
    s_cmp_lg_u32 s3, 0
    s_cselect_b32 s55, 0x40000000, s55
    v_mov_b32 v140, 0
    v_mov_b32 v141, 0
    v_mov_b32 v142, 0
    v_mov_b32 v143, 0
    s_mov_b64 exec, 0xff
    buffer_store_dwordx4 v[140:143], v9, s[44:47], s55 offen sc0 sc1
    s_mov_b64 exec, -1
    s_waitcnt vmcnt(1)
    v_cndmask_b32 v16, v16, 0, s[20:21]
    v_cndmask_b32 v17, v17, 0, s[20:21]
    v_cndmask_b32 v18, v18, 0, s[20:21]
    v_cndmask_b32 v19, v19, 0, s[20:21]
    v_cndmask_b32 v20, v20, 0, s[20:21]
    v_cndmask_b32 v21, v21, 0, s[20:21]
    v_lshlrev_b32 v64, 16, v48
    v_and_b32 v68, s65, v48
    v_lshlrev_b32 v72, 16, v49
    v_and_b32 v76, s65, v49
    v_lshlrev_b32 v65, 16, v50
    v_and_b32 v69, s65, v50
    v_lshlrev_b32 v73, 16, v51
    v_and_b32 v77, s65, v51
    v_lshlrev_b32 v66, 16, v52
    v_and_b32 v70, s65, v52
    v_lshlrev_b32 v74, 16, v53
    v_and_b32 v78, s65, v53
    v_lshlrev_b32 v67, 16, v54
    v_and_b32 v71, s65, v54
    v_lshlrev_b32 v75, 16, v55
    v_and_b32 v79, s65, v55
    v_lshlrev_b32 v80, 16, v16
    v_and_b32 v81, s65, v16
    v_lshlrev_b32 v82, 16, v17
    v_and_b32 v83, s65, v17
    v_lshlrev_b32 v84, 16, v18
    v_and_b32 v85, s65, v18
    v_lshlrev_b32 v86, 16, v19
    v_and_b32 v87, s65, v19
    v_lshlrev_b32 v88, 16, v20
    v_and_b32 v89, s65, v20
    v_lshlrev_b32 v90, 16, v21
    v_and_b32 v91, s65, v21
    v_lshlrev_b32 v92, 16, v22
    v_and_b32 v93, s65, v22
    v_lshlrev_b32 v94, 16, v23
    v_and_b32 v95, s65, v23
    v_lshlrev_b32 v96, 16, v24
    v_and_b32 v97, s65, v24
    v_lshlrev_b32 v98, 16, v25
    v_and_b32 v99, s65, v25
    v_lshlrev_b32 v100, 16, v26
    v_and_b32 v101, s65, v26
    v_lshlrev_b32 v102, 16, v27
    v_and_b32 v103, s65, v27
    v_lshlrev_b32 v104, 16, v28
    v_and_b32 v105, s65, v28
    v_lshlrev_b32 v106, 16, v29
    v_and_b32 v107, s65, v29
    v_pk_mul_f32 v[144:145], v[92:93], v[64:65]
    v_pk_mul_f32 v[146:147], v[94:95], v[66:67]
    v_pk_mul_f32 v[148:149], v[96:97], v[64:65]
    v_pk_mul_f32 v[150:151], v[98:99], v[66:67]
    v_pk_mul_f32 v[152:153], v[100:101], v[64:65]
    v_pk_mul_f32 v[154:155], v[102:103], v[66:67]
    v_pk_mul_f32 v[156:157], v[104:105], v[64:65]
    v_pk_mul_f32 v[158:159], v[106:107], v[66:67]
    v_pk_fma_f32 v[144:145], v[88:89], v[68:69], v[144:145]
    v_pk_fma_f32 v[146:147], v[90:91], v[70:71], v[146:147]
    v_pk_fma_f32 v[148:149], v[92:93], v[68:69], v[148:149]
    v_pk_fma_f32 v[150:151], v[94:95], v[70:71], v[150:151]
    v_pk_fma_f32 v[152:153], v[96:97], v[68:69], v[152:153]
    v_pk_fma_f32 v[154:155], v[98:99], v[70:71], v[154:155]
    v_pk_fma_f32 v[156:157], v[100:101], v[68:69], v[156:157]
    v_pk_fma_f32 v[158:159], v[102:103], v[70:71], v[158:159]
    v_pk_fma_f32 v[144:145], v[84:85], v[72:73], v[144:145]
    v_pk_fma_f32 v[146:147], v[86:87], v[74:75], v[146:147]
    v_pk_fma_f32 v[148:149], v[88:89], v[72:73], v[148:149]
    v_pk_fma_f32 v[150:151], v[90:91], v[74:75], v[150:151]
    v_pk_fma_f32 v[152:153], v[92:93], v[72:73], v[152:153]
    v_pk_fma_f32 v[154:155], v[94:95], v[74:75], v[154:155]
    v_pk_fma_f32 v[156:157], v[96:97], v[72:73], v[156:157]
    v_pk_fma_f32 v[158:159], v[98:99], v[74:75], v[158:159]
    v_pk_fma_f32 v[144:145], v[80:81], v[76:77], v[144:145]
    v_pk_fma_f32 v[146:147], v[82:83], v[78:79], v[146:147]
    v_pk_fma_f32 v[148:149], v[84:85], v[76:77], v[148:149]
    v_pk_fma_f32 v[150:151], v[86:87], v[78:79], v[150:151]
    v_pk_fma_f32 v[152:153], v[88:89], v[76:77], v[152:153]
    v_pk_fma_f32 v[154:155], v[90:91], v[78:79], v[154:155]
    v_pk_fma_f32 v[156:157], v[92:93], v[76:77], v[156:157]
    v_pk_fma_f32 v[158:159], v[94:95], v[78:79], v[158:159]
    s_waitcnt vmcnt(6)
    v_lshlrev_b32 v108, 16, v30
    v_and_b32 v109, s65, v30
    v_lshlrev_b32 v110, 16, v31
    v_and_b32 v111, s65, v31
    v_lshlrev_b32 v112, 16, v32
    v_and_b32 v113, s65, v32
    v_lshlrev_b32 v114, 16, v33
    v_and_b32 v115, s65, v33
    v_lshlrev_b32 v116, 16, v34
    v_and_b32 v117, s65, v34
    v_lshlrev_b32 v118, 16, v35
    v_and_b32 v119, s65, v35
    v_lshlrev_b32 v120, 16, v36
    v_and_b32 v121, s65, v36
    v_lshlrev_b32 v122, 16, v37
    v_and_b32 v123, s65, v37
    v_pk_mul_f32 v[144:145], v[144:145], v[108:109]
    v_pk_mul_f32 v[146:147], v[146:147], v[110:111]
    v_pk_mul_f32 v[148:149], v[148:149], v[112:113]
    v_pk_mul_f32 v[150:151], v[150:151], v[114:115]
    v_pk_mul_f32 v[152:153], v[152:153], v[116:117]
    v_pk_mul_f32 v[154:155], v[154:155], v[118:119]
    v_pk_mul_f32 v[156:157], v[156:157], v[120:121]
    v_pk_mul_f32 v[158:159], v[158:159], v[122:123]
    v_cvt_pk_bf16_f32 v124, v144, v145
    v_cvt_pk_bf16_f32 v125, v148, v149
    v_cvt_pk_bf16_f32 v126, v152, v153
    v_cvt_pk_bf16_f32 v127, v156, v157
    ds_write_b128 v132, v[124:127] offset:0
    v_cvt_pk_bf16_f32 v128, v146, v147
    v_cvt_pk_bf16_f32 v129, v150, v151
    v_cvt_pk_bf16_f32 v130, v154, v155
    v_cvt_pk_bf16_f32 v131, v158, v159
    ds_write_b128 v132, v[128:131] offset:128
    ds_read_b128 v[16:19], v133
    ds_read_b128 v[20:23], v136 offset:1024
    s_waitcnt lgkmcnt(1)
    buffer_store_dwordx4 v[16:19], v134, s[44:47], s95 offen sc0 sc1
    s_waitcnt lgkmcnt(0)
    buffer_store_dwordx4 v[20:23], v134, s[44:47], s97 offen sc0 sc1
    s_load_dword s84, s[44:45], 0
    s_lshr_b32 s55, s4, 2
    s_lshl_b32 s55, s55, 2
    s_and_b32 s60, s5, 3
    s_add_u32 s86, s55, s60
    s_and_b32 s55, s4, 3
    s_mul_i32 s55, s55, 8
    s_lshr_b32 s56, s5, 2
    s_add_u32 s87, s55, s56
    s_mul_i32 s88, s56, 0
    s_mul_i32 s60, s60, 4
    s_add_u32 s88, s88, s60
    s_and_b32 s88, s88, 15
    s_lshl_b32 s55, s86, 2
    s_add_u32 s55, s55, s3
    s_mul_i32 s55, s55, 176128
    s_mul_i32 s56, s87, 2816
    s_add_u32 s55, s55, s56
    s_add_u32 s89, s55, 11534336
    s_add_u32 s90, s89, 88064
    v_mov_b32 v12, 0x40000000
    v_cmp_eq_u32 vcc, 3, v4
    s_nop 1
    v_cndmask_b32 v13, v9, v12, vcc
    s_cmp_eq_u32 s87, 31
    s_cselect_b64 vcc, -1, 0
    v_cndmask_b32 v176, v9, v13, vcc
    v_cndmask_b32 v177, v9, v12, vcc
    v_cndmask_b32 v178, v13, v12, vcc
    v_lshrrev_b32 v13, 2, v2
    v_lshlrev_b32 v179, 4, v2
    v_cmp_eq_u32 vcc, v13, v4
    s_nop 1
    v_cndmask_b32 v179, v12, v179, vcc
    s_lshl_b32 s55, s86, 10
    s_lshl_b32 s56, s3, 8
    s_add_u32 s55, s55, s56
    s_add_u32 s55, s55, 32768
    s_cmp_eq_u32 s87, 31
    s_cselect_b32 s91, s55, 0x40000000
    s_lshl_b32 s67, s66, 13
    s_lshl_b32 s56, s3, 11
    s_add_u32 s67, s67, s56
    s_add_u32 s67, s67, 1048576
    s_sub_u32 s59, s67, 4
    s_lshl_b32 s62, s66, 7
    s_add_u32 s62, s62, 327680
    s_lshl_b32 s63, s4, 12
    s_add_u32 s63, s63, 327680
    s_lshl_b32 s56, s3, 3
    s_sub_u32 s56, s56, 1
    v_add_u32 v8, s56, v1
    v_max_i32 v8, 0, v8
    v_lshlrev_b32 v8, 7, v8
    v_mov_b32 v3, 152704
    s_lshl_b32 s56, s3, 7
    v_xor_b32 v7, 1, v1
    v_add_u32 v7, s56, v7
    v_lshlrev_b32 v7, 3, v7
    v_add_u32 v7, 135552, v7
    v_cmp_eq_u32 s[100:101], 0, v0
    s_mov_b32 s64, 0x05040100
    s_mov_b32 s71, 0x07060302
    v_and_b32 v180, 3, v2
    s_movk_i32 s55, 4640
    v_mul_lo_u32 v180, v180, s55
    v_lshrrev_b32 v14, 2, v2
    v_lshl_add_u32 v180, v14, 7, v180
    v_lshl_add_u32 v180, v4, 4, v180
    s_mul_i32 s56, s98, 18560
    s_lshl_b32 s57, s99, 8
    s_add_u32 s56, s56, s57
    s_add_u32 s56, s56, 98416
    v_add_u32 v180, s56, v180
    v_and_b32 v181, 1, v2
    s_movk_i32 s55, 4224
    v_mul_lo_u32 v181, v181, s55
    v_lshrrev_b32 v14, 1, v2
    v_lshl_add_u32 v181, v14, 4, v181
    v_lshlrev_b32 v14, 4, v4
    v_sub_u32 v181, v181, v14
    s_mul_i32 s56, s98, 8448
    s_sub_u32 s56, s56, s57
    s_add_u32 s56, s56, 135744
    v_add_u32 v181, s56, v181
    s_mul_i32 s56, s98, 16384
    s_lshl_b32 s57, s99, 13
    s_add_u32 s56, s56, s57
    s_add_u32 s56, s56, 98304
    v_add_u32 v182, s56, v9
    s_waitcnt lgkmcnt(0)
    s_add_u32 s84, s84, 1
    s_or_b32 s84, s84, 0x80000000
    v_mov_b32 v24, s84
    v_mov_b32 v25, s84
    v_mov_b32 v26, s84
    v_mov_b32 v27, s84
    v_mov_b32 v14, 1
    s_mov_b64 exec, 1
    s_waitcnt vmcnt(0)
    ds_add_rtn_u32 v14, v3, v14 offset:12
    s_waitcnt lgkmcnt(0)
    v_readfirstlane_b32 s55, v14
    s_mov_b64 exec, 0xff
    s_cmp_lg_u32 s55, 3
    s_cselect_b32 s62, 0x40000000, s62
    buffer_store_dwordx4 v[24:27], v9, s[44:47], s62 offen sc0 sc1
    s_mov_b64 exec, 0x1ff
    buffer_load_dword v14, v8, s[44:47], s63 offen sc1
    s_waitcnt vmcnt(0)
    v_cmp_ne_u32 vcc, s84, v14
    s_cbranch_vccnz L_rup
L_oup:
    s_mov_b64 exec, -1
    buffer_load_dwordx4 v[32:35], v9, s[44:47], s67 offen
    buffer_load_dwordx4 v[40:43], v9, s[44:47], s67 offen offset:1024
    buffer_load_dword v36, v9, s[44:47], s59 offen
    buffer_load_dword v44, v9, s[44:47], s59 offen offset:1024
    v_mov_b32 v14, 1
    s_mov_b64 exec, 1
    ds_add_u32 v3, v14 offset:24
    s_mov_b64 exec, -1
    s_waitcnt vmcnt(0)
    v_cndmask_b32 v36, v36, 0, s[100:101]
    v_perm_b32 v64, v33, v34, s64
    v_perm_b32 v65, v36, v32, s64
    ds_write_b64 v7, v[64:65] offset:0
    v_perm_b32 v66, v34, v35, s64
    v_perm_b32 v67, v32, v33, s64
    ds_write_b64 v7, v[66:67] offset:4224
    v_perm_b32 v68, v33, v34, s71
    v_perm_b32 v69, v36, v32, s71
    ds_write_b64 v7, v[68:69] offset:8448
    v_perm_b32 v70, v34, v35, s71
    v_perm_b32 v71, v32, v33, s71
    ds_write_b64 v7, v[70:71] offset:12672
    v_perm_b32 v72, v41, v42, s64
    v_perm_b32 v73, v44, v40, s64
    ds_write_b64 v7, v[72:73] offset:512
    v_perm_b32 v74, v42, v43, s64
    v_perm_b32 v75, v40, v41, s64
    ds_write_b64 v7, v[74:75] offset:4736
    v_perm_b32 v76, v41, v42, s71
    v_perm_b32 v77, v44, v40, s71
    ds_write_b64 v7, v[76:77] offset:8960
    v_perm_b32 v78, v42, v43, s71
    v_perm_b32 v79, v40, v41, s71
    ds_write_b64 v7, v[78:79] offset:13184
    v_mov_b32 v14, 1
    s_mov_b64 exec, 1
    ds_add_u32 v3, v14 offset:40
    s_mov_b64 exec, -1
    ds_read_b32 v12, v3 offset:40
    s_waitcnt lgkmcnt(0)
    v_cmp_ne_u32 vcc, 8, v12
    s_cbranch_vccnz L_rb4a
L_ob4a:
    ds_read_b128 a[0:3], v180 offset:0
    ds_read_b128 v[16:19], v181 offset:192
    ds_read_b128 a[4:7], v180 offset:512
    ds_read_b128 v[20:23], v181 offset:704
    ds_read_b128 a[8:11], v180 offset:1024
    ds_read_b128 v[24:27], v181 offset:1216
    ds_read_b128 a[12:15], v180 offset:1536
    ds_read_b128 v[28:31], v181 offset:1728
    ds_read_b128 a[16:19], v180 offset:2048
    ds_read_b128 v[32:35], v181 offset:2240
    ds_read_b128 a[20:23], v180 offset:2560
    ds_read_b128 v[36:39], v181 offset:2752
    ds_read_b128 a[24:27], v180 offset:3072
    ds_read_b128 v[40:43], v181 offset:3264
    s_waitcnt lgkmcnt(12)
    v_mfma_f32_16x16x32_bf16 v[80:83], a[0:3], v[16:19], 0
    s_waitcnt lgkmcnt(10)
    v_mfma_f32_16x16x32_bf16 v[84:87], a[4:7], v[16:19], 0
    ds_read_b128 a[28:31], v180 offset:3584
    ds_read_b128 v[44:47], v181 offset:3776
    v_mfma_f32_16x16x32_bf16 v[84:87], a[0:3], v[20:23], v[84:87]
    s_waitcnt lgkmcnt(10)
    v_mfma_f32_16x16x32_bf16 v[88:91], a[8:11], v[16:19], 0
    v_mfma_f32_16x16x32_bf16 v[88:91], a[4:7], v[20:23], v[88:91]
    v_mfma_f32_16x16x32_bf16 v[88:91], a[0:3], v[24:27], v[88:91]
    s_waitcnt lgkmcnt(8)
    v_mfma_f32_16x16x32_bf16 v[92:95], a[12:15], v[16:19], 0
    v_mfma_f32_16x16x32_bf16 v[92:95], a[8:11], v[20:23], v[92:95]
    v_mfma_f32_16x16x32_bf16 v[92:95], a[4:7], v[24:27], v[92:95]
    v_mfma_f32_16x16x32_bf16 v[92:95], a[0:3], v[28:31], v[92:95]
    s_waitcnt lgkmcnt(6)
    v_mfma_f32_16x16x32_bf16 v[96:99], a[16:19], v[16:19], 0
    v_mfma_f32_16x16x32_bf16 v[96:99], a[12:15], v[20:23], v[96:99]
    v_mfma_f32_16x16x32_bf16 v[96:99], a[8:11], v[24:27], v[96:99]
    v_mfma_f32_16x16x32_bf16 v[96:99], a[4:7], v[28:31], v[96:99]
    v_mfma_f32_16x16x32_bf16 v[96:99], a[0:3], v[32:35], v[96:99]
    s_waitcnt lgkmcnt(4)
    v_mfma_f32_16x16x32_bf16 v[100:103], a[20:23], v[16:19], 0
    v_mfma_f32_16x16x32_bf16 v[100:103], a[16:19], v[20:23], v[100:103]
    ds_read_b128 a[32:35], v180 offset:64
    v_mfma_f32_16x16x32_bf16 v[100:103], a[12:15], v[24:27], v[100:103]
    ds_read_b128 v[48:51], v181 offset:128
    v_mfma_f32_16x16x32_bf16 v[100:103], a[8:11], v[28:31], v[100:103]
    ds_read_b128 a[36:39], v180 offset:576
    v_mfma_f32_16x16x32_bf16 v[100:103], a[4:7], v[32:35], v[100:103]
    ds_read_b128 v[52:55], v181 offset:640
    v_mfma_f32_16x16x32_bf16 v[100:103], a[0:3], v[36:39], v[100:103]
    ds_read_b128 a[40:43], v180 offset:1088
    s_waitcnt lgkmcnt(7)
    v_mfma_f32_16x16x32_bf16 v[104:107], a[24:27], v[16:19], 0
    ds_read_b128 v[56:59], v181 offset:1152
    v_mfma_f32_16x16x32_bf16 v[104:107], a[20:23], v[20:23], v[104:107]
    ds_read_b128 a[44:47], v180 offset:1600
    v_mfma_f32_16x16x32_bf16 v[104:107], a[16:19], v[24:27], v[104:107]
    ds_read_b128 v[60:63], v181 offset:1664
    v_mfma_f32_16x16x32_bf16 v[104:107], a[12:15], v[28:31], v[104:107]
    ds_read_b128 a[48:51], v180 offset:2112
    v_mfma_f32_16x16x32_bf16 v[104:107], a[8:11], v[32:35], v[104:107]
    ds_read_b128 v[64:67], v181 offset:2176
    v_mfma_f32_16x16x32_bf16 v[104:107], a[4:7], v[36:39], v[104:107]
    ds_read_b128 a[52:55], v180 offset:2624
    v_mfma_f32_16x16x32_bf16 v[104:107], a[0:3], v[40:43], v[104:107]
    ds_read_b128 v[68:71], v181 offset:2688
    s_waitcnt lgkmcnt(12)
    v_mfma_f32_16x16x32_bf16 v[108:111], a[28:31], v[16:19], 0
    ds_read_b128 a[56:59], v180 offset:3136
    v_mfma_f32_16x16x32_bf16 v[108:111], a[24:27], v[20:23], v[108:111]
    ds_read_b128 v[72:75], v181 offset:3200
    v_mfma_f32_16x16x32_bf16 v[108:111], a[20:23], v[24:27], v[108:111]
    ds_read_b128 a[60:63], v180 offset:3648
    v_mfma_f32_16x16x32_bf16 v[108:111], a[16:19], v[28:31], v[108:111]
    ds_read_b128 v[76:79], v181 offset:3712
    v_mfma_f32_16x16x32_bf16 v[108:111], a[12:15], v[32:35], v[108:111]
    v_mfma_f32_16x16x32_bf16 v[108:111], a[8:11], v[36:39], v[108:111]
    v_mfma_f32_16x16x32_bf16 v[108:111], a[4:7], v[40:43], v[108:111]
    v_mfma_f32_16x16x32_bf16 v[108:111], a[0:3], v[44:47], v[108:111]
    s_waitcnt lgkmcnt(0)
    v_mfma_f32_16x16x32_bf16 v[80:83], a[32:35], v[48:51], v[80:83]
    v_lshrrev_b32 v5, 2, v1
    v_mfma_f32_16x16x32_bf16 v[84:87], a[36:39], v[48:51], v[84:87]
    v_mul_u32_u24 v5, 96, v5
    v_mfma_f32_16x16x32_bf16 v[88:91], a[40:43], v[48:51], v[88:91]
    v_and_b32 v14, 3, v1
    v_mfma_f32_16x16x32_bf16 v[92:95], a[44:47], v[48:51], v[92:95]
    v_lshl_add_u32 v5, v14, 3, v5
    v_mov_b32 v14, 1
    ds_write_b32 v3, v14 offset:32
    v_mfma_f32_16x16x32_bf16 v[96:99], a[48:51], v[48:51], v[96:99]
    v_add_u32 v6, 49152, v5
    v_mfma_f32_16x16x32_bf16 v[100:103], a[52:55], v[48:51], v[100:103]
    s_lshl_b32 s55, s3, 12
    v_mfma_f32_16x16x32_bf16 v[104:107], a[56:59], v[48:51], v[104:107]
    v_add_u32 v7, s55, v9
    v_mfma_f32_16x16x32_bf16 v[108:111], a[60:63], v[48:51], v[108:111]
    s_lshl_b32 s67, s86, 18
    v_mfma_f32_16x16x32_bf16 v[84:87], a[32:35], v[52:55], v[84:87]
    s_add_u32 s67, s67, 7340032
    v_mfma_f32_16x16x32_bf16 v[88:91], a[36:39], v[52:55], v[88:91]
    v_lshlrev_b32 v8, 4, v4
    v_mfma_f32_16x16x32_bf16 v[92:95], a[40:43], v[52:55], v[92:95]
    v_add_u32 v8, 152320, v8
    v_mfma_f32_16x16x32_bf16 v[96:99], a[44:47], v[52:55], v[96:99]
    v_mov_b32 v3, 152704
    v_mfma_f32_16x16x32_bf16 v[100:103], a[48:51], v[52:55], v[100:103]
    v_lshlrev_b32 v10, 2, v2
    v_mfma_f32_16x16x32_bf16 v[104:107], a[52:55], v[52:55], v[104:107]
    v_add_u32 v10, 0xc0, v10
    v_mfma_f32_16x16x32_bf16 v[108:111], a[56:59], v[52:55], v[108:111]
    v_mfma_f32_16x16x32_bf16 v[88:91], a[32:35], v[56:59], v[88:91]
    v_mfma_f32_16x16x32_bf16 v[92:95], a[36:39], v[56:59], v[92:95]
    ds_read_b128 a[0:3], v180 offset:128
    v_mfma_f32_16x16x32_bf16 v[96:99], a[40:43], v[56:59], v[96:99]
    ds_read_b128 v[16:19], v181 offset:64
    v_mfma_f32_16x16x32_bf16 v[100:103], a[44:47], v[56:59], v[100:103]
    ds_read_b128 a[4:7], v180 offset:640
    v_mfma_f32_16x16x32_bf16 v[104:107], a[48:51], v[56:59], v[104:107]
    ds_read_b128 v[20:23], v181 offset:576
    v_mfma_f32_16x16x32_bf16 v[108:111], a[52:55], v[56:59], v[108:111]
    ds_read_b128 a[8:11], v180 offset:1152
    v_mfma_f32_16x16x32_bf16 v[92:95], a[32:35], v[60:63], v[92:95]
    ds_read_b128 v[24:27], v181 offset:1088
    v_mfma_f32_16x16x32_bf16 v[96:99], a[36:39], v[60:63], v[96:99]
    ds_read_b128 a[12:15], v180 offset:1664
    v_mfma_f32_16x16x32_bf16 v[100:103], a[40:43], v[60:63], v[100:103]
    ds_read_b128 v[28:31], v181 offset:1600
    v_mfma_f32_16x16x32_bf16 v[104:107], a[44:47], v[60:63], v[104:107]
    ds_read_b128 a[16:19], v180 offset:2176
    v_mfma_f32_16x16x32_bf16 v[108:111], a[48:51], v[60:63], v[108:111]
    ds_read_b128 v[32:35], v181 offset:2112
    v_mfma_f32_16x16x32_bf16 v[96:99], a[32:35], v[64:67], v[96:99]
    ds_read_b128 a[20:23], v180 offset:2688
    v_mfma_f32_16x16x32_bf16 v[100:103], a[36:39], v[64:67], v[100:103]
    ds_read_b128 v[36:39], v181 offset:2624
    v_mfma_f32_16x16x32_bf16 v[104:107], a[40:43], v[64:67], v[104:107]
    ds_read_b128 a[24:27], v180 offset:3200
    v_mfma_f32_16x16x32_bf16 v[108:111], a[44:47], v[64:67], v[108:111]
    ds_read_b128 v[40:43], v181 offset:3136
    v_mfma_f32_16x16x32_bf16 v[100:103], a[32:35], v[68:71], v[100:103]
    ds_read_b128 a[28:31], v180 offset:3712
    v_mfma_f32_16x16x32_bf16 v[104:107], a[36:39], v[68:71], v[104:107]
    ds_read_b128 v[44:47], v181 offset:3648
    v_mfma_f32_16x16x32_bf16 v[108:111], a[40:43], v[68:71], v[108:111]
    v_mfma_f32_16x16x32_bf16 v[104:107], a[32:35], v[72:75], v[104:107]
    v_mfma_f32_16x16x32_bf16 v[108:111], a[36:39], v[72:75], v[108:111]
    v_mfma_f32_16x16x32_bf16 v[108:111], a[32:35], v[76:79], v[108:111]
    s_waitcnt lgkmcnt(0)
    v_mfma_f32_16x16x32_bf16 v[80:83], a[0:3], v[16:19], v[80:83]
    v_mfma_f32_16x16x32_bf16 v[84:87], a[4:7], v[16:19], v[84:87]
    v_mfma_f32_16x16x32_bf16 v[88:91], a[8:11], v[16:19], v[88:91]
    v_mfma_f32_16x16x32_bf16 v[92:95], a[12:15], v[16:19], v[92:95]
    v_mfma_f32_16x16x32_bf16 v[96:99], a[16:19], v[16:19], v[96:99]
    v_mfma_f32_16x16x32_bf16 v[100:103], a[20:23], v[16:19], v[100:103]
    v_mfma_f32_16x16x32_bf16 v[104:107], a[24:27], v[16:19], v[104:107]
    v_mfma_f32_16x16x32_bf16 v[108:111], a[28:31], v[16:19], v[108:111]
    v_mfma_f32_16x16x32_bf16 v[84:87], a[0:3], v[20:23], v[84:87]
    v_mfma_f32_16x16x32_bf16 v[88:91], a[4:7], v[20:23], v[88:91]
    v_mfma_f32_16x16x32_bf16 v[92:95], a[8:11], v[20:23], v[92:95]
    v_mfma_f32_16x16x32_bf16 v[96:99], a[12:15], v[20:23], v[96:99]
    v_mfma_f32_16x16x32_bf16 v[100:103], a[16:19], v[20:23], v[100:103]
    v_mfma_f32_16x16x32_bf16 v[104:107], a[20:23], v[20:23], v[104:107]
    v_mfma_f32_16x16x32_bf16 v[108:111], a[24:27], v[20:23], v[108:111]
    v_mfma_f32_16x16x32_bf16 v[88:91], a[0:3], v[24:27], v[88:91]
    v_mfma_f32_16x16x32_bf16 v[92:95], a[4:7], v[24:27], v[92:95]
    ds_read_b128 a[32:35], v180 offset:192
    v_mfma_f32_16x16x32_bf16 v[96:99], a[8:11], v[24:27], v[96:99]
    ds_read_b128 v[48:51], v181 offset:0
    v_mfma_f32_16x16x32_bf16 v[100:103], a[12:15], v[24:27], v[100:103]
    ds_read_b128 a[36:39], v180 offset:704
    v_mfma_f32_16x16x32_bf16 v[104:107], a[16:19], v[24:27], v[104:107]
    ds_read_b128 v[52:55], v181 offset:512
    v_mfma_f32_16x16x32_bf16 v[108:111], a[20:23], v[24:27], v[108:111]
    ds_read_b128 a[40:43], v180 offset:1216
    v_mfma_f32_16x16x32_bf16 v[92:95], a[0:3], v[28:31], v[92:95]
    ds_read_b128 v[56:59], v181 offset:1024
    v_mfma_f32_16x16x32_bf16 v[96:99], a[4:7], v[28:31], v[96:99]
    ds_read_b128 a[44:47], v180 offset:1728
    v_mfma_f32_16x16x32_bf16 v[100:103], a[8:11], v[28:31], v[100:103]
    ds_read_b128 v[60:63], v181 offset:1536
    v_mfma_f32_16x16x32_bf16 v[104:107], a[12:15], v[28:31], v[104:107]
    ds_read_b128 a[48:51], v180 offset:2240
    v_mfma_f32_16x16x32_bf16 v[108:111], a[16:19], v[28:31], v[108:111]
    ds_read_b128 v[64:67], v181 offset:2048
    v_mfma_f32_16x16x32_bf16 v[96:99], a[0:3], v[32:35], v[96:99]
    ds_read_b128 a[52:55], v180 offset:2752
    v_mfma_f32_16x16x32_bf16 v[100:103], a[4:7], v[32:35], v[100:103]
    ds_read_b128 v[68:71], v181 offset:2560
    v_mfma_f32_16x16x32_bf16 v[104:107], a[8:11], v[32:35], v[104:107]
    ds_read_b128 a[56:59], v180 offset:3264
    v_mfma_f32_16x16x32_bf16 v[108:111], a[12:15], v[32:35], v[108:111]
    ds_read_b128 v[72:75], v181 offset:3072
    v_mfma_f32_16x16x32_bf16 v[100:103], a[0:3], v[36:39], v[100:103]
    ds_read_b128 a[60:63], v180 offset:3776
    v_mfma_f32_16x16x32_bf16 v[104:107], a[4:7], v[36:39], v[104:107]
    ds_read_b128 v[76:79], v181 offset:3584
    v_mfma_f32_16x16x32_bf16 v[108:111], a[8:11], v[36:39], v[108:111]
    v_mfma_f32_16x16x32_bf16 v[104:107], a[0:3], v[40:43], v[104:107]
    v_mfma_f32_16x16x32_bf16 v[108:111], a[4:7], v[40:43], v[108:111]
    v_mfma_f32_16x16x32_bf16 v[108:111], a[0:3], v[44:47], v[108:111]
    s_waitcnt lgkmcnt(0)
    v_mov_b32 v14, 1
    s_mov_b64 exec, 1
    ds_add_u32 v3, v14 offset:16
    s_mov_b64 exec, -1
    v_mfma_f32_16x16x32_bf16 v[80:83], a[32:35], v[48:51], v[80:83]
    v_mfma_f32_16x16x32_bf16 v[84:87], a[36:39], v[48:51], v[84:87]
    v_mfma_f32_16x16x32_bf16 v[84:87], a[32:35], v[52:55], v[84:87]
    v_mfma_f32_16x16x32_bf16 v[88:91], a[40:43], v[48:51], v[88:91]
    v_mfma_f32_16x16x32_bf16 v[88:91], a[36:39], v[52:55], v[88:91]
    v_mfma_f32_16x16x32_bf16 v[88:91], a[32:35], v[56:59], v[88:91]
    v_mfma_f32_16x16x32_bf16 v[92:95], a[44:47], v[48:51], v[92:95]
    ds_read_b32 v12, v3 offset:16
    v_mfma_f32_16x16x32_bf16 v[92:95], a[40:43], v[52:55], v[92:95]
    v_mfma_f32_16x16x32_bf16 v[92:95], a[36:39], v[56:59], v[92:95]
    v_mfma_f32_16x16x32_bf16 v[92:95], a[32:35], v[60:63], v[92:95]
    v_mfma_f32_16x16x32_bf16 v[96:99], a[48:51], v[48:51], v[96:99]
    v_mfma_f32_16x16x32_bf16 v[96:99], a[44:47], v[52:55], v[96:99]
    v_mfma_f32_16x16x32_bf16 v[96:99], a[40:43], v[56:59], v[96:99]
    s_waitcnt lgkmcnt(0)
    v_cmp_ne_u32 vcc, 4, v12
    v_mfma_f32_16x16x32_bf16 v[96:99], a[36:39], v[60:63], v[96:99]
    v_mfma_f32_16x16x32_bf16 v[96:99], a[32:35], v[64:67], v[96:99]
    s_cbranch_vccnz L_rkc
L_okc:
    v_mfma_f32_16x16x32_bf16 v[100:103], a[52:55], v[48:51], v[100:103]
    ds_write_b128 v182, v[80:83] offset:0
    v_mfma_f32_16x16x32_bf16 v[100:103], a[48:51], v[52:55], v[100:103]
    v_mfma_f32_16x16x32_bf16 v[100:103], a[44:47], v[56:59], v[100:103]
    ds_write_b128 v182, v[84:87] offset:1024
    v_mfma_f32_16x16x32_bf16 v[100:103], a[40:43], v[60:63], v[100:103]
    v_mfma_f32_16x16x32_bf16 v[100:103], a[36:39], v[64:67], v[100:103]
    ds_write_b128 v182, v[88:91] offset:2048
    v_mfma_f32_16x16x32_bf16 v[100:103], a[32:35], v[68:71], v[100:103]
    v_mfma_f32_16x16x32_bf16 v[104:107], a[56:59], v[48:51], v[104:107]
    ds_write_b128 v182, v[92:95] offset:3072
    v_mfma_f32_16x16x32_bf16 v[104:107], a[52:55], v[52:55], v[104:107]
    v_mfma_f32_16x16x32_bf16 v[104:107], a[48:51], v[56:59], v[104:107]
    ds_write_b128 v182, v[96:99] offset:4096
    v_mfma_f32_16x16x32_bf16 v[104:107], a[44:47], v[60:63], v[104:107]
    v_mfma_f32_16x16x32_bf16 v[104:107], a[40:43], v[64:67], v[104:107]
    v_mfma_f32_16x16x32_bf16 v[104:107], a[36:39], v[68:71], v[104:107]
    v_mfma_f32_16x16x32_bf16 v[104:107], a[32:35], v[72:75], v[104:107]
    v_mfma_f32_16x16x32_bf16 v[108:111], a[60:63], v[48:51], v[108:111]
    ds_write_b128 v182, v[100:103] offset:5120
    v_mfma_f32_16x16x32_bf16 v[108:111], a[56:59], v[52:55], v[108:111]
    v_mfma_f32_16x16x32_bf16 v[108:111], a[52:55], v[56:59], v[108:111]
    v_mfma_f32_16x16x32_bf16 v[108:111], a[48:51], v[60:63], v[108:111]
    v_mfma_f32_16x16x32_bf16 v[108:111], a[44:47], v[64:67], v[108:111]
    v_mfma_f32_16x16x32_bf16 v[108:111], a[40:43], v[68:71], v[108:111]
    v_mfma_f32_16x16x32_bf16 v[108:111], a[36:39], v[72:75], v[108:111]
    v_mfma_f32_16x16x32_bf16 v[108:111], a[32:35], v[76:79], v[108:111]
    ds_write_b128 v182, v[104:107] offset:6144
    s_nop 6
    ds_write_b128 v182, v[108:111] offset:7168
    s_waitcnt lgkmcnt(0)
    s_barrier
    s_barrier
    s_add_u32 s55, s88, 0
    s_and_b32 s55, s55, 15
    s_lshl_b32 s55, s55, 14
    s_add_u32 s96, s55, s67
    buffer_load_dwordx4 v[16:19], v7, s[44:47], s96 offen offset:0 sc1
    buffer_load_dwordx4 v[20:23], v7, s[44:47], s96 offen offset:1024 sc1
    buffer_load_dwordx4 v[24:27], v7, s[44:47], s96 offen offset:2048 sc1
    buffer_load_dwordx4 v[28:31], v7, s[44:47], s96 offen offset:3072 sc1
    ds_read_b64_tr_b16 a[0:1], v5 offset:0
    ds_read_b64_tr_b16 a[2:3], v5 offset:1536
    ds_read_b64_tr_b16 a[4:5], v5 offset:32
    ds_read_b64_tr_b16 a[6:7], v5 offset:1568
    ds_read_b64_tr_b16 a[8:9], v5 offset:64
    ds_read_b64_tr_b16 a[10:11], v5 offset:1600
    ds_read_b64_tr_b16 a[12:13], v6 offset:0
    ds_read_b64_tr_b16 a[14:15], v6 offset:1536
    ds_read_b64_tr_b16 a[16:17], v6 offset:32
    ds_read_b64_tr_b16 a[18:19], v6 offset:1568
    ds_read_b64_tr_b16 a[20:21], v6 offset:64
    ds_read_b64_tr_b16 a[22:23], v6 offset:1600
    s_waitcnt vmcnt(0)
    v_max3_u32 v11, v16, v20, v24
    v_max_u32 v11, v11, v28
    v_cmp_eq_u32 vcc, -1, v11
    s_cbranch_vccnz L_rxP
L_oxP:
    s_add_u32 s55, s88, 1
    s_and_b32 s55, s55, 15
    s_lshl_b32 s55, s55, 14
    s_add_u32 s96, s55, s67
    buffer_load_dwordx4 v[32:35], v7, s[44:47], s96 offen offset:0 sc1
    buffer_load_dwordx4 v[36:39], v7, s[44:47], s96 offen offset:1024 sc1
    buffer_load_dwordx4 v[40:43], v7, s[44:47], s96 offen offset:2048 sc1
    buffer_load_dwordx4 v[44:47], v7, s[44:47], s96 offen offset:3072 sc1
    s_add_u32 s55, s88, 2
    s_and_b32 s55, s55, 15
    s_lshl_b32 s55, s55, 14
    s_add_u32 s96, s55, s67
    buffer_load_dwordx4 v[48:51], v7, s[44:47], s96 offen offset:0 sc1
    buffer_load_dwordx4 v[52:55], v7, s[44:47], s96 offen offset:1024 sc1
    buffer_load_dwordx4 v[56:59], v7, s[44:47], s96 offen offset:2048 sc1
    buffer_load_dwordx4 v[60:63], v7, s[44:47], s96 offen offset:3072 sc1
    v_swap_b32 v17, v20
    v_swap_b32 v18, v24
    v_swap_b32 v19, v28
    v_swap_b32 v22, v25
    v_swap_b32 v23, v29
    v_swap_b32 v27, v30
    s_setprio 2
    s_cmp_eq_u32 s87, 31
    s_cbranch_scc1 L_p2alt
    s_waitcnt lgkmcnt(0)
    v_mfma_f32_16x16x32_bf16 v[80:83], a[0:3], v[16:19], 0
    s_add_u32 s55, s88, 3
    s_and_b32 s55, s55, 15
    v_mfma_f32_16x16x32_bf16 v[84:87], a[0:3], v[20:23], 0
    s_lshl_b32 s55, s55, 14
    s_add_u32 s96, s55, s67
    v_mfma_f32_16x16x32_bf16 v[88:91], a[0:3], v[24:27], 0
    ds_read_b64_tr_b16 a[24:25], v5 offset:3072
    buffer_load_dwordx4 v[64:67], v7, s[44:47], s96 offen offset:0 sc1
    v_mfma_f32_16x16x32_bf16 v[92:95], a[0:3], v[28:31], 0
    ds_read_b64_tr_b16 a[26:27], v5 offset:4608
    v_mfma_f32_16x16x32_bf16 v[96:99], a[4:7], v[16:19], 0
    ds_read_b64_tr_b16 a[28:29], v5 offset:3104
    buffer_load_dwordx4 v[68:71], v7, s[44:47], s96 offen offset:1024 sc1
    v_mfma_f32_16x16x32_bf16 v[100:103], a[4:7], v[20:23], 0
    ds_read_b64_tr_b16 a[30:31], v5 offset:4640
    v_mfma_f32_16x16x32_bf16 v[104:107], a[4:7], v[24:27], 0
    ds_read_b64_tr_b16 a[32:33], v5 offset:3136
    buffer_load_dwordx4 v[72:75], v7, s[44:47], s96 offen offset:2048 sc1
    v_mfma_f32_16x16x32_bf16 v[108:111], a[4:7], v[28:31], 0
    ds_read_b64_tr_b16 a[34:35], v5 offset:4672
    v_mfma_f32_16x16x32_bf16 v[112:115], a[8:11], v[16:19], 0
    ds_read_b64_tr_b16 a[36:37], v6 offset:3072
    buffer_load_dwordx4 v[76:79], v7, s[44:47], s96 offen offset:3072 sc1
    v_mfma_f32_16x16x32_bf16 v[116:119], a[8:11], v[20:23], 0
    ds_read_b64_tr_b16 a[38:39], v6 offset:4608
    v_mov_b32 v13, 1
    v_mfma_f32_16x16x32_bf16 v[120:123], a[8:11], v[24:27], 0
    ds_read_b64_tr_b16 a[40:41], v6 offset:3104
    v_mfma_f32_16x16x32_bf16 v[124:127], a[8:11], v[28:31], 0
    ds_read_b64_tr_b16 a[42:43], v6 offset:4640
    v_mfma_f32_16x16x32_bf16 v[128:131], a[12:15], v[16:19], 0
    ds_read_b64_tr_b16 a[44:45], v6 offset:3136
    s_waitcnt vmcnt(8)
    v_max3_u32 v11, v32, v36, v40
    v_mfma_f32_16x16x32_bf16 v[132:135], a[12:15], v[20:23], 0
    ds_read_b64_tr_b16 a[46:47], v6 offset:4672
    v_max_u32 v11, v11, v44
    v_mfma_f32_16x16x32_bf16 v[136:139], a[12:15], v[24:27], 0
    v_cmp_eq_u32 vcc, -1, v11
    v_mfma_f32_16x16x32_bf16 v[140:143], a[12:15], v[28:31], 0
    ds_write_b32 v3, v13 offset:36
    v_mfma_f32_16x16x32_bf16 v[144:147], a[16:19], v[16:19], 0
    s_cbranch_vccnz L_rxa1
L_oxa1:
    v_swap_b32 v33, v36
    v_mfma_f32_16x16x32_bf16 v[148:151], a[16:19], v[20:23], 0
    v_swap_b32 v34, v40
    v_mfma_f32_16x16x32_bf16 v[152:155], a[16:19], v[24:27], 0
    v_swap_b32 v35, v44
    v_mfma_f32_16x16x32_bf16 v[156:159], a[16:19], v[28:31], 0
    v_swap_b32 v38, v41
    v_mfma_f32_16x16x32_bf16 v[160:163], a[20:23], v[16:19], 0
    v_swap_b32 v39, v45
    v_mfma_f32_16x16x32_bf16 v[164:167], a[20:23], v[20:23], 0
    v_swap_b32 v43, v46
    v_mfma_f32_16x16x32_bf16 v[168:171], a[20:23], v[24:27], 0
    v_mfma_f32_16x16x32_bf16 v[172:175], a[20:23], v[28:31], 0
    s_waitcnt lgkmcnt(0)
    v_mfma_f32_16x16x32_bf16 v[80:83], a[24:27], v[32:35], v[80:83]
    s_add_u32 s55, s88, 4
    s_and_b32 s55, s55, 15
    v_mfma_f32_16x16x32_bf16 v[84:87], a[24:27], v[36:39], v[84:87]
    s_lshl_b32 s55, s55, 14
    s_add_u32 s96, s55, s67
    v_mfma_f32_16x16x32_bf16 v[88:91], a[24:27], v[40:43], v[88:91]
    ds_read_b64_tr_b16 a[0:1], v5 offset:6144
    buffer_load_dwordx4 v[16:19], v7, s[44:47], s96 offen offset:0 sc1
    v_mfma_f32_16x16x32_bf16 v[92:95], a[24:27], v[44:47], v[92:95]
    ds_read_b64_tr_b16 a[2:3], v5 offset:7680
    v_mfma_f32_16x16x32_bf16 v[96:99], a[28:31], v[32:35], v[96:99]
    ds_read_b64_tr_b16 a[4:5], v5 offset:6176
    buffer_load_dwordx4 v[20:23], v7, s[44:47], s96 offen offset:1024 sc1
    v_mfma_f32_16x16x32_bf16 v[100:103], a[28:31], v[36:39], v[100:103]
    ds_read_b64_tr_b16 a[6:7], v5 offset:7712
    v_mfma_f32_16x16x32_bf16 v[104:107], a[28:31], v[40:43], v[104:107]
    ds_read_b64_tr_b16 a[8:9], v5 offset:6208
    buffer_load_dwordx4 v[24:27], v7, s[44:47], s96 offen offset:2048 sc1
    v_mfma_f32_16x16x32_bf16 v[108:111], a[28:31], v[44:47], v[108:111]
    ds_read_b64_tr_b16 a[10:11], v5 offset:7744
    v_mfma_f32_16x16x32_bf16 v[112:115], a[32:35], v[32:35], v[112:115]
    ds_read_b64_tr_b16 a[12:13], v6 offset:6144
    buffer_load_dwordx4 v[28:31], v7, s[44:47], s96 offen offset:3072 sc1
    v_mfma_f32_16x16x32_bf16 v[116:119], a[32:35], v[36:39], v[116:119]
    ds_read_b64_tr_b16 a[14:15], v6 offset:7680
    v_mov_b32 v13, 2
    v_mfma_f32_16x16x32_bf16 v[120:123], a[32:35], v[40:43], v[120:123]
    ds_read_b64_tr_b16 a[16:17], v6 offset:6176
    v_mfma_f32_16x16x32_bf16 v[124:127], a[32:35], v[44:47], v[124:127]
    ds_read_b64_tr_b16 a[18:19], v6 offset:7712
    v_mfma_f32_16x16x32_bf16 v[128:131], a[36:39], v[32:35], v[128:131]
    ds_read_b64_tr_b16 a[20:21], v6 offset:6208
    s_waitcnt vmcnt(8)
    v_max3_u32 v11, v48, v52, v56
    v_mfma_f32_16x16x32_bf16 v[132:135], a[36:39], v[36:39], v[132:135]
    ds_read_b64_tr_b16 a[22:23], v6 offset:7744
    v_max_u32 v11, v11, v60
    v_mfma_f32_16x16x32_bf16 v[136:139], a[36:39], v[40:43], v[136:139]
    v_cmp_eq_u32 vcc, -1, v11
    v_mfma_f32_16x16x32_bf16 v[140:143], a[36:39], v[44:47], v[140:143]
    ds_write_b32 v3, v13 offset:36
    v_mfma_f32_16x16x32_bf16 v[144:147], a[40:43], v[32:35], v[144:147]
    s_cbranch_vccnz L_rxa2
L_oxa2:
    v_swap_b32 v49, v52
    v_mfma_f32_16x16x32_bf16 v[148:151], a[40:43], v[36:39], v[148:151]
    v_swap_b32 v50, v56
    v_mfma_f32_16x16x32_bf16 v[152:155], a[40:43], v[40:43], v[152:155]
    v_swap_b32 v51, v60
    v_mfma_f32_16x16x32_bf16 v[156:159], a[40:43], v[44:47], v[156:159]
    v_swap_b32 v54, v57
    v_mfma_f32_16x16x32_bf16 v[160:163], a[44:47], v[32:35], v[160:163]
    v_swap_b32 v55, v61
    v_mfma_f32_16x16x32_bf16 v[164:167], a[44:47], v[36:39], v[164:167]
    v_swap_b32 v59, v62
    v_mfma_f32_16x16x32_bf16 v[168:171], a[44:47], v[40:43], v[168:171]
    v_mfma_f32_16x16x32_bf16 v[172:175], a[44:47], v[44:47], v[172:175]
    s_waitcnt lgkmcnt(0)
    v_mfma_f32_16x16x32_bf16 v[80:83], a[0:3], v[48:51], v[80:83]
    s_add_u32 s55, s88, 5
    s_and_b32 s55, s55, 15
    v_mfma_f32_16x16x32_bf16 v[84:87], a[0:3], v[52:55], v[84:87]
    s_lshl_b32 s55, s55, 14
    s_add_u32 s96, s55, s67
    v_mfma_f32_16x16x32_bf16 v[88:91], a[0:3], v[56:59], v[88:91]
    ds_read_b64_tr_b16 a[24:25], v5 offset:9216
    buffer_load_dwordx4 v[32:35], v7, s[44:47], s96 offen offset:0 sc1
    v_mfma_f32_16x16x32_bf16 v[92:95], a[0:3], v[60:63], v[92:95]
    ds_read_b64_tr_b16 a[26:27], v5 offset:10752
    v_mfma_f32_16x16x32_bf16 v[96:99], a[4:7], v[48:51], v[96:99]
    ds_read_b64_tr_b16 a[28:29], v5 offset:9248
    buffer_load_dwordx4 v[36:39], v7, s[44:47], s96 offen offset:1024 sc1
    v_mfma_f32_16x16x32_bf16 v[100:103], a[4:7], v[52:55], v[100:103]
    ds_read_b64_tr_b16 a[30:31], v5 offset:10784
    v_mfma_f32_16x16x32_bf16 v[104:107], a[4:7], v[56:59], v[104:107]
    ds_read_b64_tr_b16 a[32:33], v5 offset:9280
    buffer_load_dwordx4 v[40:43], v7, s[44:47], s96 offen offset:2048 sc1
    v_mfma_f32_16x16x32_bf16 v[108:111], a[4:7], v[60:63], v[108:111]
    ds_read_b64_tr_b16 a[34:35], v5 offset:10816
    v_mfma_f32_16x16x32_bf16 v[112:115], a[8:11], v[48:51], v[112:115]
    ds_read_b64_tr_b16 a[36:37], v6 offset:9216
    buffer_load_dwordx4 v[44:47], v7, s[44:47], s96 offen offset:3072 sc1
    v_mfma_f32_16x16x32_bf16 v[116:119], a[8:11], v[52:55], v[116:119]
    ds_read_b64_tr_b16 a[38:39], v6 offset:10752
    v_mov_b32 v13, 3
    v_mfma_f32_16x16x32_bf16 v[120:123], a[8:11], v[56:59], v[120:123]
    ds_read_b64_tr_b16 a[40:41], v6 offset:9248
    v_mfma_f32_16x16x32_bf16 v[124:127], a[8:11], v[60:63], v[124:127]
    ds_read_b64_tr_b16 a[42:43], v6 offset:10784
    v_mfma_f32_16x16x32_bf16 v[128:131], a[12:15], v[48:51], v[128:131]
    ds_read_b64_tr_b16 a[44:45], v6 offset:9280
    s_waitcnt vmcnt(8)
    v_max3_u32 v11, v64, v68, v72
    v_mfma_f32_16x16x32_bf16 v[132:135], a[12:15], v[52:55], v[132:135]
    ds_read_b64_tr_b16 a[46:47], v6 offset:10816
    v_max_u32 v11, v11, v76
    v_mfma_f32_16x16x32_bf16 v[136:139], a[12:15], v[56:59], v[136:139]
    v_cmp_eq_u32 vcc, -1, v11
    v_mfma_f32_16x16x32_bf16 v[140:143], a[12:15], v[60:63], v[140:143]
    ds_write_b32 v3, v13 offset:36
    v_mfma_f32_16x16x32_bf16 v[144:147], a[16:19], v[48:51], v[144:147]
    s_cbranch_vccnz L_rxa3
L_oxa3:
    v_swap_b32 v65, v68
    v_mfma_f32_16x16x32_bf16 v[148:151], a[16:19], v[52:55], v[148:151]
    v_swap_b32 v66, v72
    v_mfma_f32_16x16x32_bf16 v[152:155], a[16:19], v[56:59], v[152:155]
    v_swap_b32 v67, v76
    v_mfma_f32_16x16x32_bf16 v[156:159], a[16:19], v[60:63], v[156:159]
    v_swap_b32 v70, v73
    v_mfma_f32_16x16x32_bf16 v[160:163], a[20:23], v[48:51], v[160:163]
    v_swap_b32 v71, v77
    v_mfma_f32_16x16x32_bf16 v[164:167], a[20:23], v[52:55], v[164:167]
    v_swap_b32 v75, v78
    v_mfma_f32_16x16x32_bf16 v[168:171], a[20:23], v[56:59], v[168:171]
    v_mfma_f32_16x16x32_bf16 v[172:175], a[20:23], v[60:63], v[172:175]
    s_waitcnt lgkmcnt(0)
    v_mfma_f32_16x16x32_bf16 v[80:83], a[24:27], v[64:67], v[80:83]
    s_add_u32 s55, s88, 6
    s_and_b32 s55, s55, 15
    v_mfma_f32_16x16x32_bf16 v[84:87], a[24:27], v[68:71], v[84:87]
    s_lshl_b32 s55, s55, 14
    s_add_u32 s96, s55, s67
    v_mfma_f32_16x16x32_bf16 v[88:91], a[24:27], v[72:75], v[88:91]
    ds_read_b64_tr_b16 a[0:1], v5 offset:12288
    buffer_load_dwordx4 v[48:51], v7, s[44:47], s96 offen offset:0 sc1
    v_mfma_f32_16x16x32_bf16 v[92:95], a[24:27], v[76:79], v[92:95]
    ds_read_b64_tr_b16 a[2:3], v5 offset:13824
    v_mfma_f32_16x16x32_bf16 v[96:99], a[28:31], v[64:67], v[96:99]
    ds_read_b64_tr_b16 a[4:5], v5 offset:12320
    buffer_load_dwordx4 v[52:55], v7, s[44:47], s96 offen offset:1024 sc1
    v_mfma_f32_16x16x32_bf16 v[100:103], a[28:31], v[68:71], v[100:103]
    ds_read_b64_tr_b16 a[6:7], v5 offset:13856
    v_mfma_f32_16x16x32_bf16 v[104:107], a[28:31], v[72:75], v[104:107]
    ds_read_b64_tr_b16 a[8:9], v5 offset:12352
    buffer_load_dwordx4 v[56:59], v7, s[44:47], s96 offen offset:2048 sc1
    v_mfma_f32_16x16x32_bf16 v[108:111], a[28:31], v[76:79], v[108:111]
    ds_read_b64_tr_b16 a[10:11], v5 offset:13888
    v_mfma_f32_16x16x32_bf16 v[112:115], a[32:35], v[64:67], v[112:115]
    ds_read_b64_tr_b16 a[12:13], v6 offset:12288
    buffer_load_dwordx4 v[60:63], v7, s[44:47], s96 offen offset:3072 sc1
    v_mfma_f32_16x16x32_bf16 v[116:119], a[32:35], v[68:71], v[116:119]
    ds_read_b64_tr_b16 a[14:15], v6 offset:13824
    v_mov_b32 v13, 4
    v_mfma_f32_16x16x32_bf16 v[120:123], a[32:35], v[72:75], v[120:123]
    ds_read_b64_tr_b16 a[16:17], v6 offset:12320
    v_mfma_f32_16x16x32_bf16 v[124:127], a[32:35], v[76:79], v[124:127]
    ds_read_b64_tr_b16 a[18:19], v6 offset:13856
    v_mfma_f32_16x16x32_bf16 v[128:131], a[36:39], v[64:67], v[128:131]
    ds_read_b64_tr_b16 a[20:21], v6 offset:12352
    s_waitcnt vmcnt(8)
    v_max3_u32 v11, v16, v20, v24
    v_mfma_f32_16x16x32_bf16 v[132:135], a[36:39], v[68:71], v[132:135]
    ds_read_b64_tr_b16 a[22:23], v6 offset:13888
    v_max_u32 v11, v11, v28
    v_mfma_f32_16x16x32_bf16 v[136:139], a[36:39], v[72:75], v[136:139]
    v_cmp_eq_u32 vcc, -1, v11
    v_mfma_f32_16x16x32_bf16 v[140:143], a[36:39], v[76:79], v[140:143]
    ds_write_b32 v3, v13 offset:36
    v_mfma_f32_16x16x32_bf16 v[144:147], a[40:43], v[64:67], v[144:147]
    s_cbranch_vccnz L_rxa4
L_oxa4:
    v_swap_b32 v17, v20
    v_mfma_f32_16x16x32_bf16 v[148:151], a[40:43], v[68:71], v[148:151]
    v_swap_b32 v18, v24
    v_mfma_f32_16x16x32_bf16 v[152:155], a[40:43], v[72:75], v[152:155]
    v_swap_b32 v19, v28
    v_mfma_f32_16x16x32_bf16 v[156:159], a[40:43], v[76:79], v[156:159]
    v_swap_b32 v22, v25
    v_mfma_f32_16x16x32_bf16 v[160:163], a[44:47], v[64:67], v[160:163]
    v_swap_b32 v23, v29
    v_mfma_f32_16x16x32_bf16 v[164:167], a[44:47], v[68:71], v[164:167]
    v_swap_b32 v27, v30
    v_mfma_f32_16x16x32_bf16 v[168:171], a[44:47], v[72:75], v[168:171]
    v_mfma_f32_16x16x32_bf16 v[172:175], a[44:47], v[76:79], v[172:175]
    s_waitcnt lgkmcnt(0)
    v_mfma_f32_16x16x32_bf16 v[80:83], a[0:3], v[16:19], v[80:83]
    s_add_u32 s55, s88, 7
    s_and_b32 s55, s55, 15
    v_mfma_f32_16x16x32_bf16 v[84:87], a[0:3], v[20:23], v[84:87]
    s_lshl_b32 s55, s55, 14
    s_add_u32 s96, s55, s67
    v_mfma_f32_16x16x32_bf16 v[88:91], a[0:3], v[24:27], v[88:91]
    ds_read_b64_tr_b16 a[24:25], v5 offset:15360
    buffer_load_dwordx4 v[64:67], v7, s[44:47], s96 offen offset:0 sc1
    v_mfma_f32_16x16x32_bf16 v[92:95], a[0:3], v[28:31], v[92:95]
    ds_read_b64_tr_b16 a[26:27], v5 offset:16896
    v_mfma_f32_16x16x32_bf16 v[96:99], a[4:7], v[16:19], v[96:99]
    ds_read_b64_tr_b16 a[28:29], v5 offset:15392
    buffer_load_dwordx4 v[68:71], v7, s[44:47], s96 offen offset:1024 sc1
    v_mfma_f32_16x16x32_bf16 v[100:103], a[4:7], v[20:23], v[100:103]
    ds_read_b64_tr_b16 a[30:31], v5 offset:16928
    v_mfma_f32_16x16x32_bf16 v[104:107], a[4:7], v[24:27], v[104:107]
    ds_read_b64_tr_b16 a[32:33], v5 offset:15424
    buffer_load_dwordx4 v[72:75], v7, s[44:47], s96 offen offset:2048 sc1
    v_mfma_f32_16x16x32_bf16 v[108:111], a[4:7], v[28:31], v[108:111]
    ds_read_b64_tr_b16 a[34:35], v5 offset:16960
    v_mfma_f32_16x16x32_bf16 v[112:115], a[8:11], v[16:19], v[112:115]
    ds_read_b64_tr_b16 a[36:37], v6 offset:15360
    buffer_load_dwordx4 v[76:79], v7, s[44:47], s96 offen offset:3072 sc1
    v_mfma_f32_16x16x32_bf16 v[116:119], a[8:11], v[20:23], v[116:119]
    ds_read_b64_tr_b16 a[38:39], v6 offset:16896
    v_mov_b32 v13, 5
    v_mfma_f32_16x16x32_bf16 v[120:123], a[8:11], v[24:27], v[120:123]
    ds_read_b64_tr_b16 a[40:41], v6 offset:15392
    v_mfma_f32_16x16x32_bf16 v[124:127], a[8:11], v[28:31], v[124:127]
    ds_read_b64_tr_b16 a[42:43], v6 offset:16928
    v_mfma_f32_16x16x32_bf16 v[128:131], a[12:15], v[16:19], v[128:131]
    ds_read_b64_tr_b16 a[44:45], v6 offset:15424
    s_waitcnt vmcnt(8)
    v_max3_u32 v11, v32, v36, v40
    v_mfma_f32_16x16x32_bf16 v[132:135], a[12:15], v[20:23], v[132:135]
    ds_read_b64_tr_b16 a[46:47], v6 offset:16960
    v_max_u32 v11, v11, v44
    v_mfma_f32_16x16x32_bf16 v[136:139], a[12:15], v[24:27], v[136:139]
    v_cmp_eq_u32 vcc, -1, v11
    v_mfma_f32_16x16x32_bf16 v[140:143], a[12:15], v[28:31], v[140:143]
    ds_write_b32 v3, v13 offset:36
    v_mfma_f32_16x16x32_bf16 v[144:147], a[16:19], v[16:19], v[144:147]
    s_cbranch_vccnz L_rxa5
L_oxa5:
    v_swap_b32 v33, v36
    v_mfma_f32_16x16x32_bf16 v[148:151], a[16:19], v[20:23], v[148:151]
    v_swap_b32 v34, v40
    v_mfma_f32_16x16x32_bf16 v[152:155], a[16:19], v[24:27], v[152:155]
    v_swap_b32 v35, v44
    v_mfma_f32_16x16x32_bf16 v[156:159], a[16:19], v[28:31], v[156:159]
    v_swap_b32 v38, v41
    v_mfma_f32_16x16x32_bf16 v[160:163], a[20:23], v[16:19], v[160:163]
    v_swap_b32 v39, v45
    v_mfma_f32_16x16x32_bf16 v[164:167], a[20:23], v[20:23], v[164:167]
    v_swap_b32 v43, v46
    v_mfma_f32_16x16x32_bf16 v[168:171], a[20:23], v[24:27], v[168:171]
    v_mfma_f32_16x16x32_bf16 v[172:175], a[20:23], v[28:31], v[172:175]
    s_waitcnt lgkmcnt(0)
    v_mfma_f32_16x16x32_bf16 v[80:83], a[24:27], v[32:35], v[80:83]
    s_add_u32 s55, s88, 8
    s_and_b32 s55, s55, 15
    v_mfma_f32_16x16x32_bf16 v[84:87], a[24:27], v[36:39], v[84:87]
    s_lshl_b32 s55, s55, 14
    s_add_u32 s96, s55, s67
    v_mfma_f32_16x16x32_bf16 v[88:91], a[24:27], v[40:43], v[88:91]
    ds_read_b64_tr_b16 a[0:1], v5 offset:18432
    buffer_load_dwordx4 v[16:19], v7, s[44:47], s96 offen offset:0 sc1
    v_mfma_f32_16x16x32_bf16 v[92:95], a[24:27], v[44:47], v[92:95]
    ds_read_b64_tr_b16 a[2:3], v5 offset:19968
    v_mfma_f32_16x16x32_bf16 v[96:99], a[28:31], v[32:35], v[96:99]
    ds_read_b64_tr_b16 a[4:5], v5 offset:18464
    buffer_load_dwordx4 v[20:23], v7, s[44:47], s96 offen offset:1024 sc1
    v_mfma_f32_16x16x32_bf16 v[100:103], a[28:31], v[36:39], v[100:103]
    ds_read_b64_tr_b16 a[6:7], v5 offset:20000
    v_mfma_f32_16x16x32_bf16 v[104:107], a[28:31], v[40:43], v[104:107]
    ds_read_b64_tr_b16 a[8:9], v5 offset:18496
    buffer_load_dwordx4 v[24:27], v7, s[44:47], s96 offen offset:2048 sc1
    v_mfma_f32_16x16x32_bf16 v[108:111], a[28:31], v[44:47], v[108:111]
    ds_read_b64_tr_b16 a[10:11], v5 offset:20032
    v_mfma_f32_16x16x32_bf16 v[112:115], a[32:35], v[32:35], v[112:115]
    ds_read_b64_tr_b16 a[12:13], v6 offset:18432
    buffer_load_dwordx4 v[28:31], v7, s[44:47], s96 offen offset:3072 sc1
    v_mfma_f32_16x16x32_bf16 v[116:119], a[32:35], v[36:39], v[116:119]
    ds_read_b64_tr_b16 a[14:15], v6 offset:19968
    v_mov_b32 v13, 6
    v_mfma_f32_16x16x32_bf16 v[120:123], a[32:35], v[40:43], v[120:123]
    ds_read_b64_tr_b16 a[16:17], v6 offset:18464
    v_mfma_f32_16x16x32_bf16 v[124:127], a[32:35], v[44:47], v[124:127]
    ds_read_b64_tr_b16 a[18:19], v6 offset:20000
    v_mfma_f32_16x16x32_bf16 v[128:131], a[36:39], v[32:35], v[128:131]
    ds_read_b64_tr_b16 a[20:21], v6 offset:18496
    s_waitcnt vmcnt(8)
    v_max3_u32 v11, v48, v52, v56
    v_mfma_f32_16x16x32_bf16 v[132:135], a[36:39], v[36:39], v[132:135]
    ds_read_b64_tr_b16 a[22:23], v6 offset:20032
    v_max_u32 v11, v11, v60
    v_mfma_f32_16x16x32_bf16 v[136:139], a[36:39], v[40:43], v[136:139]
    v_cmp_eq_u32 vcc, -1, v11
    v_mfma_f32_16x16x32_bf16 v[140:143], a[36:39], v[44:47], v[140:143]
    ds_write_b32 v3, v13 offset:36
    v_mfma_f32_16x16x32_bf16 v[144:147], a[40:43], v[32:35], v[144:147]
    s_cbranch_vccnz L_rxa6
L_oxa6:
    v_swap_b32 v49, v52
    v_mfma_f32_16x16x32_bf16 v[148:151], a[40:43], v[36:39], v[148:151]
    v_swap_b32 v50, v56
    v_mfma_f32_16x16x32_bf16 v[152:155], a[40:43], v[40:43], v[152:155]
    v_swap_b32 v51, v60
    v_mfma_f32_16x16x32_bf16 v[156:159], a[40:43], v[44:47], v[156:159]
    v_swap_b32 v54, v57
    v_mfma_f32_16x16x32_bf16 v[160:163], a[44:47], v[32:35], v[160:163]
    v_swap_b32 v55, v61
    v_mfma_f32_16x16x32_bf16 v[164:167], a[44:47], v[36:39], v[164:167]
    v_swap_b32 v59, v62
    v_mfma_f32_16x16x32_bf16 v[168:171], a[44:47], v[40:43], v[168:171]
    v_mfma_f32_16x16x32_bf16 v[172:175], a[44:47], v[44:47], v[172:175]
    s_waitcnt lgkmcnt(0)
    v_mfma_f32_16x16x32_bf16 v[80:83], a[0:3], v[48:51], v[80:83]
    s_add_u32 s55, s88, 9
    s_and_b32 s55, s55, 15
    v_mfma_f32_16x16x32_bf16 v[84:87], a[0:3], v[52:55], v[84:87]
    s_lshl_b32 s55, s55, 14
    s_add_u32 s96, s55, s67
    v_mfma_f32_16x16x32_bf16 v[88:91], a[0:3], v[56:59], v[88:91]
    ds_read_b64_tr_b16 a[24:25], v5 offset:21504
    buffer_load_dwordx4 v[32:35], v7, s[44:47], s96 offen offset:0 sc1
    v_mfma_f32_16x16x32_bf16 v[92:95], a[0:3], v[60:63], v[92:95]
    ds_read_b64_tr_b16 a[26:27], v5 offset:23040
    v_mfma_f32_16x16x32_bf16 v[96:99], a[4:7], v[48:51], v[96:99]
    ds_read_b64_tr_b16 a[28:29], v5 offset:21536
    buffer_load_dwordx4 v[36:39], v7, s[44:47], s96 offen offset:1024 sc1
    v_mfma_f32_16x16x32_bf16 v[100:103], a[4:7], v[52:55], v[100:103]
    ds_read_b64_tr_b16 a[30:31], v5 offset:23072
    v_mfma_f32_16x16x32_bf16 v[104:107], a[4:7], v[56:59], v[104:107]
    ds_read_b64_tr_b16 a[32:33], v5 offset:21568
    buffer_load_dwordx4 v[40:43], v7, s[44:47], s96 offen offset:2048 sc1
    v_mfma_f32_16x16x32_bf16 v[108:111], a[4:7], v[60:63], v[108:111]
    ds_read_b64_tr_b16 a[34:35], v5 offset:23104
    v_mfma_f32_16x16x32_bf16 v[112:115], a[8:11], v[48:51], v[112:115]
    ds_read_b64_tr_b16 a[36:37], v6 offset:21504
    buffer_load_dwordx4 v[44:47], v7, s[44:47], s96 offen offset:3072 sc1
    v_mfma_f32_16x16x32_bf16 v[116:119], a[8:11], v[52:55], v[116:119]
    ds_read_b64_tr_b16 a[38:39], v6 offset:23040
    v_mov_b32 v13, 7
    v_mfma_f32_16x16x32_bf16 v[120:123], a[8:11], v[56:59], v[120:123]
    ds_read_b64_tr_b16 a[40:41], v6 offset:21536
    v_mfma_f32_16x16x32_bf16 v[124:127], a[8:11], v[60:63], v[124:127]
    ds_read_b64_tr_b16 a[42:43], v6 offset:23072
    v_mfma_f32_16x16x32_bf16 v[128:131], a[12:15], v[48:51], v[128:131]
    ds_read_b64_tr_b16 a[44:45], v6 offset:21568
    s_waitcnt vmcnt(8)
    v_max3_u32 v11, v64, v68, v72
    v_mfma_f32_16x16x32_bf16 v[132:135], a[12:15], v[52:55], v[132:135]
    ds_read_b64_tr_b16 a[46:47], v6 offset:23104
    v_max_u32 v11, v11, v76
    v_mfma_f32_16x16x32_bf16 v[136:139], a[12:15], v[56:59], v[136:139]
    v_cmp_eq_u32 vcc, -1, v11
    v_mfma_f32_16x16x32_bf16 v[140:143], a[12:15], v[60:63], v[140:143]
    ds_write_b32 v3, v13 offset:36
    v_mfma_f32_16x16x32_bf16 v[144:147], a[16:19], v[48:51], v[144:147]
    s_cbranch_vccnz L_rxa7
L_oxa7:
    v_swap_b32 v65, v68
    v_mfma_f32_16x16x32_bf16 v[148:151], a[16:19], v[52:55], v[148:151]
    v_swap_b32 v66, v72
    v_mfma_f32_16x16x32_bf16 v[152:155], a[16:19], v[56:59], v[152:155]
    v_swap_b32 v67, v76
    v_mfma_f32_16x16x32_bf16 v[156:159], a[16:19], v[60:63], v[156:159]
    v_swap_b32 v70, v73
    v_mfma_f32_16x16x32_bf16 v[160:163], a[20:23], v[48:51], v[160:163]
    v_swap_b32 v71, v77
    v_mfma_f32_16x16x32_bf16 v[164:167], a[20:23], v[52:55], v[164:167]
    v_swap_b32 v75, v78
    v_mfma_f32_16x16x32_bf16 v[168:171], a[20:23], v[56:59], v[168:171]
    v_mfma_f32_16x16x32_bf16 v[172:175], a[20:23], v[60:63], v[172:175]
    s_waitcnt lgkmcnt(0)
    v_mfma_f32_16x16x32_bf16 v[80:83], a[24:27], v[64:67], v[80:83]
    s_add_u32 s55, s88, 10
    s_and_b32 s55, s55, 15
    v_mfma_f32_16x16x32_bf16 v[84:87], a[24:27], v[68:71], v[84:87]
    s_lshl_b32 s55, s55, 14
    s_add_u32 s96, s55, s67
    v_mfma_f32_16x16x32_bf16 v[88:91], a[24:27], v[72:75], v[88:91]
    ds_read_b64_tr_b16 a[0:1], v5 offset:24576
    buffer_load_dwordx4 v[48:51], v7, s[44:47], s96 offen offset:0 sc1
    v_mfma_f32_16x16x32_bf16 v[92:95], a[24:27], v[76:79], v[92:95]
    ds_read_b64_tr_b16 a[2:3], v5 offset:26112
    v_mfma_f32_16x16x32_bf16 v[96:99], a[28:31], v[64:67], v[96:99]
    ds_read_b64_tr_b16 a[4:5], v5 offset:24608
    buffer_load_dwordx4 v[52:55], v7, s[44:47], s96 offen offset:1024 sc1
    v_mfma_f32_16x16x32_bf16 v[100:103], a[28:31], v[68:71], v[100:103]
    ds_read_b64_tr_b16 a[6:7], v5 offset:26144
    v_mfma_f32_16x16x32_bf16 v[104:107], a[28:31], v[72:75], v[104:107]
    ds_read_b64_tr_b16 a[8:9], v5 offset:24640
    buffer_load_dwordx4 v[56:59], v7, s[44:47], s96 offen offset:2048 sc1
    v_mfma_f32_16x16x32_bf16 v[108:111], a[28:31], v[76:79], v[108:111]
    ds_read_b64_tr_b16 a[10:11], v5 offset:26176
    v_mfma_f32_16x16x32_bf16 v[112:115], a[32:35], v[64:67], v[112:115]
    ds_read_b64_tr_b16 a[12:13], v6 offset:24576
    buffer_load_dwordx4 v[60:63], v7, s[44:47], s96 offen offset:3072 sc1
    v_mfma_f32_16x16x32_bf16 v[116:119], a[32:35], v[68:71], v[116:119]
    ds_read_b64_tr_b16 a[14:15], v6 offset:26112
    v_mov_b32 v13, 8
    v_mfma_f32_16x16x32_bf16 v[120:123], a[32:35], v[72:75], v[120:123]
    ds_read_b64_tr_b16 a[16:17], v6 offset:24608
    v_mfma_f32_16x16x32_bf16 v[124:127], a[32:35], v[76:79], v[124:127]
    ds_read_b64_tr_b16 a[18:19], v6 offset:26144
    v_mfma_f32_16x16x32_bf16 v[128:131], a[36:39], v[64:67], v[128:131]
    ds_read_b64_tr_b16 a[20:21], v6 offset:24640
    s_waitcnt vmcnt(8)
    v_max3_u32 v11, v16, v20, v24
    v_mfma_f32_16x16x32_bf16 v[132:135], a[36:39], v[68:71], v[132:135]
    ds_read_b64_tr_b16 a[22:23], v6 offset:26176
    v_max_u32 v11, v11, v28
    v_mfma_f32_16x16x32_bf16 v[136:139], a[36:39], v[72:75], v[136:139]
    v_cmp_eq_u32 vcc, -1, v11
    v_mfma_f32_16x16x32_bf16 v[140:143], a[36:39], v[76:79], v[140:143]
    ds_write_b32 v3, v13 offset:36
    v_mfma_f32_16x16x32_bf16 v[144:147], a[40:43], v[64:67], v[144:147]
    s_cbranch_vccnz L_rxa8
L_oxa8:
    v_swap_b32 v17, v20
    v_mfma_f32_16x16x32_bf16 v[148:151], a[40:43], v[68:71], v[148:151]
    v_swap_b32 v18, v24
    v_mfma_f32_16x16x32_bf16 v[152:155], a[40:43], v[72:75], v[152:155]
    v_swap_b32 v19, v28
    v_mfma_f32_16x16x32_bf16 v[156:159], a[40:43], v[76:79], v[156:159]
    v_swap_b32 v22, v25
    v_mfma_f32_16x16x32_bf16 v[160:163], a[44:47], v[64:67], v[160:163]
    v_swap_b32 v23, v29
    v_mfma_f32_16x16x32_bf16 v[164:167], a[44:47], v[68:71], v[164:167]
    v_swap_b32 v27, v30
    v_mfma_f32_16x16x32_bf16 v[168:171], a[44:47], v[72:75], v[168:171]
    v_mfma_f32_16x16x32_bf16 v[172:175], a[44:47], v[76:79], v[172:175]
    s_waitcnt lgkmcnt(0)
    v_mfma_f32_16x16x32_bf16 v[80:83], a[0:3], v[16:19], v[80:83]
    s_add_u32 s55, s88, 11
    s_and_b32 s55, s55, 15
    v_mfma_f32_16x16x32_bf16 v[84:87], a[0:3], v[20:23], v[84:87]
    s_lshl_b32 s55, s55, 14
    s_add_u32 s96, s55, s67
    v_mfma_f32_16x16x32_bf16 v[88:91], a[0:3], v[24:27], v[88:91]
    ds_read_b64_tr_b16 a[24:25], v5 offset:27648
    buffer_load_dwordx4 v[64:67], v7, s[44:47], s96 offen offset:0 sc1
    v_mfma_f32_16x16x32_bf16 v[92:95], a[0:3], v[28:31], v[92:95]
    ds_read_b64_tr_b16 a[26:27], v5 offset:29184
    v_mfma_f32_16x16x32_bf16 v[96:99], a[4:7], v[16:19], v[96:99]
    ds_read_b64_tr_b16 a[28:29], v5 offset:27680
    buffer_load_dwordx4 v[68:71], v7, s[44:47], s96 offen offset:1024 sc1
    v_mfma_f32_16x16x32_bf16 v[100:103], a[4:7], v[20:23], v[100:103]
    ds_read_b64_tr_b16 a[30:31], v5 offset:29216
    v_mfma_f32_16x16x32_bf16 v[104:107], a[4:7], v[24:27], v[104:107]
    ds_read_b64_tr_b16 a[32:33], v5 offset:27712
    buffer_load_dwordx4 v[72:75], v7, s[44:47], s96 offen offset:2048 sc1
    v_mfma_f32_16x16x32_bf16 v[108:111], a[4:7], v[28:31], v[108:111]
    ds_read_b64_tr_b16 a[34:35], v5 offset:29248
    v_mfma_f32_16x16x32_bf16 v[112:115], a[8:11], v[16:19], v[112:115]
    ds_read_b64_tr_b16 a[36:37], v6 offset:27648
    buffer_load_dwordx4 v[76:79], v7, s[44:47], s96 offen offset:3072 sc1
    v_mfma_f32_16x16x32_bf16 v[116:119], a[8:11], v[20:23], v[116:119]
    ds_read_b64_tr_b16 a[38:39], v6 offset:29184
    v_mov_b32 v13, 9
    v_mfma_f32_16x16x32_bf16 v[120:123], a[8:11], v[24:27], v[120:123]
    ds_read_b64_tr_b16 a[40:41], v6 offset:27680
    v_mfma_f32_16x16x32_bf16 v[124:127], a[8:11], v[28:31], v[124:127]
    ds_read_b64_tr_b16 a[42:43], v6 offset:29216
    v_mfma_f32_16x16x32_bf16 v[128:131], a[12:15], v[16:19], v[128:131]
    ds_read_b64_tr_b16 a[44:45], v6 offset:27712
    s_waitcnt vmcnt(8)
    v_max3_u32 v11, v32, v36, v40
    v_mfma_f32_16x16x32_bf16 v[132:135], a[12:15], v[20:23], v[132:135]
    ds_read_b64_tr_b16 a[46:47], v6 offset:29248
    v_max_u32 v11, v11, v44
    v_mfma_f32_16x16x32_bf16 v[136:139], a[12:15], v[24:27], v[136:139]
    ds_read_b32 v12, v3 offset:0
    v_cmp_eq_u32 vcc, -1, v11
    v_mfma_f32_16x16x32_bf16 v[140:143], a[12:15], v[28:31], v[140:143]
    ds_write_b32 v3, v13 offset:36
    v_mfma_f32_16x16x32_bf16 v[144:147], a[16:19], v[16:19], v[144:147]
    s_cbranch_vccnz L_rxa9
L_oxa9:
    v_swap_b32 v33, v36
    v_mfma_f32_16x16x32_bf16 v[148:151], a[16:19], v[20:23], v[148:151]
    v_swap_b32 v34, v40
    v_mfma_f32_16x16x32_bf16 v[152:155], a[16:19], v[24:27], v[152:155]
    v_swap_b32 v35, v44
    v_mfma_f32_16x16x32_bf16 v[156:159], a[16:19], v[28:31], v[156:159]
    v_swap_b32 v38, v41
    v_mfma_f32_16x16x32_bf16 v[160:163], a[20:23], v[16:19], v[160:163]
    v_swap_b32 v39, v45
    v_mfma_f32_16x16x32_bf16 v[164:167], a[20:23], v[20:23], v[164:167]
    v_swap_b32 v43, v46
    v_mfma_f32_16x16x32_bf16 v[168:171], a[20:23], v[24:27], v[168:171]
    v_mfma_f32_16x16x32_bf16 v[172:175], a[20:23], v[28:31], v[172:175]
    s_waitcnt lgkmcnt(0)
    v_cmp_ne_u32 vcc, 4, v12
    v_mfma_f32_16x16x32_bf16 v[80:83], a[24:27], v[32:35], v[80:83]
    s_add_u32 s55, s88, 12
    s_and_b32 s55, s55, 15
    v_mfma_f32_16x16x32_bf16 v[84:87], a[24:27], v[36:39], v[84:87]
    s_cbranch_vccnz L_rfa9
L_ofa9:
    s_lshl_b32 s55, s55, 14
    s_add_u32 s96, s55, s67
    v_mfma_f32_16x16x32_bf16 v[88:91], a[24:27], v[40:43], v[88:91]
    ds_read_b64_tr_b16 a[0:1], v5 offset:30720
    buffer_load_dwordx4 v[16:19], v7, s[44:47], s96 offen offset:0 sc1
    v_mfma_f32_16x16x32_bf16 v[92:95], a[24:27], v[44:47], v[92:95]
    ds_read_b64_tr_b16 a[2:3], v5 offset:32256
    v_mfma_f32_16x16x32_bf16 v[96:99], a[28:31], v[32:35], v[96:99]
    ds_read_b64_tr_b16 a[4:5], v5 offset:30752
    buffer_load_dwordx4 v[20:23], v7, s[44:47], s96 offen offset:1024 sc1
    v_mfma_f32_16x16x32_bf16 v[100:103], a[28:31], v[36:39], v[100:103]
    ds_read_b64_tr_b16 a[6:7], v5 offset:32288
    v_mfma_f32_16x16x32_bf16 v[104:107], a[28:31], v[40:43], v[104:107]
    ds_read_b64_tr_b16 a[8:9], v5 offset:30784
    buffer_load_dwordx4 v[24:27], v7, s[44:47], s96 offen offset:2048 sc1
    v_mfma_f32_16x16x32_bf16 v[108:111], a[28:31], v[44:47], v[108:111]
    ds_read_b64_tr_b16 a[10:11], v5 offset:32320
    v_mfma_f32_16x16x32_bf16 v[112:115], a[32:35], v[32:35], v[112:115]
    ds_read_b64_tr_b16 a[12:13], v6 offset:30720
    buffer_load_dwordx4 v[28:31], v7, s[44:47], s96 offen offset:3072 sc1
    v_mfma_f32_16x16x32_bf16 v[116:119], a[32:35], v[36:39], v[116:119]
    ds_read_b64_tr_b16 a[14:15], v6 offset:32256
    v_mov_b32 v13, 10
    v_mfma_f32_16x16x32_bf16 v[120:123], a[32:35], v[40:43], v[120:123]
    ds_read_b64_tr_b16 a[16:17], v6 offset:30752
    v_mfma_f32_16x16x32_bf16 v[124:127], a[32:35], v[44:47], v[124:127]
    ds_read_b64_tr_b16 a[18:19], v6 offset:32288
    v_mfma_f32_16x16x32_bf16 v[128:131], a[36:39], v[32:35], v[128:131]
    ds_read_b64_tr_b16 a[20:21], v6 offset:30784
    s_waitcnt vmcnt(8)
    v_max3_u32 v11, v48, v52, v56
    v_mfma_f32_16x16x32_bf16 v[132:135], a[36:39], v[36:39], v[132:135]
    ds_read_b64_tr_b16 a[22:23], v6 offset:32320
    v_max_u32 v11, v11, v60
    v_mfma_f32_16x16x32_bf16 v[136:139], a[36:39], v[40:43], v[136:139]
    v_cmp_eq_u32 vcc, -1, v11
    v_mfma_f32_16x16x32_bf16 v[140:143], a[36:39], v[44:47], v[140:143]
    ds_write_b32 v3, v13 offset:36
    v_mfma_f32_16x16x32_bf16 v[144:147], a[40:43], v[32:35], v[144:147]
    s_cbranch_vccnz L_rxa10
L_oxa10:
    v_swap_b32 v49, v52
    v_mfma_f32_16x16x32_bf16 v[148:151], a[40:43], v[36:39], v[148:151]
    v_swap_b32 v50, v56
    v_mfma_f32_16x16x32_bf16 v[152:155], a[40:43], v[40:43], v[152:155]
    v_swap_b32 v51, v60
    v_mfma_f32_16x16x32_bf16 v[156:159], a[40:43], v[44:47], v[156:159]
    v_swap_b32 v54, v57
    v_mfma_f32_16x16x32_bf16 v[160:163], a[44:47], v[32:35], v[160:163]
    v_swap_b32 v55, v61
    v_mfma_f32_16x16x32_bf16 v[164:167], a[44:47], v[36:39], v[164:167]
    v_swap_b32 v59, v62
    v_mfma_f32_16x16x32_bf16 v[168:171], a[44:47], v[40:43], v[168:171]
    v_mfma_f32_16x16x32_bf16 v[172:175], a[44:47], v[44:47], v[172:175]
    s_waitcnt lgkmcnt(0)
    v_mfma_f32_16x16x32_bf16 v[80:83], a[0:3], v[48:51], v[80:83]
    s_add_u32 s55, s88, 13
    s_and_b32 s55, s55, 15
    v_mfma_f32_16x16x32_bf16 v[84:87], a[0:3], v[52:55], v[84:87]
    s_lshl_b32 s55, s55, 14
    s_add_u32 s96, s55, s67
    v_mfma_f32_16x16x32_bf16 v[88:91], a[0:3], v[56:59], v[88:91]
    ds_read_b64_tr_b16 a[24:25], v5 offset:33792
    buffer_load_dwordx4 v[32:35], v7, s[44:47], s96 offen offset:0 sc1
    v_mfma_f32_16x16x32_bf16 v[92:95], a[0:3], v[60:63], v[92:95]
    ds_read_b64_tr_b16 a[26:27], v5 offset:35328
    v_mfma_f32_16x16x32_bf16 v[96:99], a[4:7], v[48:51], v[96:99]
    ds_read_b64_tr_b16 a[28:29], v5 offset:33824
    buffer_load_dwordx4 v[36:39], v7, s[44:47], s96 offen offset:1024 sc1
    v_mfma_f32_16x16x32_bf16 v[100:103], a[4:7], v[52:55], v[100:103]
    ds_read_b64_tr_b16 a[30:31], v5 offset:35360
    v_mfma_f32_16x16x32_bf16 v[104:107], a[4:7], v[56:59], v[104:107]
    ds_read_b64_tr_b16 a[32:33], v5 offset:33856
    buffer_load_dwordx4 v[40:43], v7, s[44:47], s96 offen offset:2048 sc1
    v_mfma_f32_16x16x32_bf16 v[108:111], a[4:7], v[60:63], v[108:111]
    ds_read_b64_tr_b16 a[34:35], v5 offset:35392
    v_mfma_f32_16x16x32_bf16 v[112:115], a[8:11], v[48:51], v[112:115]
    ds_read_b64_tr_b16 a[36:37], v6 offset:33792
    buffer_load_dwordx4 v[44:47], v7, s[44:47], s96 offen offset:3072 sc1
    v_mfma_f32_16x16x32_bf16 v[116:119], a[8:11], v[52:55], v[116:119]
    ds_read_b64_tr_b16 a[38:39], v6 offset:35328
    v_mov_b32 v13, 11
    v_mfma_f32_16x16x32_bf16 v[120:123], a[8:11], v[56:59], v[120:123]
    ds_read_b64_tr_b16 a[40:41], v6 offset:33824
    v_mfma_f32_16x16x32_bf16 v[124:127], a[8:11], v[60:63], v[124:127]
    ds_read_b64_tr_b16 a[42:43], v6 offset:35360
    v_mfma_f32_16x16x32_bf16 v[128:131], a[12:15], v[48:51], v[128:131]
    ds_read_b64_tr_b16 a[44:45], v6 offset:33856
    s_waitcnt vmcnt(8)
    v_max3_u32 v11, v64, v68, v72
    v_mfma_f32_16x16x32_bf16 v[132:135], a[12:15], v[52:55], v[132:135]
    ds_read_b64_tr_b16 a[46:47], v6 offset:35392
    v_max_u32 v11, v11, v76
    v_mfma_f32_16x16x32_bf16 v[136:139], a[12:15], v[56:59], v[136:139]
    v_cmp_eq_u32 vcc, -1, v11
    v_mfma_f32_16x16x32_bf16 v[140:143], a[12:15], v[60:63], v[140:143]
    ds_write_b32 v3, v13 offset:36
    v_mfma_f32_16x16x32_bf16 v[144:147], a[16:19], v[48:51], v[144:147]
    s_cbranch_vccnz L_rxa11
L_oxa11:
    v_swap_b32 v65, v68
    v_mfma_f32_16x16x32_bf16 v[148:151], a[16:19], v[52:55], v[148:151]
    v_swap_b32 v66, v72
    v_mfma_f32_16x16x32_bf16 v[152:155], a[16:19], v[56:59], v[152:155]
    v_swap_b32 v67, v76
    v_mfma_f32_16x16x32_bf16 v[156:159], a[16:19], v[60:63], v[156:159]
    v_swap_b32 v70, v73
    v_mfma_f32_16x16x32_bf16 v[160:163], a[20:23], v[48:51], v[160:163]
    v_swap_b32 v71, v77
    v_mfma_f32_16x16x32_bf16 v[164:167], a[20:23], v[52:55], v[164:167]
    v_swap_b32 v75, v78
    v_mfma_f32_16x16x32_bf16 v[168:171], a[20:23], v[56:59], v[168:171]
    v_mfma_f32_16x16x32_bf16 v[172:175], a[20:23], v[60:63], v[172:175]
    s_waitcnt lgkmcnt(0)
    v_mfma_f32_16x16x32_bf16 v[80:83], a[24:27], v[64:67], v[80:83]
    s_add_u32 s55, s88, 14
    s_and_b32 s55, s55, 15
    v_mfma_f32_16x16x32_bf16 v[84:87], a[24:27], v[68:71], v[84:87]
    s_lshl_b32 s55, s55, 14
    s_add_u32 s96, s55, s67
    v_mfma_f32_16x16x32_bf16 v[88:91], a[24:27], v[72:75], v[88:91]
    ds_read_b64_tr_b16 a[0:1], v5 offset:36864
    buffer_load_dwordx4 v[48:51], v7, s[44:47], s96 offen offset:0 sc1
    v_mfma_f32_16x16x32_bf16 v[92:95], a[24:27], v[76:79], v[92:95]
    ds_read_b64_tr_b16 a[2:3], v5 offset:38400
    v_mfma_f32_16x16x32_bf16 v[96:99], a[28:31], v[64:67], v[96:99]
    ds_read_b64_tr_b16 a[4:5], v5 offset:36896
    buffer_load_dwordx4 v[52:55], v7, s[44:47], s96 offen offset:1024 sc1
    v_mfma_f32_16x16x32_bf16 v[100:103], a[28:31], v[68:71], v[100:103]
    ds_read_b64_tr_b16 a[6:7], v5 offset:38432
    v_mfma_f32_16x16x32_bf16 v[104:107], a[28:31], v[72:75], v[104:107]
    ds_read_b64_tr_b16 a[8:9], v5 offset:36928
    buffer_load_dwordx4 v[56:59], v7, s[44:47], s96 offen offset:2048 sc1
    v_mfma_f32_16x16x32_bf16 v[108:111], a[28:31], v[76:79], v[108:111]
    ds_read_b64_tr_b16 a[10:11], v5 offset:38464
    v_mfma_f32_16x16x32_bf16 v[112:115], a[32:35], v[64:67], v[112:115]
    ds_read_b64_tr_b16 a[12:13], v6 offset:36864
    buffer_load_dwordx4 v[60:63], v7, s[44:47], s96 offen offset:3072 sc1
    v_mfma_f32_16x16x32_bf16 v[116:119], a[32:35], v[68:71], v[116:119]
    ds_read_b64_tr_b16 a[14:15], v6 offset:38400
    v_mov_b32 v13, 12
    v_mfma_f32_16x16x32_bf16 v[120:123], a[32:35], v[72:75], v[120:123]
    ds_read_b64_tr_b16 a[16:17], v6 offset:36896
    v_mfma_f32_16x16x32_bf16 v[124:127], a[32:35], v[76:79], v[124:127]
    ds_read_b64_tr_b16 a[18:19], v6 offset:38432
    v_mfma_f32_16x16x32_bf16 v[128:131], a[36:39], v[64:67], v[128:131]
    ds_read_b64_tr_b16 a[20:21], v6 offset:36928
    s_waitcnt vmcnt(8)
    v_max3_u32 v11, v16, v20, v24
    v_mfma_f32_16x16x32_bf16 v[132:135], a[36:39], v[68:71], v[132:135]
    ds_read_b64_tr_b16 a[22:23], v6 offset:38464
    v_max_u32 v11, v11, v28
    v_mfma_f32_16x16x32_bf16 v[136:139], a[36:39], v[72:75], v[136:139]
    v_cmp_eq_u32 vcc, -1, v11
    v_mfma_f32_16x16x32_bf16 v[140:143], a[36:39], v[76:79], v[140:143]
    ds_write_b32 v3, v13 offset:36
    v_mfma_f32_16x16x32_bf16 v[144:147], a[40:43], v[64:67], v[144:147]
    s_cbranch_vccnz L_rxa12
L_oxa12:
    v_swap_b32 v17, v20
    v_mfma_f32_16x16x32_bf16 v[148:151], a[40:43], v[68:71], v[148:151]
    v_swap_b32 v18, v24
    v_mfma_f32_16x16x32_bf16 v[152:155], a[40:43], v[72:75], v[152:155]
    v_swap_b32 v19, v28
    v_mfma_f32_16x16x32_bf16 v[156:159], a[40:43], v[76:79], v[156:159]
    v_swap_b32 v22, v25
    v_mfma_f32_16x16x32_bf16 v[160:163], a[44:47], v[64:67], v[160:163]
    v_swap_b32 v23, v29
    v_mfma_f32_16x16x32_bf16 v[164:167], a[44:47], v[68:71], v[164:167]
    v_swap_b32 v27, v30
    v_mfma_f32_16x16x32_bf16 v[168:171], a[44:47], v[72:75], v[168:171]
    v_mfma_f32_16x16x32_bf16 v[172:175], a[44:47], v[76:79], v[172:175]
    s_waitcnt lgkmcnt(0)
    v_mfma_f32_16x16x32_bf16 v[80:83], a[0:3], v[16:19], v[80:83]
    s_add_u32 s55, s88, 15
    s_and_b32 s55, s55, 15
    v_mfma_f32_16x16x32_bf16 v[84:87], a[0:3], v[20:23], v[84:87]
    s_lshl_b32 s55, s55, 14
    s_add_u32 s96, s55, s67
    v_mfma_f32_16x16x32_bf16 v[88:91], a[0:3], v[24:27], v[88:91]
    ds_read_b64_tr_b16 a[24:25], v5 offset:39936
    buffer_load_dwordx4 v[64:67], v7, s[44:47], s96 offen offset:0 sc1
    v_mfma_f32_16x16x32_bf16 v[92:95], a[0:3], v[28:31], v[92:95]
    ds_read_b64_tr_b16 a[26:27], v5 offset:41472
    v_mfma_f32_16x16x32_bf16 v[96:99], a[4:7], v[16:19], v[96:99]
    ds_read_b64_tr_b16 a[28:29], v5 offset:39968
    buffer_load_dwordx4 v[68:71], v7, s[44:47], s96 offen offset:1024 sc1
    v_mfma_f32_16x16x32_bf16 v[100:103], a[4:7], v[20:23], v[100:103]
    ds_read_b64_tr_b16 a[30:31], v5 offset:41504
    v_mfma_f32_16x16x32_bf16 v[104:107], a[4:7], v[24:27], v[104:107]
    ds_read_b64_tr_b16 a[32:33], v5 offset:40000
    buffer_load_dwordx4 v[72:75], v7, s[44:47], s96 offen offset:2048 sc1
    v_mfma_f32_16x16x32_bf16 v[108:111], a[4:7], v[28:31], v[108:111]
    ds_read_b64_tr_b16 a[34:35], v5 offset:41536
    v_mfma_f32_16x16x32_bf16 v[112:115], a[8:11], v[16:19], v[112:115]
    ds_read_b64_tr_b16 a[36:37], v6 offset:39936
    buffer_load_dwordx4 v[76:79], v7, s[44:47], s96 offen offset:3072 sc1
    v_mfma_f32_16x16x32_bf16 v[116:119], a[8:11], v[20:23], v[116:119]
    ds_read_b64_tr_b16 a[38:39], v6 offset:41472
    v_mov_b32 v13, 13
    v_mfma_f32_16x16x32_bf16 v[120:123], a[8:11], v[24:27], v[120:123]
    ds_read_b64_tr_b16 a[40:41], v6 offset:39968
    v_mfma_f32_16x16x32_bf16 v[124:127], a[8:11], v[28:31], v[124:127]
    ds_read_b64_tr_b16 a[42:43], v6 offset:41504
    v_mfma_f32_16x16x32_bf16 v[128:131], a[12:15], v[16:19], v[128:131]
    ds_read_b64_tr_b16 a[44:45], v6 offset:40000
    s_waitcnt vmcnt(8)
    v_max3_u32 v11, v32, v36, v40
    v_mfma_f32_16x16x32_bf16 v[132:135], a[12:15], v[20:23], v[132:135]
    ds_read_b64_tr_b16 a[46:47], v6 offset:41536
    v_max_u32 v11, v11, v44
    v_mfma_f32_16x16x32_bf16 v[136:139], a[12:15], v[24:27], v[136:139]
    v_cmp_eq_u32 vcc, -1, v11
    v_mfma_f32_16x16x32_bf16 v[140:143], a[12:15], v[28:31], v[140:143]
    ds_write_b32 v3, v13 offset:36
    v_mfma_f32_16x16x32_bf16 v[144:147], a[16:19], v[16:19], v[144:147]
    s_cbranch_vccnz L_rxa13
L_oxa13:
    v_swap_b32 v33, v36
    v_mfma_f32_16x16x32_bf16 v[148:151], a[16:19], v[20:23], v[148:151]
    v_swap_b32 v34, v40
    v_mfma_f32_16x16x32_bf16 v[152:155], a[16:19], v[24:27], v[152:155]
    v_swap_b32 v35, v44
    v_mfma_f32_16x16x32_bf16 v[156:159], a[16:19], v[28:31], v[156:159]
    v_swap_b32 v38, v41
    v_mfma_f32_16x16x32_bf16 v[160:163], a[20:23], v[16:19], v[160:163]
    v_swap_b32 v39, v45
    v_mfma_f32_16x16x32_bf16 v[164:167], a[20:23], v[20:23], v[164:167]
    v_swap_b32 v43, v46
    v_mfma_f32_16x16x32_bf16 v[168:171], a[20:23], v[24:27], v[168:171]
    v_mfma_f32_16x16x32_bf16 v[172:175], a[20:23], v[28:31], v[172:175]
    s_waitcnt lgkmcnt(0)
    v_mfma_f32_16x16x32_bf16 v[80:83], a[24:27], v[32:35], v[80:83]
    v_mfma_f32_16x16x32_bf16 v[84:87], a[24:27], v[36:39], v[84:87]
    v_mfma_f32_16x16x32_bf16 v[88:91], a[24:27], v[40:43], v[88:91]
    ds_read_b64_tr_b16 a[0:1], v5 offset:43008
    v_mfma_f32_16x16x32_bf16 v[92:95], a[24:27], v[44:47], v[92:95]
    ds_read_b64_tr_b16 a[2:3], v5 offset:44544
    v_mfma_f32_16x16x32_bf16 v[96:99], a[28:31], v[32:35], v[96:99]
    ds_read_b64_tr_b16 a[4:5], v5 offset:43040
    v_mfma_f32_16x16x32_bf16 v[100:103], a[28:31], v[36:39], v[100:103]
    ds_read_b64_tr_b16 a[6:7], v5 offset:44576
    v_mfma_f32_16x16x32_bf16 v[104:107], a[28:31], v[40:43], v[104:107]
    ds_read_b64_tr_b16 a[8:9], v5 offset:43072
    v_mfma_f32_16x16x32_bf16 v[108:111], a[28:31], v[44:47], v[108:111]
    ds_read_b64_tr_b16 a[10:11], v5 offset:44608
    v_mfma_f32_16x16x32_bf16 v[112:115], a[32:35], v[32:35], v[112:115]
    ds_read_b64_tr_b16 a[12:13], v6 offset:43008
    v_mfma_f32_16x16x32_bf16 v[116:119], a[32:35], v[36:39], v[116:119]
    ds_read_b64_tr_b16 a[14:15], v6 offset:44544
    v_mfma_f32_16x16x32_bf16 v[120:123], a[32:35], v[40:43], v[120:123]
    ds_read_b64_tr_b16 a[16:17], v6 offset:43040
    v_mfma_f32_16x16x32_bf16 v[124:127], a[32:35], v[44:47], v[124:127]
    ds_read_b64_tr_b16 a[18:19], v6 offset:44576
    v_mfma_f32_16x16x32_bf16 v[128:131], a[36:39], v[32:35], v[128:131]
    ds_read_b64_tr_b16 a[20:21], v6 offset:43072
    s_waitcnt vmcnt(4)
    v_max3_u32 v11, v48, v52, v56
    v_mfma_f32_16x16x32_bf16 v[132:135], a[36:39], v[36:39], v[132:135]
    ds_read_b64_tr_b16 a[22:23], v6 offset:44608
    v_max_u32 v11, v11, v60
    v_mfma_f32_16x16x32_bf16 v[136:139], a[36:39], v[40:43], v[136:139]
    v_cmp_eq_u32 vcc, -1, v11
    v_mfma_f32_16x16x32_bf16 v[140:143], a[36:39], v[44:47], v[140:143]
    v_mfma_f32_16x16x32_bf16 v[144:147], a[40:43], v[32:35], v[144:147]
    s_cbranch_vccnz L_rxa14
L_oxa14:
    v_swap_b32 v49, v52
    v_mfma_f32_16x16x32_bf16 v[148:151], a[40:43], v[36:39], v[148:151]
    v_swap_b32 v50, v56
    v_mfma_f32_16x16x32_bf16 v[152:155], a[40:43], v[40:43], v[152:155]
    v_swap_b32 v51, v60
    v_mfma_f32_16x16x32_bf16 v[156:159], a[40:43], v[44:47], v[156:159]
    v_swap_b32 v54, v57
    v_mfma_f32_16x16x32_bf16 v[160:163], a[44:47], v[32:35], v[160:163]
    v_swap_b32 v55, v61
    v_mfma_f32_16x16x32_bf16 v[164:167], a[44:47], v[36:39], v[164:167]
    v_swap_b32 v59, v62
    v_mfma_f32_16x16x32_bf16 v[168:171], a[44:47], v[40:43], v[168:171]
    v_mfma_f32_16x16x32_bf16 v[172:175], a[44:47], v[44:47], v[172:175]
    s_waitcnt lgkmcnt(0)
    v_mfma_f32_16x16x32_bf16 v[80:83], a[0:3], v[48:51], v[80:83]
    v_mfma_f32_16x16x32_bf16 v[84:87], a[0:3], v[52:55], v[84:87]
    v_mfma_f32_16x16x32_bf16 v[88:91], a[0:3], v[56:59], v[88:91]
    ds_read_b64_tr_b16 a[24:25], v5 offset:46080
    v_mfma_f32_16x16x32_bf16 v[92:95], a[0:3], v[60:63], v[92:95]
    ds_read_b64_tr_b16 a[26:27], v5 offset:47616
    v_mfma_f32_16x16x32_bf16 v[96:99], a[4:7], v[48:51], v[96:99]
    ds_read_b64_tr_b16 a[28:29], v5 offset:46112
    v_mfma_f32_16x16x32_bf16 v[100:103], a[4:7], v[52:55], v[100:103]
    ds_read_b64_tr_b16 a[30:31], v5 offset:47648
    v_mfma_f32_16x16x32_bf16 v[104:107], a[4:7], v[56:59], v[104:107]
    ds_read_b64_tr_b16 a[32:33], v5 offset:46144
    v_mfma_f32_16x16x32_bf16 v[108:111], a[4:7], v[60:63], v[108:111]
    ds_read_b64_tr_b16 a[34:35], v5 offset:47680
    v_mfma_f32_16x16x32_bf16 v[112:115], a[8:11], v[48:51], v[112:115]
    ds_read_b64_tr_b16 a[36:37], v6 offset:46080
    v_mfma_f32_16x16x32_bf16 v[116:119], a[8:11], v[52:55], v[116:119]
    ds_read_b64_tr_b16 a[38:39], v6 offset:47616
    v_mfma_f32_16x16x32_bf16 v[120:123], a[8:11], v[56:59], v[120:123]
    ds_read_b64_tr_b16 a[40:41], v6 offset:46112
    v_mfma_f32_16x16x32_bf16 v[124:127], a[8:11], v[60:63], v[124:127]
    ds_read_b64_tr_b16 a[42:43], v6 offset:47648
    v_mfma_f32_16x16x32_bf16 v[128:131], a[12:15], v[48:51], v[128:131]
    ds_read_b64_tr_b16 a[44:45], v6 offset:46144
    s_waitcnt vmcnt(0)
    v_max3_u32 v11, v64, v68, v72
    v_mfma_f32_16x16x32_bf16 v[132:135], a[12:15], v[52:55], v[132:135]
    ds_read_b64_tr_b16 a[46:47], v6 offset:47680
    v_max_u32 v11, v11, v76
    v_mfma_f32_16x16x32_bf16 v[136:139], a[12:15], v[56:59], v[136:139]
    ds_read_b32 v12, v3 offset:4
    v_cmp_eq_u32 vcc, -1, v11
    v_mfma_f32_16x16x32_bf16 v[140:143], a[12:15], v[60:63], v[140:143]
    v_mfma_f32_16x16x32_bf16 v[144:147], a[16:19], v[48:51], v[144:147]
    s_cbranch_vccnz L_rxa15
L_oxa15:
    v_swap_b32 v65, v68
    v_mfma_f32_16x16x32_bf16 v[148:151], a[16:19], v[52:55], v[148:151]
    v_swap_b32 v66, v72
    v_mfma_f32_16x16x32_bf16 v[152:155], a[16:19], v[56:59], v[152:155]
    v_swap_b32 v67, v76
    v_mfma_f32_16x16x32_bf16 v[156:159], a[16:19], v[60:63], v[156:159]
    v_swap_b32 v70, v73
    v_mfma_f32_16x16x32_bf16 v[160:163], a[20:23], v[48:51], v[160:163]
    v_swap_b32 v71, v77
    v_mfma_f32_16x16x32_bf16 v[164:167], a[20:23], v[52:55], v[164:167]
    v_swap_b32 v75, v78
    v_mfma_f32_16x16x32_bf16 v[168:171], a[20:23], v[56:59], v[168:171]
    v_mfma_f32_16x16x32_bf16 v[172:175], a[20:23], v[60:63], v[172:175]
    s_waitcnt lgkmcnt(0)
    v_cmp_ne_u32 vcc, 4, v12
    v_mfma_f32_16x16x32_bf16 v[112:115], a[32:35], v[64:67], v[112:115]
    v_mfma_f32_16x16x32_bf16 v[116:119], a[32:35], v[68:71], v[116:119]
    s_cbranch_vccnz L_rfa15
L_ofa15:
    v_mfma_f32_16x16x32_bf16 v[120:123], a[32:35], v[72:75], v[120:123]
    ds_read_b128 v[40:43], v8 offset:0
    v_mfma_f32_16x16x32_bf16 v[124:127], a[32:35], v[76:79], v[124:127]
    ds_read_b128 v[44:47], v8 offset:64
    v_mfma_f32_16x16x32_bf16 v[80:83], a[24:27], v[64:67], v[80:83]
    ds_read_b128 v[48:51], v8 offset:128
    v_mfma_f32_16x16x32_bf16 v[84:87], a[24:27], v[68:71], v[84:87]
    ds_read_b128 v[52:55], v8 offset:192
    v_mfma_f32_16x16x32_bf16 v[88:91], a[24:27], v[72:75], v[88:91]
    ds_read_b128 v[56:59], v8 offset:256
    v_mfma_f32_16x16x32_bf16 v[92:95], a[24:27], v[76:79], v[92:95]
    ds_read_b128 v[60:63], v8 offset:320
    v_mfma_f32_16x16x32_bf16 v[128:131], a[36:39], v[64:67], v[128:131]
    ds_bpermute_b32 v32, v10, v112
    v_mfma_f32_16x16x32_bf16 v[132:135], a[36:39], v[68:71], v[132:135]
    ds_bpermute_b32 v34, v10, v116
    v_mfma_f32_16x16x32_bf16 v[136:139], a[36:39], v[72:75], v[136:139]
    ds_bpermute_b32 v36, v10, v120
    v_mfma_f32_16x16x32_bf16 v[140:143], a[36:39], v[76:79], v[140:143]
    ds_bpermute_b32 v38, v10, v124
    v_mfma_f32_16x16x32_bf16 v[96:99], a[28:31], v[64:67], v[96:99]
    v_mfma_f32_16x16x32_bf16 v[100:103], a[28:31], v[68:71], v[100:103]
    v_mfma_f32_16x16x32_bf16 v[104:107], a[28:31], v[72:75], v[104:107]
    s_mov_b32 s57, 0xbb000000
    s_waitcnt lgkmcnt(0)
    v_mul_f32 v32, s57, v32
    v_mul_f32 v34, s57, v34
    v_mfma_f32_16x16x32_bf16 v[108:111], a[28:31], v[76:79], v[108:111]
    v_mul_f32 v36, s57, v36
    v_mul_f32 v38, s57, v38
    v_mfma_f32_16x16x32_bf16 v[144:147], a[40:43], v[64:67], v[144:147]
    v_pk_fma_f32 v[80:81], v[40:41], v[32:33], v[80:81] op_sel_hi:[1,0,1]
    v_pk_fma_f32 v[82:83], v[42:43], v[32:33], v[82:83] op_sel_hi:[1,0,1]
    v_mfma_f32_16x16x32_bf16 v[148:151], a[40:43], v[68:71], v[148:151]
    v_pk_fma_f32 v[128:129], v[52:53], v[32:33], v[128:129] op_sel_hi:[1,0,1]
    v_pk_fma_f32 v[130:131], v[54:55], v[32:33], v[130:131] op_sel_hi:[1,0,1]
    v_mfma_f32_16x16x32_bf16 v[152:155], a[40:43], v[72:75], v[152:155]
    v_max_f32 v80, 0, v80
    v_max_f32 v81, 0, v81
    v_mfma_f32_16x16x32_bf16 v[156:159], a[40:43], v[76:79], v[156:159]
    v_max_f32 v82, 0, v82
    v_max_f32 v83, 0, v83
    v_mfma_f32_16x16x32_bf16 v[160:163], a[44:47], v[64:67], v[160:163]
    v_pk_mul_f32 v[80:81], v[80:81], v[128:129]
    v_pk_mul_f32 v[82:83], v[82:83], v[130:131]
    v_mfma_f32_16x16x32_bf16 v[164:167], a[44:47], v[68:71], v[164:167]
    v_cvt_pk_bf16_f32 v16, v80, v81
    v_cvt_pk_bf16_f32 v17, v82, v83
    v_mfma_f32_16x16x32_bf16 v[168:171], a[44:47], v[72:75], v[168:171]
    v_pk_fma_f32 v[84:85], v[40:41], v[34:35], v[84:85] op_sel_hi:[1,0,1]
    v_pk_fma_f32 v[86:87], v[42:43], v[34:35], v[86:87] op_sel_hi:[1,0,1]
    v_mfma_f32_16x16x32_bf16 v[172:175], a[44:47], v[76:79], v[172:175]
    v_pk_fma_f32 v[132:133], v[52:53], v[34:35], v[132:133] op_sel_hi:[1,0,1]
    v_pk_fma_f32 v[134:135], v[54:55], v[34:35], v[134:135] op_sel_hi:[1,0,1]
L_p2join:
    v_max_f32 v84, 0, v84
    v_max_f32 v85, 0, v85
    v_max_f32 v86, 0, v86
    v_max_f32 v87, 0, v87
    v_pk_mul_f32 v[84:85], v[84:85], v[132:133]
    v_pk_mul_f32 v[86:87], v[86:87], v[134:135]
    v_cvt_pk_bf16_f32 v18, v84, v85
    v_cvt_pk_bf16_f32 v19, v86, v87
    buffer_store_dwordx4 v[16:19], v176, s[44:47], s89 offen offset:0 sc0 sc1
    v_pk_fma_f32 v[88:89], v[40:41], v[36:37], v[88:89] op_sel_hi:[1,0,1]
    v_pk_fma_f32 v[90:91], v[42:43], v[36:37], v[90:91] op_sel_hi:[1,0,1]
    v_pk_fma_f32 v[136:137], v[52:53], v[36:37], v[136:137] op_sel_hi:[1,0,1]
    v_pk_fma_f32 v[138:139], v[54:55], v[36:37], v[138:139] op_sel_hi:[1,0,1]
    v_max_f32 v88, 0, v88
    v_max_f32 v89, 0, v89
    v_max_f32 v90, 0, v90
    v_max_f32 v91, 0, v91
    v_pk_mul_f32 v[88:89], v[88:89], v[136:137]
    v_pk_mul_f32 v[90:91], v[90:91], v[138:139]
    v_cvt_pk_bf16_f32 v20, v88, v89
    v_cvt_pk_bf16_f32 v21, v90, v91
    v_pk_fma_f32 v[92:93], v[40:41], v[38:39], v[92:93] op_sel_hi:[1,0,1]
    v_pk_fma_f32 v[94:95], v[42:43], v[38:39], v[94:95] op_sel_hi:[1,0,1]
    v_pk_fma_f32 v[140:141], v[52:53], v[38:39], v[140:141] op_sel_hi:[1,0,1]
    v_pk_fma_f32 v[142:143], v[54:55], v[38:39], v[142:143] op_sel_hi:[1,0,1]
    v_max_f32 v92, 0, v92
    v_max_f32 v93, 0, v93
    v_max_f32 v94, 0, v94
    v_max_f32 v95, 0, v95
    v_pk_mul_f32 v[92:93], v[92:93], v[140:141]
    v_pk_mul_f32 v[94:95], v[94:95], v[142:143]
    v_cvt_pk_bf16_f32 v22, v92, v93
    v_cvt_pk_bf16_f32 v23, v94, v95
    buffer_store_dwordx4 v[20:23], v176, s[44:47], s90 offen offset:0 sc0 sc1
    v_pk_fma_f32 v[96:97], v[44:45], v[32:33], v[96:97] op_sel_hi:[1,0,1]
    v_pk_fma_f32 v[98:99], v[46:47], v[32:33], v[98:99] op_sel_hi:[1,0,1]
    v_pk_fma_f32 v[144:145], v[56:57], v[32:33], v[144:145] op_sel_hi:[1,0,1]
    v_pk_fma_f32 v[146:147], v[58:59], v[32:33], v[146:147] op_sel_hi:[1,0,1]
    v_max_f32 v96, 0, v96
    v_max_f32 v97, 0, v97
    v_max_f32 v98, 0, v98
    v_max_f32 v99, 0, v99
    v_pk_mul_f32 v[96:97], v[96:97], v[144:145]
    v_pk_mul_f32 v[98:99], v[98:99], v[146:147]
    v_cvt_pk_bf16_f32 v24, v96, v97
    v_cvt_pk_bf16_f32 v25, v98, v99
    v_pk_fma_f32 v[100:101], v[44:45], v[34:35], v[100:101] op_sel_hi:[1,0,1]
    v_pk_fma_f32 v[102:103], v[46:47], v[34:35], v[102:103] op_sel_hi:[1,0,1]
    v_pk_fma_f32 v[148:149], v[56:57], v[34:35], v[148:149] op_sel_hi:[1,0,1]
    v_pk_fma_f32 v[150:151], v[58:59], v[34:35], v[150:151] op_sel_hi:[1,0,1]
    v_max_f32 v100, 0, v100
    v_max_f32 v101, 0, v101
    v_max_f32 v102, 0, v102
    v_max_f32 v103, 0, v103
    v_pk_mul_f32 v[100:101], v[100:101], v[148:149]
    v_pk_mul_f32 v[102:103], v[102:103], v[150:151]
    v_cvt_pk_bf16_f32 v26, v100, v101
    v_cvt_pk_bf16_f32 v27, v102, v103
    buffer_store_dwordx4 v[24:27], v177, s[44:47], s89 offen offset:1024 sc0 sc1
    v_pk_fma_f32 v[104:105], v[44:45], v[36:37], v[104:105] op_sel_hi:[1,0,1]
    v_pk_fma_f32 v[106:107], v[46:47], v[36:37], v[106:107] op_sel_hi:[1,0,1]
    v_pk_fma_f32 v[152:153], v[56:57], v[36:37], v[152:153] op_sel_hi:[1,0,1]
    v_pk_fma_f32 v[154:155], v[58:59], v[36:37], v[154:155] op_sel_hi:[1,0,1]
    v_max_f32 v104, 0, v104
    v_max_f32 v105, 0, v105
    v_max_f32 v106, 0, v106
    v_max_f32 v107, 0, v107
    v_pk_mul_f32 v[104:105], v[104:105], v[152:153]
    v_pk_mul_f32 v[106:107], v[106:107], v[154:155]
    v_cvt_pk_bf16_f32 v28, v104, v105
    v_cvt_pk_bf16_f32 v29, v106, v107
    v_pk_fma_f32 v[108:109], v[44:45], v[38:39], v[108:109] op_sel_hi:[1,0,1]
    v_pk_fma_f32 v[110:111], v[46:47], v[38:39], v[110:111] op_sel_hi:[1,0,1]
    v_pk_fma_f32 v[156:157], v[56:57], v[38:39], v[156:157] op_sel_hi:[1,0,1]
    v_pk_fma_f32 v[158:159], v[58:59], v[38:39], v[158:159] op_sel_hi:[1,0,1]
    v_max_f32 v108, 0, v108
    v_max_f32 v109, 0, v109
    v_max_f32 v110, 0, v110
    v_max_f32 v111, 0, v111
    v_pk_mul_f32 v[108:109], v[108:109], v[156:157]
    v_pk_mul_f32 v[110:111], v[110:111], v[158:159]
    v_cvt_pk_bf16_f32 v30, v108, v109
    v_cvt_pk_bf16_f32 v31, v110, v111
    buffer_store_dwordx4 v[28:31], v177, s[44:47], s90 offen offset:1024 sc0 sc1
    v_pk_fma_f32 v[112:113], v[48:49], v[32:33], v[112:113] op_sel_hi:[1,0,1]
    v_pk_fma_f32 v[114:115], v[50:51], v[32:33], v[114:115] op_sel_hi:[1,0,1]
    v_pk_fma_f32 v[160:161], v[60:61], v[32:33], v[160:161] op_sel_hi:[1,0,1]
    v_pk_fma_f32 v[162:163], v[62:63], v[32:33], v[162:163] op_sel_hi:[1,0,1]
    v_max_f32 v112, 0, v112
    v_max_f32 v113, 0, v113
    v_max_f32 v114, 0, v114
    v_max_f32 v115, 0, v115
    v_pk_mul_f32 v[112:113], v[112:113], v[160:161]
    v_pk_mul_f32 v[114:115], v[114:115], v[162:163]
    v_cvt_pk_bf16_f32 v64, v112, v113
    v_cvt_pk_bf16_f32 v65, v114, v115
    v_pk_fma_f32 v[116:117], v[48:49], v[34:35], v[116:117] op_sel_hi:[1,0,1]
    v_pk_fma_f32 v[118:119], v[50:51], v[34:35], v[118:119] op_sel_hi:[1,0,1]
    v_pk_fma_f32 v[164:165], v[60:61], v[34:35], v[164:165] op_sel_hi:[1,0,1]
    v_pk_fma_f32 v[166:167], v[62:63], v[34:35], v[166:167] op_sel_hi:[1,0,1]
    v_max_f32 v116, 0, v116
    v_max_f32 v117, 0, v117
    v_max_f32 v118, 0, v118
    v_max_f32 v119, 0, v119
    v_pk_mul_f32 v[116:117], v[116:117], v[164:165]
    v_pk_mul_f32 v[118:119], v[118:119], v[166:167]
    v_cvt_pk_bf16_f32 v66, v116, v117
    v_cvt_pk_bf16_f32 v67, v118, v119
    buffer_store_dwordx4 v[64:67], v178, s[44:47], s89 offen offset:2048 sc0 sc1
    v_pk_fma_f32 v[120:121], v[48:49], v[36:37], v[120:121] op_sel_hi:[1,0,1]
    v_pk_fma_f32 v[122:123], v[50:51], v[36:37], v[122:123] op_sel_hi:[1,0,1]
    v_pk_fma_f32 v[168:169], v[60:61], v[36:37], v[168:169] op_sel_hi:[1,0,1]
    v_pk_fma_f32 v[170:171], v[62:63], v[36:37], v[170:171] op_sel_hi:[1,0,1]
    v_max_f32 v120, 0, v120
    v_max_f32 v121, 0, v121
    v_max_f32 v122, 0, v122
    v_max_f32 v123, 0, v123
    v_pk_mul_f32 v[120:121], v[120:121], v[168:169]
    v_pk_mul_f32 v[122:123], v[122:123], v[170:171]
    v_cvt_pk_bf16_f32 v68, v120, v121
    v_cvt_pk_bf16_f32 v69, v122, v123
    v_pk_fma_f32 v[124:125], v[48:49], v[38:39], v[124:125] op_sel_hi:[1,0,1]
    v_pk_fma_f32 v[126:127], v[50:51], v[38:39], v[126:127] op_sel_hi:[1,0,1]
    v_pk_fma_f32 v[172:173], v[60:61], v[38:39], v[172:173] op_sel_hi:[1,0,1]
    v_pk_fma_f32 v[174:175], v[62:63], v[38:39], v[174:175] op_sel_hi:[1,0,1]
    v_max_f32 v124, 0, v124
    v_max_f32 v125, 0, v125
    v_max_f32 v126, 0, v126
    v_max_f32 v127, 0, v127
    v_pk_mul_f32 v[124:125], v[124:125], v[172:173]
    v_pk_mul_f32 v[126:127], v[126:127], v[174:175]
    v_cvt_pk_bf16_f32 v70, v124, v125
    v_cvt_pk_bf16_f32 v71, v126, v127
    buffer_store_dwordx4 v[68:71], v178, s[44:47], s90 offen offset:2048 sc0 sc1
    s_barrier
    s_endpgm
L_p2alt:
    s_waitcnt lgkmcnt(0)
    v_mfma_f32_16x16x32_bf16 v[80:83], a[0:3], v[16:19], 0
    s_add_u32 s55, s88, 3
    s_and_b32 s55, s55, 15
    v_mfma_f32_16x16x32_bf16 v[84:87], a[0:3], v[20:23], 0
    s_lshl_b32 s55, s55, 14
    s_add_u32 s96, s55, s67
    v_mfma_f32_16x16x32_bf16 v[88:91], a[0:3], v[24:27], 0
    ds_read_b64_tr_b16 a[24:25], v5 offset:3072
    buffer_load_dwordx4 v[64:67], v7, s[44:47], s96 offen offset:0 sc1
    v_mfma_f32_16x16x32_bf16 v[92:95], a[0:3], v[28:31], 0
    ds_read_b64_tr_b16 a[26:27], v5 offset:4608
    v_mfma_f32_16x16x32_bf16 v[96:99], a[4:7], v[16:19], 0
    ds_read_b64_tr_b16 a[28:29], v5 offset:3104
    buffer_load_dwordx4 v[68:71], v7, s[44:47], s96 offen offset:1024 sc1
    v_mfma_f32_16x16x32_bf16 v[100:103], a[4:7], v[20:23], 0
    ds_read_b64_tr_b16 a[30:31], v5 offset:4640
    v_mfma_f32_16x16x32_bf16 v[104:107], a[4:7], v[24:27], 0
    ds_read_b64_tr_b16 a[32:33], v5 offset:3136
    buffer_load_dwordx4 v[72:75], v7, s[44:47], s96 offen offset:2048 sc1
    v_mfma_f32_16x16x32_bf16 v[108:111], a[4:7], v[28:31], 0
    ds_read_b64_tr_b16 a[34:35], v5 offset:4672
    v_mfma_f32_16x16x32_bf16 v[112:115], a[8:11], v[16:19], 0
    ds_read_b64_tr_b16 a[36:37], v6 offset:3072
    buffer_load_dwordx4 v[76:79], v7, s[44:47], s96 offen offset:3072 sc1
    v_mfma_f32_16x16x32_bf16 v[116:119], a[8:11], v[20:23], 0
    ds_read_b64_tr_b16 a[38:39], v6 offset:4608
    v_mov_b32 v13, 1
    v_mfma_f32_16x16x32_bf16 v[120:123], a[8:11], v[24:27], 0
    ds_read_b64_tr_b16 a[40:41], v6 offset:3104
    v_mfma_f32_16x16x32_bf16 v[124:127], a[8:11], v[28:31], 0
    ds_read_b64_tr_b16 a[42:43], v6 offset:4640
    v_mfma_f32_16x16x32_bf16 v[128:131], a[12:15], v[16:19], 0
    ds_read_b64_tr_b16 a[44:45], v6 offset:3136
    s_waitcnt vmcnt(8)
    v_max3_u32 v11, v32, v36, v40
    v_mfma_f32_16x16x32_bf16 v[132:135], a[12:15], v[20:23], 0
    ds_read_b64_tr_b16 a[46:47], v6 offset:4672
    v_max_u32 v11, v11, v44
    v_mfma_f32_16x16x32_bf16 v[136:139], a[12:15], v[24:27], 0
    v_cmp_eq_u32 vcc, -1, v11
    v_mfma_f32_16x16x32_bf16 v[140:143], a[12:15], v[28:31], 0
    ds_write_b32 v3, v13 offset:36
    v_mfma_f32_16x16x32_bf16 v[144:147], a[16:19], v[16:19], 0
    s_cbranch_vccnz L_rxb1
L_oxb1:
    v_swap_b32 v33, v36
    v_mfma_f32_16x16x32_bf16 v[148:151], a[16:19], v[20:23], 0
    v_swap_b32 v34, v40
    v_mfma_f32_16x16x32_bf16 v[152:155], a[16:19], v[24:27], 0
    v_swap_b32 v35, v44
    v_mfma_f32_16x16x32_bf16 v[156:159], a[16:19], v[28:31], 0
    v_swap_b32 v38, v41
    v_mfma_f32_16x16x32_bf16 v[160:163], v[16:19], v[16:19], 0
    v_swap_b32 v39, v45
    v_mfma_f32_16x16x32_bf16 v[164:167], v[20:23], v[20:23], 0
    v_swap_b32 v43, v46
    v_mfma_f32_16x16x32_bf16 v[168:171], v[24:27], v[24:27], 0
    v_mfma_f32_16x16x32_bf16 v[172:175], v[28:31], v[28:31], 0
    s_waitcnt lgkmcnt(0)
    v_mfma_f32_16x16x32_bf16 v[80:83], a[24:27], v[32:35], v[80:83]
    s_add_u32 s55, s88, 4
    s_and_b32 s55, s55, 15
    v_mfma_f32_16x16x32_bf16 v[84:87], a[24:27], v[36:39], v[84:87]
    s_lshl_b32 s55, s55, 14
    s_add_u32 s96, s55, s67
    v_mfma_f32_16x16x32_bf16 v[88:91], a[24:27], v[40:43], v[88:91]
    ds_read_b64_tr_b16 a[0:1], v5 offset:6144
    buffer_load_dwordx4 v[16:19], v7, s[44:47], s96 offen offset:0 sc1
    v_mfma_f32_16x16x32_bf16 v[92:95], a[24:27], v[44:47], v[92:95]
    ds_read_b64_tr_b16 a[2:3], v5 offset:7680
    v_mfma_f32_16x16x32_bf16 v[96:99], a[28:31], v[32:35], v[96:99]
    ds_read_b64_tr_b16 a[4:5], v5 offset:6176
    buffer_load_dwordx4 v[20:23], v7, s[44:47], s96 offen offset:1024 sc1
    v_mfma_f32_16x16x32_bf16 v[100:103], a[28:31], v[36:39], v[100:103]
    ds_read_b64_tr_b16 a[6:7], v5 offset:7712
    v_mfma_f32_16x16x32_bf16 v[104:107], a[28:31], v[40:43], v[104:107]
    ds_read_b64_tr_b16 a[8:9], v5 offset:6208
    buffer_load_dwordx4 v[24:27], v7, s[44:47], s96 offen offset:2048 sc1
    v_mfma_f32_16x16x32_bf16 v[108:111], a[28:31], v[44:47], v[108:111]
    ds_read_b64_tr_b16 a[10:11], v5 offset:7744
    v_mfma_f32_16x16x32_bf16 v[112:115], a[32:35], v[32:35], v[112:115]
    ds_read_b64_tr_b16 a[12:13], v6 offset:6144
    buffer_load_dwordx4 v[28:31], v7, s[44:47], s96 offen offset:3072 sc1
    v_mfma_f32_16x16x32_bf16 v[116:119], a[32:35], v[36:39], v[116:119]
    ds_read_b64_tr_b16 a[14:15], v6 offset:7680
    v_mov_b32 v13, 2
    v_mfma_f32_16x16x32_bf16 v[120:123], a[32:35], v[40:43], v[120:123]
    ds_read_b64_tr_b16 a[16:17], v6 offset:6176
    v_mfma_f32_16x16x32_bf16 v[124:127], a[32:35], v[44:47], v[124:127]
    ds_read_b64_tr_b16 a[18:19], v6 offset:7712
    v_mfma_f32_16x16x32_bf16 v[128:131], a[36:39], v[32:35], v[128:131]
    ds_read_b64_tr_b16 a[20:21], v6 offset:6208
    s_waitcnt vmcnt(8)
    v_max3_u32 v11, v48, v52, v56
    v_mfma_f32_16x16x32_bf16 v[132:135], a[36:39], v[36:39], v[132:135]
    ds_read_b64_tr_b16 a[22:23], v6 offset:7744
    v_max_u32 v11, v11, v60
    v_mfma_f32_16x16x32_bf16 v[136:139], a[36:39], v[40:43], v[136:139]
    v_cmp_eq_u32 vcc, -1, v11
    v_mfma_f32_16x16x32_bf16 v[140:143], a[36:39], v[44:47], v[140:143]
    ds_write_b32 v3, v13 offset:36
    v_mfma_f32_16x16x32_bf16 v[144:147], a[40:43], v[32:35], v[144:147]
    s_cbranch_vccnz L_rxb2
L_oxb2:
    v_swap_b32 v49, v52
    v_mfma_f32_16x16x32_bf16 v[148:151], a[40:43], v[36:39], v[148:151]
    v_swap_b32 v50, v56
    v_mfma_f32_16x16x32_bf16 v[152:155], a[40:43], v[40:43], v[152:155]
    v_swap_b32 v51, v60
    v_mfma_f32_16x16x32_bf16 v[156:159], a[40:43], v[44:47], v[156:159]
    v_swap_b32 v54, v57
    v_mfma_f32_16x16x32_bf16 v[160:163], v[32:35], v[32:35], v[160:163]
    v_swap_b32 v55, v61
    v_mfma_f32_16x16x32_bf16 v[164:167], v[36:39], v[36:39], v[164:167]
    v_swap_b32 v59, v62
    v_mfma_f32_16x16x32_bf16 v[168:171], v[40:43], v[40:43], v[168:171]
    v_mfma_f32_16x16x32_bf16 v[172:175], v[44:47], v[44:47], v[172:175]
    s_waitcnt lgkmcnt(0)
    v_mfma_f32_16x16x32_bf16 v[80:83], a[0:3], v[48:51], v[80:83]
    s_add_u32 s55, s88, 5
    s_and_b32 s55, s55, 15
    v_mfma_f32_16x16x32_bf16 v[84:87], a[0:3], v[52:55], v[84:87]
    s_lshl_b32 s55, s55, 14
    s_add_u32 s96, s55, s67
    v_mfma_f32_16x16x32_bf16 v[88:91], a[0:3], v[56:59], v[88:91]
    ds_read_b64_tr_b16 a[24:25], v5 offset:9216
    buffer_load_dwordx4 v[32:35], v7, s[44:47], s96 offen offset:0 sc1
    v_mfma_f32_16x16x32_bf16 v[92:95], a[0:3], v[60:63], v[92:95]
    ds_read_b64_tr_b16 a[26:27], v5 offset:10752
    v_mfma_f32_16x16x32_bf16 v[96:99], a[4:7], v[48:51], v[96:99]
    ds_read_b64_tr_b16 a[28:29], v5 offset:9248
    buffer_load_dwordx4 v[36:39], v7, s[44:47], s96 offen offset:1024 sc1
    v_mfma_f32_16x16x32_bf16 v[100:103], a[4:7], v[52:55], v[100:103]
    ds_read_b64_tr_b16 a[30:31], v5 offset:10784
    v_mfma_f32_16x16x32_bf16 v[104:107], a[4:7], v[56:59], v[104:107]
    ds_read_b64_tr_b16 a[32:33], v5 offset:9280
    buffer_load_dwordx4 v[40:43], v7, s[44:47], s96 offen offset:2048 sc1
    v_mfma_f32_16x16x32_bf16 v[108:111], a[4:7], v[60:63], v[108:111]
    ds_read_b64_tr_b16 a[34:35], v5 offset:10816
    v_mfma_f32_16x16x32_bf16 v[112:115], a[8:11], v[48:51], v[112:115]
    ds_read_b64_tr_b16 a[36:37], v6 offset:9216
    buffer_load_dwordx4 v[44:47], v7, s[44:47], s96 offen offset:3072 sc1
    v_mfma_f32_16x16x32_bf16 v[116:119], a[8:11], v[52:55], v[116:119]
    ds_read_b64_tr_b16 a[38:39], v6 offset:10752
    v_mov_b32 v13, 3
    v_mfma_f32_16x16x32_bf16 v[120:123], a[8:11], v[56:59], v[120:123]
    ds_read_b64_tr_b16 a[40:41], v6 offset:9248
    v_mfma_f32_16x16x32_bf16 v[124:127], a[8:11], v[60:63], v[124:127]
    ds_read_b64_tr_b16 a[42:43], v6 offset:10784
    v_mfma_f32_16x16x32_bf16 v[128:131], a[12:15], v[48:51], v[128:131]
    ds_read_b64_tr_b16 a[44:45], v6 offset:9280
    s_waitcnt vmcnt(8)
    v_max3_u32 v11, v64, v68, v72
    v_mfma_f32_16x16x32_bf16 v[132:135], a[12:15], v[52:55], v[132:135]
    ds_read_b64_tr_b16 a[46:47], v6 offset:10816
    v_max_u32 v11, v11, v76
    v_mfma_f32_16x16x32_bf16 v[136:139], a[12:15], v[56:59], v[136:139]
    v_cmp_eq_u32 vcc, -1, v11
    v_mfma_f32_16x16x32_bf16 v[140:143], a[12:15], v[60:63], v[140:143]
    ds_write_b32 v3, v13 offset:36
    v_mfma_f32_16x16x32_bf16 v[144:147], a[16:19], v[48:51], v[144:147]
    s_cbranch_vccnz L_rxb3
L_oxb3:
    v_swap_b32 v65, v68
    v_mfma_f32_16x16x32_bf16 v[148:151], a[16:19], v[52:55], v[148:151]
    v_swap_b32 v66, v72
    v_mfma_f32_16x16x32_bf16 v[152:155], a[16:19], v[56:59], v[152:155]
    v_swap_b32 v67, v76
    v_mfma_f32_16x16x32_bf16 v[156:159], a[16:19], v[60:63], v[156:159]
    v_swap_b32 v70, v73
    v_mfma_f32_16x16x32_bf16 v[160:163], v[48:51], v[48:51], v[160:163]
    v_swap_b32 v71, v77
    v_mfma_f32_16x16x32_bf16 v[164:167], v[52:55], v[52:55], v[164:167]
    v_swap_b32 v75, v78
    v_mfma_f32_16x16x32_bf16 v[168:171], v[56:59], v[56:59], v[168:171]
    v_mfma_f32_16x16x32_bf16 v[172:175], v[60:63], v[60:63], v[172:175]
    s_waitcnt lgkmcnt(0)
    v_mfma_f32_16x16x32_bf16 v[80:83], a[24:27], v[64:67], v[80:83]
    s_add_u32 s55, s88, 6
    s_and_b32 s55, s55, 15
    v_mfma_f32_16x16x32_bf16 v[84:87], a[24:27], v[68:71], v[84:87]
    s_lshl_b32 s55, s55, 14
    s_add_u32 s96, s55, s67
    v_mfma_f32_16x16x32_bf16 v[88:91], a[24:27], v[72:75], v[88:91]
    ds_read_b64_tr_b16 a[0:1], v5 offset:12288
    buffer_load_dwordx4 v[48:51], v7, s[44:47], s96 offen offset:0 sc1
    v_mfma_f32_16x16x32_bf16 v[92:95], a[24:27], v[76:79], v[92:95]
    ds_read_b64_tr_b16 a[2:3], v5 offset:13824
    v_mfma_f32_16x16x32_bf16 v[96:99], a[28:31], v[64:67], v[96:99]
    ds_read_b64_tr_b16 a[4:5], v5 offset:12320
    buffer_load_dwordx4 v[52:55], v7, s[44:47], s96 offen offset:1024 sc1
    v_mfma_f32_16x16x32_bf16 v[100:103], a[28:31], v[68:71], v[100:103]
    ds_read_b64_tr_b16 a[6:7], v5 offset:13856
    v_mfma_f32_16x16x32_bf16 v[104:107], a[28:31], v[72:75], v[104:107]
    ds_read_b64_tr_b16 a[8:9], v5 offset:12352
    buffer_load_dwordx4 v[56:59], v7, s[44:47], s96 offen offset:2048 sc1
    v_mfma_f32_16x16x32_bf16 v[108:111], a[28:31], v[76:79], v[108:111]
    ds_read_b64_tr_b16 a[10:11], v5 offset:13888
    v_mfma_f32_16x16x32_bf16 v[112:115], a[32:35], v[64:67], v[112:115]
    ds_read_b64_tr_b16 a[12:13], v6 offset:12288
    buffer_load_dwordx4 v[60:63], v7, s[44:47], s96 offen offset:3072 sc1
    v_mfma_f32_16x16x32_bf16 v[116:119], a[32:35], v[68:71], v[116:119]
    ds_read_b64_tr_b16 a[14:15], v6 offset:13824
    v_mov_b32 v13, 4
    v_mfma_f32_16x16x32_bf16 v[120:123], a[32:35], v[72:75], v[120:123]
    ds_read_b64_tr_b16 a[16:17], v6 offset:12320
    v_mfma_f32_16x16x32_bf16 v[124:127], a[32:35], v[76:79], v[124:127]
    ds_read_b64_tr_b16 a[18:19], v6 offset:13856
    v_mfma_f32_16x16x32_bf16 v[128:131], a[36:39], v[64:67], v[128:131]
    ds_read_b64_tr_b16 a[20:21], v6 offset:12352
    s_waitcnt vmcnt(8)
    v_max3_u32 v11, v16, v20, v24
    v_mfma_f32_16x16x32_bf16 v[132:135], a[36:39], v[68:71], v[132:135]
    ds_read_b64_tr_b16 a[22:23], v6 offset:13888
    v_max_u32 v11, v11, v28
    v_mfma_f32_16x16x32_bf16 v[136:139], a[36:39], v[72:75], v[136:139]
    v_cmp_eq_u32 vcc, -1, v11
    v_mfma_f32_16x16x32_bf16 v[140:143], a[36:39], v[76:79], v[140:143]
    ds_write_b32 v3, v13 offset:36
    v_mfma_f32_16x16x32_bf16 v[144:147], a[40:43], v[64:67], v[144:147]
    s_cbranch_vccnz L_rxb4
L_oxb4:
    v_swap_b32 v17, v20
    v_mfma_f32_16x16x32_bf16 v[148:151], a[40:43], v[68:71], v[148:151]
    v_swap_b32 v18, v24
    v_mfma_f32_16x16x32_bf16 v[152:155], a[40:43], v[72:75], v[152:155]
    v_swap_b32 v19, v28
    v_mfma_f32_16x16x32_bf16 v[156:159], a[40:43], v[76:79], v[156:159]
    v_swap_b32 v22, v25
    v_mfma_f32_16x16x32_bf16 v[160:163], v[64:67], v[64:67], v[160:163]
    v_swap_b32 v23, v29
    v_mfma_f32_16x16x32_bf16 v[164:167], v[68:71], v[68:71], v[164:167]
    v_swap_b32 v27, v30
    v_mfma_f32_16x16x32_bf16 v[168:171], v[72:75], v[72:75], v[168:171]
    v_mfma_f32_16x16x32_bf16 v[172:175], v[76:79], v[76:79], v[172:175]
    s_waitcnt lgkmcnt(0)
    v_mfma_f32_16x16x32_bf16 v[80:83], a[0:3], v[16:19], v[80:83]
    s_add_u32 s55, s88, 7
    s_and_b32 s55, s55, 15
    v_mfma_f32_16x16x32_bf16 v[84:87], a[0:3], v[20:23], v[84:87]
    s_lshl_b32 s55, s55, 14
    s_add_u32 s96, s55, s67
    v_mfma_f32_16x16x32_bf16 v[88:91], a[0:3], v[24:27], v[88:91]
    ds_read_b64_tr_b16 a[24:25], v5 offset:15360
    buffer_load_dwordx4 v[64:67], v7, s[44:47], s96 offen offset:0 sc1
    v_mfma_f32_16x16x32_bf16 v[92:95], a[0:3], v[28:31], v[92:95]
    ds_read_b64_tr_b16 a[26:27], v5 offset:16896
    v_mfma_f32_16x16x32_bf16 v[96:99], a[4:7], v[16:19], v[96:99]
    ds_read_b64_tr_b16 a[28:29], v5 offset:15392
    buffer_load_dwordx4 v[68:71], v7, s[44:47], s96 offen offset:1024 sc1
    v_mfma_f32_16x16x32_bf16 v[100:103], a[4:7], v[20:23], v[100:103]
    ds_read_b64_tr_b16 a[30:31], v5 offset:16928
    v_mfma_f32_16x16x32_bf16 v[104:107], a[4:7], v[24:27], v[104:107]
    ds_read_b64_tr_b16 a[32:33], v5 offset:15424
    buffer_load_dwordx4 v[72:75], v7, s[44:47], s96 offen offset:2048 sc1
    v_mfma_f32_16x16x32_bf16 v[108:111], a[4:7], v[28:31], v[108:111]
    ds_read_b64_tr_b16 a[34:35], v5 offset:16960
    v_mfma_f32_16x16x32_bf16 v[112:115], a[8:11], v[16:19], v[112:115]
    ds_read_b64_tr_b16 a[36:37], v6 offset:15360
    buffer_load_dwordx4 v[76:79], v7, s[44:47], s96 offen offset:3072 sc1
    v_mfma_f32_16x16x32_bf16 v[116:119], a[8:11], v[20:23], v[116:119]
    ds_read_b64_tr_b16 a[38:39], v6 offset:16896
    v_mov_b32 v13, 5
    v_mfma_f32_16x16x32_bf16 v[120:123], a[8:11], v[24:27], v[120:123]
    ds_read_b64_tr_b16 a[40:41], v6 offset:15392
    v_mfma_f32_16x16x32_bf16 v[124:127], a[8:11], v[28:31], v[124:127]
    ds_read_b64_tr_b16 a[42:43], v6 offset:16928
    v_mfma_f32_16x16x32_bf16 v[128:131], a[12:15], v[16:19], v[128:131]
    ds_read_b64_tr_b16 a[44:45], v6 offset:15424
    s_waitcnt vmcnt(8)
    v_max3_u32 v11, v32, v36, v40
    v_mfma_f32_16x16x32_bf16 v[132:135], a[12:15], v[20:23], v[132:135]
    ds_read_b64_tr_b16 a[46:47], v6 offset:16960
    v_max_u32 v11, v11, v44
    v_mfma_f32_16x16x32_bf16 v[136:139], a[12:15], v[24:27], v[136:139]
    v_cmp_eq_u32 vcc, -1, v11
    v_mfma_f32_16x16x32_bf16 v[140:143], a[12:15], v[28:31], v[140:143]
    ds_write_b32 v3, v13 offset:36
    v_mfma_f32_16x16x32_bf16 v[144:147], a[16:19], v[16:19], v[144:147]
    s_cbranch_vccnz L_rxb5
L_oxb5:
    v_swap_b32 v33, v36
    v_mfma_f32_16x16x32_bf16 v[148:151], a[16:19], v[20:23], v[148:151]
    v_swap_b32 v34, v40
    v_mfma_f32_16x16x32_bf16 v[152:155], a[16:19], v[24:27], v[152:155]
    v_swap_b32 v35, v44
    v_mfma_f32_16x16x32_bf16 v[156:159], a[16:19], v[28:31], v[156:159]
    v_swap_b32 v38, v41
    v_mfma_f32_16x16x32_bf16 v[160:163], v[16:19], v[16:19], v[160:163]
    v_swap_b32 v39, v45
    v_mfma_f32_16x16x32_bf16 v[164:167], v[20:23], v[20:23], v[164:167]
    v_swap_b32 v43, v46
    v_mfma_f32_16x16x32_bf16 v[168:171], v[24:27], v[24:27], v[168:171]
    v_mfma_f32_16x16x32_bf16 v[172:175], v[28:31], v[28:31], v[172:175]
    s_waitcnt lgkmcnt(0)
    v_mfma_f32_16x16x32_bf16 v[80:83], a[24:27], v[32:35], v[80:83]
    s_add_u32 s55, s88, 8
    s_and_b32 s55, s55, 15
    v_mfma_f32_16x16x32_bf16 v[84:87], a[24:27], v[36:39], v[84:87]
    s_lshl_b32 s55, s55, 14
    s_add_u32 s96, s55, s67
    v_mfma_f32_16x16x32_bf16 v[88:91], a[24:27], v[40:43], v[88:91]
    ds_read_b64_tr_b16 a[0:1], v5 offset:18432
    buffer_load_dwordx4 v[16:19], v7, s[44:47], s96 offen offset:0 sc1
    v_mfma_f32_16x16x32_bf16 v[92:95], a[24:27], v[44:47], v[92:95]
    ds_read_b64_tr_b16 a[2:3], v5 offset:19968
    v_mfma_f32_16x16x32_bf16 v[96:99], a[28:31], v[32:35], v[96:99]
    ds_read_b64_tr_b16 a[4:5], v5 offset:18464
    buffer_load_dwordx4 v[20:23], v7, s[44:47], s96 offen offset:1024 sc1
    v_mfma_f32_16x16x32_bf16 v[100:103], a[28:31], v[36:39], v[100:103]
    ds_read_b64_tr_b16 a[6:7], v5 offset:20000
    v_mfma_f32_16x16x32_bf16 v[104:107], a[28:31], v[40:43], v[104:107]
    ds_read_b64_tr_b16 a[8:9], v5 offset:18496
    buffer_load_dwordx4 v[24:27], v7, s[44:47], s96 offen offset:2048 sc1
    v_mfma_f32_16x16x32_bf16 v[108:111], a[28:31], v[44:47], v[108:111]
    ds_read_b64_tr_b16 a[10:11], v5 offset:20032
    v_mfma_f32_16x16x32_bf16 v[112:115], a[32:35], v[32:35], v[112:115]
    ds_read_b64_tr_b16 a[12:13], v6 offset:18432
    buffer_load_dwordx4 v[28:31], v7, s[44:47], s96 offen offset:3072 sc1
    v_mfma_f32_16x16x32_bf16 v[116:119], a[32:35], v[36:39], v[116:119]
    ds_read_b64_tr_b16 a[14:15], v6 offset:19968
    v_mov_b32 v13, 6
    v_mfma_f32_16x16x32_bf16 v[120:123], a[32:35], v[40:43], v[120:123]
    ds_read_b64_tr_b16 a[16:17], v6 offset:18464
    v_mfma_f32_16x16x32_bf16 v[124:127], a[32:35], v[44:47], v[124:127]
    ds_read_b64_tr_b16 a[18:19], v6 offset:20000
    v_mfma_f32_16x16x32_bf16 v[128:131], a[36:39], v[32:35], v[128:131]
    ds_read_b64_tr_b16 a[20:21], v6 offset:18496
    s_waitcnt vmcnt(8)
    v_max3_u32 v11, v48, v52, v56
    v_mfma_f32_16x16x32_bf16 v[132:135], a[36:39], v[36:39], v[132:135]
    ds_read_b64_tr_b16 a[22:23], v6 offset:20032
    v_max_u32 v11, v11, v60
    v_mfma_f32_16x16x32_bf16 v[136:139], a[36:39], v[40:43], v[136:139]
    v_cmp_eq_u32 vcc, -1, v11
    v_mfma_f32_16x16x32_bf16 v[140:143], a[36:39], v[44:47], v[140:143]
    ds_write_b32 v3, v13 offset:36
    v_mfma_f32_16x16x32_bf16 v[144:147], a[40:43], v[32:35], v[144:147]
    s_cbranch_vccnz L_rxb6
L_oxb6:
    v_swap_b32 v49, v52
    v_mfma_f32_16x16x32_bf16 v[148:151], a[40:43], v[36:39], v[148:151]
    v_swap_b32 v50, v56
    v_mfma_f32_16x16x32_bf16 v[152:155], a[40:43], v[40:43], v[152:155]
    v_swap_b32 v51, v60
    v_mfma_f32_16x16x32_bf16 v[156:159], a[40:43], v[44:47], v[156:159]
    v_swap_b32 v54, v57
    v_mfma_f32_16x16x32_bf16 v[160:163], v[32:35], v[32:35], v[160:163]
    v_swap_b32 v55, v61
    v_mfma_f32_16x16x32_bf16 v[164:167], v[36:39], v[36:39], v[164:167]
    v_swap_b32 v59, v62
    v_mfma_f32_16x16x32_bf16 v[168:171], v[40:43], v[40:43], v[168:171]
    v_mfma_f32_16x16x32_bf16 v[172:175], v[44:47], v[44:47], v[172:175]
    s_waitcnt lgkmcnt(0)
    v_mfma_f32_16x16x32_bf16 v[80:83], a[0:3], v[48:51], v[80:83]
    s_add_u32 s55, s88, 9
    s_and_b32 s55, s55, 15
    v_mfma_f32_16x16x32_bf16 v[84:87], a[0:3], v[52:55], v[84:87]
    s_lshl_b32 s55, s55, 14
    s_add_u32 s96, s55, s67
    v_mfma_f32_16x16x32_bf16 v[88:91], a[0:3], v[56:59], v[88:91]
    ds_read_b64_tr_b16 a[24:25], v5 offset:21504
    buffer_load_dwordx4 v[32:35], v7, s[44:47], s96 offen offset:0 sc1
    v_mfma_f32_16x16x32_bf16 v[92:95], a[0:3], v[60:63], v[92:95]
    ds_read_b64_tr_b16 a[26:27], v5 offset:23040
    v_mfma_f32_16x16x32_bf16 v[96:99], a[4:7], v[48:51], v[96:99]
    ds_read_b64_tr_b16 a[28:29], v5 offset:21536
    buffer_load_dwordx4 v[36:39], v7, s[44:47], s96 offen offset:1024 sc1
    v_mfma_f32_16x16x32_bf16 v[100:103], a[4:7], v[52:55], v[100:103]
    ds_read_b64_tr_b16 a[30:31], v5 offset:23072
    v_mfma_f32_16x16x32_bf16 v[104:107], a[4:7], v[56:59], v[104:107]
    ds_read_b64_tr_b16 a[32:33], v5 offset:21568
    buffer_load_dwordx4 v[40:43], v7, s[44:47], s96 offen offset:2048 sc1
    v_mfma_f32_16x16x32_bf16 v[108:111], a[4:7], v[60:63], v[108:111]
    ds_read_b64_tr_b16 a[34:35], v5 offset:23104
    v_mfma_f32_16x16x32_bf16 v[112:115], a[8:11], v[48:51], v[112:115]
    ds_read_b64_tr_b16 a[36:37], v6 offset:21504
    buffer_load_dwordx4 v[44:47], v7, s[44:47], s96 offen offset:3072 sc1
    v_mfma_f32_16x16x32_bf16 v[116:119], a[8:11], v[52:55], v[116:119]
    ds_read_b64_tr_b16 a[38:39], v6 offset:23040
    v_mov_b32 v13, 7
    v_mfma_f32_16x16x32_bf16 v[120:123], a[8:11], v[56:59], v[120:123]
    ds_read_b64_tr_b16 a[40:41], v6 offset:21536
    v_mfma_f32_16x16x32_bf16 v[124:127], a[8:11], v[60:63], v[124:127]
    ds_read_b64_tr_b16 a[42:43], v6 offset:23072
    v_mfma_f32_16x16x32_bf16 v[128:131], a[12:15], v[48:51], v[128:131]
    ds_read_b64_tr_b16 a[44:45], v6 offset:21568
    s_waitcnt vmcnt(8)
    v_max3_u32 v11, v64, v68, v72
    v_mfma_f32_16x16x32_bf16 v[132:135], a[12:15], v[52:55], v[132:135]
    ds_read_b64_tr_b16 a[46:47], v6 offset:23104
    v_max_u32 v11, v11, v76
    v_mfma_f32_16x16x32_bf16 v[136:139], a[12:15], v[56:59], v[136:139]
    v_cmp_eq_u32 vcc, -1, v11
    v_mfma_f32_16x16x32_bf16 v[140:143], a[12:15], v[60:63], v[140:143]
    ds_write_b32 v3, v13 offset:36
    v_mfma_f32_16x16x32_bf16 v[144:147], a[16:19], v[48:51], v[144:147]
    s_cbranch_vccnz L_rxb7
L_oxb7:
    v_swap_b32 v65, v68
    v_mfma_f32_16x16x32_bf16 v[148:151], a[16:19], v[52:55], v[148:151]
    v_swap_b32 v66, v72
    v_mfma_f32_16x16x32_bf16 v[152:155], a[16:19], v[56:59], v[152:155]
    v_swap_b32 v67, v76
    v_mfma_f32_16x16x32_bf16 v[156:159], a[16:19], v[60:63], v[156:159]
    v_swap_b32 v70, v73
    v_mfma_f32_16x16x32_bf16 v[160:163], v[48:51], v[48:51], v[160:163]
    v_swap_b32 v71, v77
    v_mfma_f32_16x16x32_bf16 v[164:167], v[52:55], v[52:55], v[164:167]
    v_swap_b32 v75, v78
    v_mfma_f32_16x16x32_bf16 v[168:171], v[56:59], v[56:59], v[168:171]
    v_mfma_f32_16x16x32_bf16 v[172:175], v[60:63], v[60:63], v[172:175]
    s_waitcnt lgkmcnt(0)
    v_mfma_f32_16x16x32_bf16 v[80:83], a[24:27], v[64:67], v[80:83]
    s_add_u32 s55, s88, 10
    s_and_b32 s55, s55, 15
    v_mfma_f32_16x16x32_bf16 v[84:87], a[24:27], v[68:71], v[84:87]
    s_lshl_b32 s55, s55, 14
    s_add_u32 s96, s55, s67
    v_mfma_f32_16x16x32_bf16 v[88:91], a[24:27], v[72:75], v[88:91]
    ds_read_b64_tr_b16 a[0:1], v5 offset:24576
    buffer_load_dwordx4 v[48:51], v7, s[44:47], s96 offen offset:0 sc1
    v_mfma_f32_16x16x32_bf16 v[92:95], a[24:27], v[76:79], v[92:95]
    ds_read_b64_tr_b16 a[2:3], v5 offset:26112
    v_mfma_f32_16x16x32_bf16 v[96:99], a[28:31], v[64:67], v[96:99]
    ds_read_b64_tr_b16 a[4:5], v5 offset:24608
    buffer_load_dwordx4 v[52:55], v7, s[44:47], s96 offen offset:1024 sc1
    v_mfma_f32_16x16x32_bf16 v[100:103], a[28:31], v[68:71], v[100:103]
    ds_read_b64_tr_b16 a[6:7], v5 offset:26144
    v_mfma_f32_16x16x32_bf16 v[104:107], a[28:31], v[72:75], v[104:107]
    ds_read_b64_tr_b16 a[8:9], v5 offset:24640
    buffer_load_dwordx4 v[56:59], v7, s[44:47], s96 offen offset:2048 sc1
    v_mfma_f32_16x16x32_bf16 v[108:111], a[28:31], v[76:79], v[108:111]
    ds_read_b64_tr_b16 a[10:11], v5 offset:26176
    v_mfma_f32_16x16x32_bf16 v[112:115], a[32:35], v[64:67], v[112:115]
    ds_read_b64_tr_b16 a[12:13], v6 offset:24576
    buffer_load_dwordx4 v[60:63], v7, s[44:47], s96 offen offset:3072 sc1
    v_mfma_f32_16x16x32_bf16 v[116:119], a[32:35], v[68:71], v[116:119]
    ds_read_b64_tr_b16 a[14:15], v6 offset:26112
    v_mov_b32 v13, 8
    v_mfma_f32_16x16x32_bf16 v[120:123], a[32:35], v[72:75], v[120:123]
    ds_read_b64_tr_b16 a[16:17], v6 offset:24608
    v_mfma_f32_16x16x32_bf16 v[124:127], a[32:35], v[76:79], v[124:127]
    ds_read_b64_tr_b16 a[18:19], v6 offset:26144
    v_mfma_f32_16x16x32_bf16 v[128:131], a[36:39], v[64:67], v[128:131]
    ds_read_b64_tr_b16 a[20:21], v6 offset:24640
    s_waitcnt vmcnt(8)
    v_max3_u32 v11, v16, v20, v24
    v_mfma_f32_16x16x32_bf16 v[132:135], a[36:39], v[68:71], v[132:135]
    ds_read_b64_tr_b16 a[22:23], v6 offset:26176
    v_max_u32 v11, v11, v28
    v_mfma_f32_16x16x32_bf16 v[136:139], a[36:39], v[72:75], v[136:139]
    v_cmp_eq_u32 vcc, -1, v11
    v_mfma_f32_16x16x32_bf16 v[140:143], a[36:39], v[76:79], v[140:143]
    ds_write_b32 v3, v13 offset:36
    v_mfma_f32_16x16x32_bf16 v[144:147], a[40:43], v[64:67], v[144:147]
    s_cbranch_vccnz L_rxb8
L_oxb8:
    v_swap_b32 v17, v20
    v_mfma_f32_16x16x32_bf16 v[148:151], a[40:43], v[68:71], v[148:151]
    v_swap_b32 v18, v24
    v_mfma_f32_16x16x32_bf16 v[152:155], a[40:43], v[72:75], v[152:155]
    v_swap_b32 v19, v28
    v_mfma_f32_16x16x32_bf16 v[156:159], a[40:43], v[76:79], v[156:159]
    v_swap_b32 v22, v25
    v_mfma_f32_16x16x32_bf16 v[160:163], v[64:67], v[64:67], v[160:163]
    v_swap_b32 v23, v29
    v_mfma_f32_16x16x32_bf16 v[164:167], v[68:71], v[68:71], v[164:167]
    v_swap_b32 v27, v30
    v_mfma_f32_16x16x32_bf16 v[168:171], v[72:75], v[72:75], v[168:171]
    v_mfma_f32_16x16x32_bf16 v[172:175], v[76:79], v[76:79], v[172:175]
    s_waitcnt lgkmcnt(0)
    v_mfma_f32_16x16x32_bf16 v[80:83], a[0:3], v[16:19], v[80:83]
    s_add_u32 s55, s88, 11
    s_and_b32 s55, s55, 15
    v_mfma_f32_16x16x32_bf16 v[84:87], a[0:3], v[20:23], v[84:87]
    s_lshl_b32 s55, s55, 14
    s_add_u32 s96, s55, s67
    v_mfma_f32_16x16x32_bf16 v[88:91], a[0:3], v[24:27], v[88:91]
    ds_read_b64_tr_b16 a[24:25], v5 offset:27648
    buffer_load_dwordx4 v[64:67], v7, s[44:47], s96 offen offset:0 sc1
    v_mfma_f32_16x16x32_bf16 v[92:95], a[0:3], v[28:31], v[92:95]
    ds_read_b64_tr_b16 a[26:27], v5 offset:29184
    v_mfma_f32_16x16x32_bf16 v[96:99], a[4:7], v[16:19], v[96:99]
    ds_read_b64_tr_b16 a[28:29], v5 offset:27680
    buffer_load_dwordx4 v[68:71], v7, s[44:47], s96 offen offset:1024 sc1
    v_mfma_f32_16x16x32_bf16 v[100:103], a[4:7], v[20:23], v[100:103]
    ds_read_b64_tr_b16 a[30:31], v5 offset:29216
    v_mfma_f32_16x16x32_bf16 v[104:107], a[4:7], v[24:27], v[104:107]
    ds_read_b64_tr_b16 a[32:33], v5 offset:27712
    buffer_load_dwordx4 v[72:75], v7, s[44:47], s96 offen offset:2048 sc1
    v_mfma_f32_16x16x32_bf16 v[108:111], a[4:7], v[28:31], v[108:111]
    ds_read_b64_tr_b16 a[34:35], v5 offset:29248
    v_mfma_f32_16x16x32_bf16 v[112:115], a[8:11], v[16:19], v[112:115]
    ds_read_b64_tr_b16 a[36:37], v6 offset:27648
    buffer_load_dwordx4 v[76:79], v7, s[44:47], s96 offen offset:3072 sc1
    v_mfma_f32_16x16x32_bf16 v[116:119], a[8:11], v[20:23], v[116:119]
    ds_read_b64_tr_b16 a[38:39], v6 offset:29184
    v_mov_b32 v13, 9
    v_mfma_f32_16x16x32_bf16 v[120:123], a[8:11], v[24:27], v[120:123]
    ds_read_b64_tr_b16 a[40:41], v6 offset:27680
    v_mfma_f32_16x16x32_bf16 v[124:127], a[8:11], v[28:31], v[124:127]
    ds_read_b64_tr_b16 a[42:43], v6 offset:29216
    v_mfma_f32_16x16x32_bf16 v[128:131], a[12:15], v[16:19], v[128:131]
    ds_read_b64_tr_b16 a[44:45], v6 offset:27712
    s_waitcnt vmcnt(8)
    v_max3_u32 v11, v32, v36, v40
    v_mfma_f32_16x16x32_bf16 v[132:135], a[12:15], v[20:23], v[132:135]
    ds_read_b64_tr_b16 a[46:47], v6 offset:29248
    v_max_u32 v11, v11, v44
    v_mfma_f32_16x16x32_bf16 v[136:139], a[12:15], v[24:27], v[136:139]
    ds_read_b32 v12, v3 offset:0
    v_cmp_eq_u32 vcc, -1, v11
    v_mfma_f32_16x16x32_bf16 v[140:143], a[12:15], v[28:31], v[140:143]
    ds_write_b32 v3, v13 offset:36
    v_mfma_f32_16x16x32_bf16 v[144:147], a[16:19], v[16:19], v[144:147]
    s_cbranch_vccnz L_rxb9
L_oxb9:
    v_swap_b32 v33, v36
    v_mfma_f32_16x16x32_bf16 v[148:151], a[16:19], v[20:23], v[148:151]
    v_swap_b32 v34, v40
    v_mfma_f32_16x16x32_bf16 v[152:155], a[16:19], v[24:27], v[152:155]
    v_swap_b32 v35, v44
    v_mfma_f32_16x16x32_bf16 v[156:159], a[16:19], v[28:31], v[156:159]
    v_swap_b32 v38, v41
    v_mfma_f32_16x16x32_bf16 v[160:163], v[16:19], v[16:19], v[160:163]
    v_swap_b32 v39, v45
    v_mfma_f32_16x16x32_bf16 v[164:167], v[20:23], v[20:23], v[164:167]
    v_swap_b32 v43, v46
    v_mfma_f32_16x16x32_bf16 v[168:171], v[24:27], v[24:27], v[168:171]
    v_mfma_f32_16x16x32_bf16 v[172:175], v[28:31], v[28:31], v[172:175]
    s_waitcnt lgkmcnt(0)
    v_cmp_ne_u32 vcc, 4, v12
    v_mfma_f32_16x16x32_bf16 v[80:83], a[24:27], v[32:35], v[80:83]
    s_add_u32 s55, s88, 12
    s_and_b32 s55, s55, 15
    v_mfma_f32_16x16x32_bf16 v[84:87], a[24:27], v[36:39], v[84:87]
    s_cbranch_vccnz L_rfb9
L_ofb9:
    s_lshl_b32 s55, s55, 14
    s_add_u32 s96, s55, s67
    v_mfma_f32_16x16x32_bf16 v[88:91], a[24:27], v[40:43], v[88:91]
    ds_read_b64_tr_b16 a[0:1], v5 offset:30720
    buffer_load_dwordx4 v[16:19], v7, s[44:47], s96 offen offset:0 sc1
    v_mfma_f32_16x16x32_bf16 v[92:95], a[24:27], v[44:47], v[92:95]
    ds_read_b64_tr_b16 a[2:3], v5 offset:32256
    v_mfma_f32_16x16x32_bf16 v[96:99], a[28:31], v[32:35], v[96:99]
    ds_read_b64_tr_b16 a[4:5], v5 offset:30752
    buffer_load_dwordx4 v[20:23], v7, s[44:47], s96 offen offset:1024 sc1
    v_mfma_f32_16x16x32_bf16 v[100:103], a[28:31], v[36:39], v[100:103]
    ds_read_b64_tr_b16 a[6:7], v5 offset:32288
    v_mfma_f32_16x16x32_bf16 v[104:107], a[28:31], v[40:43], v[104:107]
    ds_read_b64_tr_b16 a[8:9], v5 offset:30784
    buffer_load_dwordx4 v[24:27], v7, s[44:47], s96 offen offset:2048 sc1
    v_mfma_f32_16x16x32_bf16 v[108:111], a[28:31], v[44:47], v[108:111]
    ds_read_b64_tr_b16 a[10:11], v5 offset:32320
    v_mfma_f32_16x16x32_bf16 v[112:115], a[32:35], v[32:35], v[112:115]
    ds_read_b64_tr_b16 a[12:13], v6 offset:30720
    buffer_load_dwordx4 v[28:31], v7, s[44:47], s96 offen offset:3072 sc1
    v_mfma_f32_16x16x32_bf16 v[116:119], a[32:35], v[36:39], v[116:119]
    ds_read_b64_tr_b16 a[14:15], v6 offset:32256
    v_mov_b32 v13, 10
    v_mfma_f32_16x16x32_bf16 v[120:123], a[32:35], v[40:43], v[120:123]
    ds_read_b64_tr_b16 a[16:17], v6 offset:30752
    v_mfma_f32_16x16x32_bf16 v[124:127], a[32:35], v[44:47], v[124:127]
    ds_read_b64_tr_b16 a[18:19], v6 offset:32288
    v_mfma_f32_16x16x32_bf16 v[128:131], a[36:39], v[32:35], v[128:131]
    ds_read_b64_tr_b16 a[20:21], v6 offset:30784
    s_waitcnt vmcnt(8)
    v_max3_u32 v11, v48, v52, v56
    v_mfma_f32_16x16x32_bf16 v[132:135], a[36:39], v[36:39], v[132:135]
    ds_read_b64_tr_b16 a[22:23], v6 offset:32320
    v_max_u32 v11, v11, v60
    v_mfma_f32_16x16x32_bf16 v[136:139], a[36:39], v[40:43], v[136:139]
    v_cmp_eq_u32 vcc, -1, v11
    v_mfma_f32_16x16x32_bf16 v[140:143], a[36:39], v[44:47], v[140:143]
    ds_write_b32 v3, v13 offset:36
    v_mfma_f32_16x16x32_bf16 v[144:147], a[40:43], v[32:35], v[144:147]
    s_cbranch_vccnz L_rxb10
L_oxb10:
    v_swap_b32 v49, v52
    v_mfma_f32_16x16x32_bf16 v[148:151], a[40:43], v[36:39], v[148:151]
    v_swap_b32 v50, v56
    v_mfma_f32_16x16x32_bf16 v[152:155], a[40:43], v[40:43], v[152:155]
    v_swap_b32 v51, v60
    v_mfma_f32_16x16x32_bf16 v[156:159], a[40:43], v[44:47], v[156:159]
    v_swap_b32 v54, v57
    v_mfma_f32_16x16x32_bf16 v[160:163], v[32:35], v[32:35], v[160:163]
    v_swap_b32 v55, v61
    v_mfma_f32_16x16x32_bf16 v[164:167], v[36:39], v[36:39], v[164:167]
    v_swap_b32 v59, v62
    v_mfma_f32_16x16x32_bf16 v[168:171], v[40:43], v[40:43], v[168:171]
    v_mfma_f32_16x16x32_bf16 v[172:175], v[44:47], v[44:47], v[172:175]
    s_waitcnt lgkmcnt(0)
    v_mfma_f32_16x16x32_bf16 v[80:83], a[0:3], v[48:51], v[80:83]
    s_add_u32 s55, s88, 13
    s_and_b32 s55, s55, 15
    v_mfma_f32_16x16x32_bf16 v[84:87], a[0:3], v[52:55], v[84:87]
    s_lshl_b32 s55, s55, 14
    s_add_u32 s96, s55, s67
    v_mfma_f32_16x16x32_bf16 v[88:91], a[0:3], v[56:59], v[88:91]
    ds_read_b64_tr_b16 a[24:25], v5 offset:33792
    buffer_load_dwordx4 v[32:35], v7, s[44:47], s96 offen offset:0 sc1
    v_mfma_f32_16x16x32_bf16 v[92:95], a[0:3], v[60:63], v[92:95]
    ds_read_b64_tr_b16 a[26:27], v5 offset:35328
    v_mfma_f32_16x16x32_bf16 v[96:99], a[4:7], v[48:51], v[96:99]
    ds_read_b64_tr_b16 a[28:29], v5 offset:33824
    buffer_load_dwordx4 v[36:39], v7, s[44:47], s96 offen offset:1024 sc1
    v_mfma_f32_16x16x32_bf16 v[100:103], a[4:7], v[52:55], v[100:103]
    ds_read_b64_tr_b16 a[30:31], v5 offset:35360
    v_mfma_f32_16x16x32_bf16 v[104:107], a[4:7], v[56:59], v[104:107]
    ds_read_b64_tr_b16 a[32:33], v5 offset:33856
    buffer_load_dwordx4 v[40:43], v7, s[44:47], s96 offen offset:2048 sc1
    v_mfma_f32_16x16x32_bf16 v[108:111], a[4:7], v[60:63], v[108:111]
    ds_read_b64_tr_b16 a[34:35], v5 offset:35392
    v_mfma_f32_16x16x32_bf16 v[112:115], a[8:11], v[48:51], v[112:115]
    ds_read_b64_tr_b16 a[36:37], v6 offset:33792
    buffer_load_dwordx4 v[44:47], v7, s[44:47], s96 offen offset:3072 sc1
    v_mfma_f32_16x16x32_bf16 v[116:119], a[8:11], v[52:55], v[116:119]
    ds_read_b64_tr_b16 a[38:39], v6 offset:35328
    v_mov_b32 v13, 11
    v_mfma_f32_16x16x32_bf16 v[120:123], a[8:11], v[56:59], v[120:123]
    ds_read_b64_tr_b16 a[40:41], v6 offset:33824
    v_mfma_f32_16x16x32_bf16 v[124:127], a[8:11], v[60:63], v[124:127]
    ds_read_b64_tr_b16 a[42:43], v6 offset:35360
    v_mfma_f32_16x16x32_bf16 v[128:131], a[12:15], v[48:51], v[128:131]
    ds_read_b64_tr_b16 a[44:45], v6 offset:33856
    s_waitcnt vmcnt(8)
    v_max3_u32 v11, v64, v68, v72
    v_mfma_f32_16x16x32_bf16 v[132:135], a[12:15], v[52:55], v[132:135]
    ds_read_b64_tr_b16 a[46:47], v6 offset:35392
    v_max_u32 v11, v11, v76
    v_mfma_f32_16x16x32_bf16 v[136:139], a[12:15], v[56:59], v[136:139]
    v_cmp_eq_u32 vcc, -1, v11
    v_mfma_f32_16x16x32_bf16 v[140:143], a[12:15], v[60:63], v[140:143]
    ds_write_b32 v3, v13 offset:36
    v_mfma_f32_16x16x32_bf16 v[144:147], a[16:19], v[48:51], v[144:147]
    s_cbranch_vccnz L_rxb11
L_oxb11:
    v_swap_b32 v65, v68
    v_mfma_f32_16x16x32_bf16 v[148:151], a[16:19], v[52:55], v[148:151]
    v_swap_b32 v66, v72
    v_mfma_f32_16x16x32_bf16 v[152:155], a[16:19], v[56:59], v[152:155]
    v_swap_b32 v67, v76
    v_mfma_f32_16x16x32_bf16 v[156:159], a[16:19], v[60:63], v[156:159]
    v_swap_b32 v70, v73
    v_mfma_f32_16x16x32_bf16 v[160:163], v[48:51], v[48:51], v[160:163]
    v_swap_b32 v71, v77
    v_mfma_f32_16x16x32_bf16 v[164:167], v[52:55], v[52:55], v[164:167]
    v_swap_b32 v75, v78
    v_mfma_f32_16x16x32_bf16 v[168:171], v[56:59], v[56:59], v[168:171]
    v_mfma_f32_16x16x32_bf16 v[172:175], v[60:63], v[60:63], v[172:175]
    s_waitcnt lgkmcnt(0)
    v_mfma_f32_16x16x32_bf16 v[80:83], a[24:27], v[64:67], v[80:83]
    s_add_u32 s55, s88, 14
    s_and_b32 s55, s55, 15
    v_mfma_f32_16x16x32_bf16 v[84:87], a[24:27], v[68:71], v[84:87]
    s_lshl_b32 s55, s55, 14
    s_add_u32 s96, s55, s67
    v_mfma_f32_16x16x32_bf16 v[88:91], a[24:27], v[72:75], v[88:91]
    ds_read_b64_tr_b16 a[0:1], v5 offset:36864
    buffer_load_dwordx4 v[48:51], v7, s[44:47], s96 offen offset:0 sc1
    v_mfma_f32_16x16x32_bf16 v[92:95], a[24:27], v[76:79], v[92:95]
    ds_read_b64_tr_b16 a[2:3], v5 offset:38400
    v_mfma_f32_16x16x32_bf16 v[96:99], a[28:31], v[64:67], v[96:99]
    ds_read_b64_tr_b16 a[4:5], v5 offset:36896
    buffer_load_dwordx4 v[52:55], v7, s[44:47], s96 offen offset:1024 sc1
    v_mfma_f32_16x16x32_bf16 v[100:103], a[28:31], v[68:71], v[100:103]
    ds_read_b64_tr_b16 a[6:7], v5 offset:38432
    v_mfma_f32_16x16x32_bf16 v[104:107], a[28:31], v[72:75], v[104:107]
    ds_read_b64_tr_b16 a[8:9], v5 offset:36928
    buffer_load_dwordx4 v[56:59], v7, s[44:47], s96 offen offset:2048 sc1
    v_mfma_f32_16x16x32_bf16 v[108:111], a[28:31], v[76:79], v[108:111]
    ds_read_b64_tr_b16 a[10:11], v5 offset:38464
    v_mfma_f32_16x16x32_bf16 v[112:115], a[32:35], v[64:67], v[112:115]
    ds_read_b64_tr_b16 a[12:13], v6 offset:36864
    buffer_load_dwordx4 v[60:63], v7, s[44:47], s96 offen offset:3072 sc1
    v_mfma_f32_16x16x32_bf16 v[116:119], a[32:35], v[68:71], v[116:119]
    ds_read_b64_tr_b16 a[14:15], v6 offset:38400
    v_mov_b32 v13, 12
    v_mfma_f32_16x16x32_bf16 v[120:123], a[32:35], v[72:75], v[120:123]
    ds_read_b64_tr_b16 a[16:17], v6 offset:36896
    v_mfma_f32_16x16x32_bf16 v[124:127], a[32:35], v[76:79], v[124:127]
    ds_read_b64_tr_b16 a[18:19], v6 offset:38432
    v_mfma_f32_16x16x32_bf16 v[128:131], a[36:39], v[64:67], v[128:131]
    ds_read_b64_tr_b16 a[20:21], v6 offset:36928
    s_waitcnt vmcnt(8)
    v_max3_u32 v11, v16, v20, v24
    v_mfma_f32_16x16x32_bf16 v[132:135], a[36:39], v[68:71], v[132:135]
    ds_read_b64_tr_b16 a[22:23], v6 offset:38464
    v_max_u32 v11, v11, v28
    v_mfma_f32_16x16x32_bf16 v[136:139], a[36:39], v[72:75], v[136:139]
    v_cmp_eq_u32 vcc, -1, v11
    v_mfma_f32_16x16x32_bf16 v[140:143], a[36:39], v[76:79], v[140:143]
    ds_write_b32 v3, v13 offset:36
    v_mfma_f32_16x16x32_bf16 v[144:147], a[40:43], v[64:67], v[144:147]
    s_cbranch_vccnz L_rxb12
L_oxb12:
    v_swap_b32 v17, v20
    v_mfma_f32_16x16x32_bf16 v[148:151], a[40:43], v[68:71], v[148:151]
    v_swap_b32 v18, v24
    v_mfma_f32_16x16x32_bf16 v[152:155], a[40:43], v[72:75], v[152:155]
    v_swap_b32 v19, v28
    v_mfma_f32_16x16x32_bf16 v[156:159], a[40:43], v[76:79], v[156:159]
    v_swap_b32 v22, v25
    v_mfma_f32_16x16x32_bf16 v[160:163], v[64:67], v[64:67], v[160:163]
    v_swap_b32 v23, v29
    v_mfma_f32_16x16x32_bf16 v[164:167], v[68:71], v[68:71], v[164:167]
    v_swap_b32 v27, v30
    v_mfma_f32_16x16x32_bf16 v[168:171], v[72:75], v[72:75], v[168:171]
    v_mfma_f32_16x16x32_bf16 v[172:175], v[76:79], v[76:79], v[172:175]
    s_waitcnt lgkmcnt(0)
    v_mfma_f32_16x16x32_bf16 v[80:83], a[0:3], v[16:19], v[80:83]
    s_add_u32 s55, s88, 15
    s_and_b32 s55, s55, 15
    v_mfma_f32_16x16x32_bf16 v[84:87], a[0:3], v[20:23], v[84:87]
    s_lshl_b32 s55, s55, 14
    s_add_u32 s96, s55, s67
    v_mfma_f32_16x16x32_bf16 v[88:91], a[0:3], v[24:27], v[88:91]
    ds_read_b64_tr_b16 a[24:25], v5 offset:39936
    buffer_load_dwordx4 v[64:67], v7, s[44:47], s96 offen offset:0 sc1
    v_mfma_f32_16x16x32_bf16 v[92:95], a[0:3], v[28:31], v[92:95]
    ds_read_b64_tr_b16 a[26:27], v5 offset:41472
    v_mfma_f32_16x16x32_bf16 v[96:99], a[4:7], v[16:19], v[96:99]
    ds_read_b64_tr_b16 a[28:29], v5 offset:39968
    buffer_load_dwordx4 v[68:71], v7, s[44:47], s96 offen offset:1024 sc1
    v_mfma_f32_16x16x32_bf16 v[100:103], a[4:7], v[20:23], v[100:103]
    ds_read_b64_tr_b16 a[30:31], v5 offset:41504
    v_mfma_f32_16x16x32_bf16 v[104:107], a[4:7], v[24:27], v[104:107]
    ds_read_b64_tr_b16 a[32:33], v5 offset:40000
    buffer_load_dwordx4 v[72:75], v7, s[44:47], s96 offen offset:2048 sc1
    v_mfma_f32_16x16x32_bf16 v[108:111], a[4:7], v[28:31], v[108:111]
    ds_read_b64_tr_b16 a[34:35], v5 offset:41536
    v_mfma_f32_16x16x32_bf16 v[112:115], a[8:11], v[16:19], v[112:115]
    ds_read_b64_tr_b16 a[36:37], v6 offset:39936
    buffer_load_dwordx4 v[76:79], v7, s[44:47], s96 offen offset:3072 sc1
    v_mfma_f32_16x16x32_bf16 v[116:119], a[8:11], v[20:23], v[116:119]
    ds_read_b64_tr_b16 a[38:39], v6 offset:41472
    v_mov_b32 v13, 13
    v_mfma_f32_16x16x32_bf16 v[120:123], a[8:11], v[24:27], v[120:123]
    ds_read_b64_tr_b16 a[40:41], v6 offset:39968
    v_mfma_f32_16x16x32_bf16 v[124:127], a[8:11], v[28:31], v[124:127]
    ds_read_b64_tr_b16 a[42:43], v6 offset:41504
    v_mfma_f32_16x16x32_bf16 v[128:131], a[12:15], v[16:19], v[128:131]
    ds_read_b64_tr_b16 a[44:45], v6 offset:40000
    s_waitcnt vmcnt(8)
    v_max3_u32 v11, v32, v36, v40
    v_mfma_f32_16x16x32_bf16 v[132:135], a[12:15], v[20:23], v[132:135]
    ds_read_b64_tr_b16 a[46:47], v6 offset:41536
    v_max_u32 v11, v11, v44
    v_mfma_f32_16x16x32_bf16 v[136:139], a[12:15], v[24:27], v[136:139]
    v_cmp_eq_u32 vcc, -1, v11
    v_mfma_f32_16x16x32_bf16 v[140:143], a[12:15], v[28:31], v[140:143]
    ds_write_b32 v3, v13 offset:36
    v_mfma_f32_16x16x32_bf16 v[144:147], a[16:19], v[16:19], v[144:147]
    s_cbranch_vccnz L_rxb13
L_oxb13:
    v_swap_b32 v33, v36
    v_mfma_f32_16x16x32_bf16 v[148:151], a[16:19], v[20:23], v[148:151]
    v_swap_b32 v34, v40
    v_mfma_f32_16x16x32_bf16 v[152:155], a[16:19], v[24:27], v[152:155]
    v_swap_b32 v35, v44
    v_mfma_f32_16x16x32_bf16 v[156:159], a[16:19], v[28:31], v[156:159]
    v_swap_b32 v38, v41
    v_mfma_f32_16x16x32_bf16 v[160:163], v[16:19], v[16:19], v[160:163]
    v_swap_b32 v39, v45
    v_mfma_f32_16x16x32_bf16 v[164:167], v[20:23], v[20:23], v[164:167]
    v_swap_b32 v43, v46
    v_mfma_f32_16x16x32_bf16 v[168:171], v[24:27], v[24:27], v[168:171]
    v_mfma_f32_16x16x32_bf16 v[172:175], v[28:31], v[28:31], v[172:175]
    s_waitcnt lgkmcnt(0)
    v_mfma_f32_16x16x32_bf16 v[80:83], a[24:27], v[32:35], v[80:83]
    v_mfma_f32_16x16x32_bf16 v[84:87], a[24:27], v[36:39], v[84:87]
    v_mfma_f32_16x16x32_bf16 v[88:91], a[24:27], v[40:43], v[88:91]
    ds_read_b64_tr_b16 a[0:1], v5 offset:43008
    v_mfma_f32_16x16x32_bf16 v[92:95], a[24:27], v[44:47], v[92:95]
    ds_read_b64_tr_b16 a[2:3], v5 offset:44544
    v_mfma_f32_16x16x32_bf16 v[96:99], a[28:31], v[32:35], v[96:99]
    ds_read_b64_tr_b16 a[4:5], v5 offset:43040
    v_mfma_f32_16x16x32_bf16 v[100:103], a[28:31], v[36:39], v[100:103]
    ds_read_b64_tr_b16 a[6:7], v5 offset:44576
    v_mfma_f32_16x16x32_bf16 v[104:107], a[28:31], v[40:43], v[104:107]
    ds_read_b64_tr_b16 a[8:9], v5 offset:43072
    v_mfma_f32_16x16x32_bf16 v[108:111], a[28:31], v[44:47], v[108:111]
    ds_read_b64_tr_b16 a[10:11], v5 offset:44608
    v_mfma_f32_16x16x32_bf16 v[112:115], a[32:35], v[32:35], v[112:115]
    ds_read_b64_tr_b16 a[12:13], v6 offset:43008
    v_mfma_f32_16x16x32_bf16 v[116:119], a[32:35], v[36:39], v[116:119]
    ds_read_b64_tr_b16 a[14:15], v6 offset:44544
    v_mfma_f32_16x16x32_bf16 v[120:123], a[32:35], v[40:43], v[120:123]
    ds_read_b64_tr_b16 a[16:17], v6 offset:43040
    v_mfma_f32_16x16x32_bf16 v[124:127], a[32:35], v[44:47], v[124:127]
    ds_read_b64_tr_b16 a[18:19], v6 offset:44576
    v_mfma_f32_16x16x32_bf16 v[128:131], a[36:39], v[32:35], v[128:131]
    ds_read_b64_tr_b16 a[20:21], v6 offset:43072
    s_waitcnt vmcnt(4)
    v_max3_u32 v11, v48, v52, v56
    v_mfma_f32_16x16x32_bf16 v[132:135], a[36:39], v[36:39], v[132:135]
    ds_read_b64_tr_b16 a[22:23], v6 offset:44608
    v_max_u32 v11, v11, v60
    v_mfma_f32_16x16x32_bf16 v[136:139], a[36:39], v[40:43], v[136:139]
    v_cmp_eq_u32 vcc, -1, v11
    v_mfma_f32_16x16x32_bf16 v[140:143], a[36:39], v[44:47], v[140:143]
    v_mfma_f32_16x16x32_bf16 v[144:147], a[40:43], v[32:35], v[144:147]
    s_cbranch_vccnz L_rxb14
L_oxb14:
    v_swap_b32 v49, v52
    v_mfma_f32_16x16x32_bf16 v[148:151], a[40:43], v[36:39], v[148:151]
    v_swap_b32 v50, v56
    v_mfma_f32_16x16x32_bf16 v[152:155], a[40:43], v[40:43], v[152:155]
    v_swap_b32 v51, v60
    v_mfma_f32_16x16x32_bf16 v[156:159], a[40:43], v[44:47], v[156:159]
    v_swap_b32 v54, v57
    v_mfma_f32_16x16x32_bf16 v[160:163], v[32:35], v[32:35], v[160:163]
    v_swap_b32 v55, v61
    v_mfma_f32_16x16x32_bf16 v[164:167], v[36:39], v[36:39], v[164:167]
    v_swap_b32 v59, v62
    v_mfma_f32_16x16x32_bf16 v[168:171], v[40:43], v[40:43], v[168:171]
    v_mfma_f32_16x16x32_bf16 v[172:175], v[44:47], v[44:47], v[172:175]
    s_waitcnt lgkmcnt(0)
    v_mfma_f32_16x16x32_bf16 v[80:83], a[0:3], v[48:51], v[80:83]
    v_mfma_f32_16x16x32_bf16 v[84:87], a[0:3], v[52:55], v[84:87]
    v_mfma_f32_16x16x32_bf16 v[88:91], a[0:3], v[56:59], v[88:91]
    ds_read_b64_tr_b16 a[24:25], v5 offset:46080
    v_mfma_f32_16x16x32_bf16 v[92:95], a[0:3], v[60:63], v[92:95]
    ds_read_b64_tr_b16 a[26:27], v5 offset:47616
    v_mfma_f32_16x16x32_bf16 v[96:99], a[4:7], v[48:51], v[96:99]
    ds_read_b64_tr_b16 a[28:29], v5 offset:46112
    v_mfma_f32_16x16x32_bf16 v[100:103], a[4:7], v[52:55], v[100:103]
    ds_read_b64_tr_b16 a[30:31], v5 offset:47648
    v_mfma_f32_16x16x32_bf16 v[104:107], a[4:7], v[56:59], v[104:107]
    ds_read_b64_tr_b16 a[32:33], v5 offset:46144
    v_mfma_f32_16x16x32_bf16 v[108:111], a[4:7], v[60:63], v[108:111]
    ds_read_b64_tr_b16 a[34:35], v5 offset:47680
    v_mfma_f32_16x16x32_bf16 v[112:115], a[8:11], v[48:51], v[112:115]
    ds_read_b64_tr_b16 a[36:37], v6 offset:46080
    v_mfma_f32_16x16x32_bf16 v[116:119], a[8:11], v[52:55], v[116:119]
    ds_read_b64_tr_b16 a[38:39], v6 offset:47616
    v_mfma_f32_16x16x32_bf16 v[120:123], a[8:11], v[56:59], v[120:123]
    ds_read_b64_tr_b16 a[40:41], v6 offset:46112
    v_mfma_f32_16x16x32_bf16 v[124:127], a[8:11], v[60:63], v[124:127]
    ds_read_b64_tr_b16 a[42:43], v6 offset:47648
    v_mfma_f32_16x16x32_bf16 v[128:131], a[12:15], v[48:51], v[128:131]
    ds_read_b64_tr_b16 a[44:45], v6 offset:46144
    s_waitcnt vmcnt(0)
    v_max3_u32 v11, v64, v68, v72
    v_mfma_f32_16x16x32_bf16 v[132:135], a[12:15], v[52:55], v[132:135]
    ds_read_b64_tr_b16 a[46:47], v6 offset:47680
    v_max_u32 v11, v11, v76
    v_mfma_f32_16x16x32_bf16 v[136:139], a[12:15], v[56:59], v[136:139]
    ds_read_b32 v12, v3 offset:4
    v_cmp_eq_u32 vcc, -1, v11
    v_mfma_f32_16x16x32_bf16 v[140:143], a[12:15], v[60:63], v[140:143]
    v_mfma_f32_16x16x32_bf16 v[144:147], a[16:19], v[48:51], v[144:147]
    s_cbranch_vccnz L_rxb15
L_oxb15:
    v_swap_b32 v65, v68
    v_mfma_f32_16x16x32_bf16 v[148:151], a[16:19], v[52:55], v[148:151]
    v_swap_b32 v66, v72
    v_mfma_f32_16x16x32_bf16 v[152:155], a[16:19], v[56:59], v[152:155]
    v_swap_b32 v67, v76
    v_mfma_f32_16x16x32_bf16 v[156:159], a[16:19], v[60:63], v[156:159]
    v_swap_b32 v70, v73
    v_mfma_f32_16x16x32_bf16 v[160:163], v[48:51], v[48:51], v[160:163]
    v_swap_b32 v71, v77
    v_mfma_f32_16x16x32_bf16 v[164:167], v[52:55], v[52:55], v[164:167]
    v_swap_b32 v75, v78
    v_mfma_f32_16x16x32_bf16 v[168:171], v[56:59], v[56:59], v[168:171]
    v_mfma_f32_16x16x32_bf16 v[172:175], v[60:63], v[60:63], v[172:175]
    s_waitcnt lgkmcnt(0)
    v_cmp_ne_u32 vcc, 4, v12
    v_mfma_f32_16x16x32_bf16 v[112:115], a[32:35], v[64:67], v[112:115]
    v_mfma_f32_16x16x32_bf16 v[116:119], a[32:35], v[68:71], v[116:119]
    s_cbranch_vccnz L_rfb15
L_ofb15:
    v_mfma_f32_16x16x32_bf16 v[120:123], a[32:35], v[72:75], v[120:123]
    ds_read_b128 v[40:43], v8 offset:0
    v_mfma_f32_16x16x32_bf16 v[124:127], a[32:35], v[76:79], v[124:127]
    ds_read_b128 v[44:47], v8 offset:64
    v_mfma_f32_16x16x32_bf16 v[80:83], a[24:27], v[64:67], v[80:83]
    ds_read_b128 v[48:51], v8 offset:128
    v_mfma_f32_16x16x32_bf16 v[84:87], a[24:27], v[68:71], v[84:87]
    ds_read_b128 v[52:55], v8 offset:192
    v_mfma_f32_16x16x32_bf16 v[88:91], a[24:27], v[72:75], v[88:91]
    ds_read_b128 v[56:59], v8 offset:256
    v_mfma_f32_16x16x32_bf16 v[92:95], a[24:27], v[76:79], v[92:95]
    ds_read_b128 v[60:63], v8 offset:320
    v_mfma_f32_16x16x32_bf16 v[128:131], a[36:39], v[64:67], v[128:131]
    ds_bpermute_b32 v32, v10, v112
    v_mfma_f32_16x16x32_bf16 v[132:135], a[36:39], v[68:71], v[132:135]
    ds_bpermute_b32 v34, v10, v116
    v_mfma_f32_16x16x32_bf16 v[136:139], a[36:39], v[72:75], v[136:139]
    ds_bpermute_b32 v36, v10, v120
    v_mfma_f32_16x16x32_bf16 v[140:143], a[36:39], v[76:79], v[140:143]
    ds_bpermute_b32 v38, v10, v124
    v_mfma_f32_16x16x32_bf16 v[96:99], a[28:31], v[64:67], v[96:99]
    v_mfma_f32_16x16x32_bf16 v[100:103], a[28:31], v[68:71], v[100:103]
    v_mfma_f32_16x16x32_bf16 v[104:107], a[28:31], v[72:75], v[104:107]
    s_mov_b32 s57, 0xbb000000
    s_waitcnt lgkmcnt(0)
    v_mul_f32 v32, s57, v32
    v_mul_f32 v34, s57, v34
    v_mfma_f32_16x16x32_bf16 v[108:111], a[28:31], v[76:79], v[108:111]
    v_mul_f32 v36, s57, v36
    v_mul_f32 v38, s57, v38
    v_mfma_f32_16x16x32_bf16 v[144:147], a[40:43], v[64:67], v[144:147]
    v_pk_fma_f32 v[80:81], v[40:41], v[32:33], v[80:81] op_sel_hi:[1,0,1]
    v_pk_fma_f32 v[82:83], v[42:43], v[32:33], v[82:83] op_sel_hi:[1,0,1]
    v_mfma_f32_16x16x32_bf16 v[148:151], a[40:43], v[68:71], v[148:151]
    v_pk_fma_f32 v[128:129], v[52:53], v[32:33], v[128:129] op_sel_hi:[1,0,1]
    v_pk_fma_f32 v[130:131], v[54:55], v[32:33], v[130:131] op_sel_hi:[1,0,1]
    v_mfma_f32_16x16x32_bf16 v[152:155], a[40:43], v[72:75], v[152:155]
    v_max_f32 v80, 0, v80
    v_max_f32 v81, 0, v81
    v_mfma_f32_16x16x32_bf16 v[156:159], a[40:43], v[76:79], v[156:159]
    v_max_f32 v82, 0, v82
    v_max_f32 v83, 0, v83
    v_mfma_f32_16x16x32_bf16 v[160:163], v[64:67], v[64:67], v[160:163]
    v_pk_mul_f32 v[80:81], v[80:81], v[128:129]
    v_pk_mul_f32 v[82:83], v[82:83], v[130:131]
    v_mfma_f32_16x16x32_bf16 v[164:167], v[68:71], v[68:71], v[164:167]
    v_cvt_pk_bf16_f32 v16, v80, v81
    v_cvt_pk_bf16_f32 v17, v82, v83
    v_mfma_f32_16x16x32_bf16 v[168:171], v[72:75], v[72:75], v[168:171]
    v_pk_fma_f32 v[84:85], v[40:41], v[34:35], v[84:85] op_sel_hi:[1,0,1]
    v_pk_fma_f32 v[86:87], v[42:43], v[34:35], v[86:87] op_sel_hi:[1,0,1]
    v_mfma_f32_16x16x32_bf16 v[172:175], v[76:79], v[76:79], v[172:175]
    v_pk_fma_f32 v[132:133], v[52:53], v[34:35], v[132:133] op_sel_hi:[1,0,1]
    v_pk_fma_f32 v[134:135], v[54:55], v[34:35], v[134:135] op_sel_hi:[1,0,1]
    s_nop 7
    v_and_b32 v10, 3, v2
    v_mov_b32 v72, v160
    v_mov_b32 v73, v164
    v_mov_b32 v74, v168
    v_mov_b32 v75, v172
    v_cmp_eq_u32 vcc, 1, v10
    s_nop 1
    v_cndmask_b32 v72, v72, v161, vcc
    v_cndmask_b32 v73, v73, v165, vcc
    v_cndmask_b32 v74, v74, v169, vcc
    v_cndmask_b32 v75, v75, v173, vcc
    v_cmp_eq_u32 vcc, 2, v10
    s_nop 1
    v_cndmask_b32 v72, v72, v162, vcc
    v_cndmask_b32 v73, v73, v166, vcc
    v_cndmask_b32 v74, v74, v170, vcc
    v_cndmask_b32 v75, v75, v174, vcc
    v_cmp_eq_u32 vcc, 3, v10
    s_nop 1
    v_cndmask_b32 v72, v72, v163, vcc
    v_cndmask_b32 v73, v73, v167, vcc
    v_cndmask_b32 v74, v74, v171, vcc
    v_cndmask_b32 v75, v75, v175, vcc
    s_mov_b32 s56, 0x3b000000
    s_mov_b32 s57, 0x3727c5ac
    v_mul_f32 v72, s56, v72
    v_mul_f32 v73, s56, v73
    v_mul_f32 v74, s56, v74
    v_mul_f32 v75, s56, v75
    v_fma_f32 v72, -v32, v32, v72
    v_fma_f32 v73, -v34, v34, v73
    v_fma_f32 v74, -v36, v36, v74
    v_fma_f32 v75, -v38, v38, v75
    v_max_f32 v72, 0, v72
    v_max_f32 v73, 0, v73
    v_max_f32 v74, 0, v74
    v_max_f32 v75, 0, v75
    v_add_f32 v72, s57, v72
    v_add_f32 v73, s57, v73
    v_add_f32 v74, s57, v74
    v_add_f32 v75, s57, v75
    v_rcp_f32 v72, v72
    v_rcp_f32 v73, v73
    v_rcp_f32 v74, v74
    v_rcp_f32 v75, v75
    s_nop 0
    buffer_store_dwordx4 v[72:75], v179, s[44:47], s91 offen sc0 sc1
    s_branch L_p2join
L_B:
    s_setprio 1
    s_load_dword s84, s[44:45], 0
    s_lshl_b32 s56, s66, 2
    s_load_dword s54, s[18:19], s56
    s_load_dwordx2 s[36:37], s[0:1], 72
    s_load_dwordx2 s[28:29], s[0:1], 56
    s_load_dwordx2 s[32:33], s[0:1], 64
    s_load_dwordx2 s[40:41], s[0:1], 80
    s_mov_b32 s85, 200000
    s_mov_b32 s65, 0xffff0000
    s_mov_b32 s46, 20971520
    s_mov_b32 s47, 0x20000
    s_mov_b32 s38, 1409024
    s_mov_b32 s39, 0x20000
    s_mov_b32 s42, 2097152
    s_mov_b32 s43, 0x20000
    s_mov_b32 s50, 1409024
    s_mov_b32 s51, 0x20000
    s_lshr_b32 s55, s66, 4
    s_lshl_b32 s72, s55, 14
    s_and_b32 s55, s66, 3
    s_lshl_b32 s55, s55, 10
    s_add_u32 s72, s72, s55
    s_bfe_u32 s55, s66, 0x20002
    s_lshl_b32 s55, s55, 8
    s_add_u32 s72, s72, s55
    s_lshl_b32 s55, s3, 19
    s_add_u32 s72, s72, s55
    s_add_u32 s72, s72, 7340032
    s_add_u32 s73, s72, 0x40000
    v_lshlrev_b32 v63, 4, v2
    v_lshl_add_u32 v63, v4, 12, v63
    v_mov_b32 v64, -1
    v_mov_b32 v65, -1
    v_mov_b32 v66, -1
    v_mov_b32 v67, -1
    buffer_store_dwordx4 v[64:67], v63, s[44:47], s72 offen sc0 sc1
    buffer_store_dwordx4 v[64:67], v63, s[44:47], s73 offen sc0 sc1
    v_and_b32 v13, 7, v1
    v_lshrrev_b32 v12, 3, v1
    v_mul_u32_u24 v12, 33024, v12
    v_lshl_add_u32 v12, v13, 4, v12
    s_lshl_b32 s55, s2, 7
    s_add_u32 s55, s55, 524288
    s_cmp_lg_u32 s3, 0
    s_cselect_b32 s55, 0x40000000, s55
    buffer_store_dwordx4 v[40:43], v12, s[44:47], s55 offen sc0 sc1
    s_lshr_b32 s55, s4, 2
    s_lshl_b32 s55, s55, 2
    s_and_b32 s60, s5, 3
    s_add_u32 s86, s55, s60
    s_and_b32 s55, s4, 3
    s_mul_i32 s55, s55, 8
    s_lshr_b32 s56, s5, 2
    s_add_u32 s87, s55, s56
    s_mul_i32 s88, s56, 0
    s_mul_i32 s60, s60, 4
    s_add_u32 s88, s88, s60
    s_and_b32 s88, s88, 15
    v_and_b32 v6, 7, v1
    v_xor_b32 v5, s98, v6
    v_lshlrev_b32 v5, 4, v5
    v_lshl_add_u32 v5, v1, 7, v5
    s_lshl_b32 s55, s99, 3
    s_add_u32 s55, s55, 90112
    v_add_u32 v5, s55, v5
    v_lshrrev_b32 v7, 3, v1
    s_mov_b32 s55, 33024
    v_mul_lo_u32 v8, v7, s55
    v_lshl_add_u32 v8, v6, 4, v8
    v_xor_b32 v6, v6, v7
    v_lshlrev_b32 v6, 4, v6
    v_lshl_add_u32 v6, v7, 7, v6
    s_lshl_b32 s55, s3, 11
    s_add_u32 s55, s55, 90112
    v_add_u32 v6, s55, v6
    v_xor_b32 v16, 32, v5
    v_xor_b32 v17, 64, v5
    v_xor_b32 v18, 0x60, v5
    s_mul_i32 s55, s3, 4224
    s_add_u32 s55, s55, 135424
    v_and_b32 v12, 7, v1
    v_lshl_add_u32 v12, v12, 4, s55
    ds_write_b128 v12, v[40:43]
    s_cmp_lg_u32 s99, 0
    s_cbranch_scc1 L_nohead
    v_and_b32 v12, 31, v1
    v_lshlrev_b32 v12, 4, v12
    v_lshrrev_b32 v13, 5, v1
    s_movk_i32 s56, 4640
    v_mad_u32_u24 v12, v13, s56, v12
    s_mul_i32 s55, s98, 18560
    s_add_u32 s55, s55, 98304
    v_add_u32 v12, s55, v12
    ds_write_b128 v12, v[40:43]
    ds_write_b128 v12, v[40:43] offset:9280
L_nohead:
    s_mul_i32 s55, s3, 528384
    s_lshl_b32 s56, s2, 7
    s_add_u32 s55, s55, s56
    s_add_u32 s95, s55, 3145728
    s_add_u32 s97, s95, 264192
    s_movk_i32 s55, 0x2aab
    s_movk_i32 s56, 2752
    v_add_u32 v14, 0, v1
    v_mul_u32_u24 v3, s55, v14
    v_lshrrev_b32 v3, 16, v3
    v_mul_u32_u24 v13, 6, v3
    v_sub_u32 v14, v14, v13
    v_bfe_u32 v13, v3, 2, 2
    v_lshlrev_b32 v13, 3, v13
    v_lshrrev_b32 v12, 4, v3
    v_lshl_add_u32 v13, v12, 2, v13
    v_and_b32 v3, 3, v3
    v_add_u32 v13, v13, v3
    v_mul_u32_u24 v13, s56, v13
    v_lshl_add_u32 v60, v14, 4, v13
    v_add_u32 v14, 64, v1
    v_mul_u32_u24 v3, s55, v14
    v_lshrrev_b32 v3, 16, v3
    v_mul_u32_u24 v13, 6, v3
    v_sub_u32 v14, v14, v13
    v_bfe_u32 v13, v3, 2, 2
    v_lshlrev_b32 v13, 3, v13
    v_lshrrev_b32 v12, 4, v3
    v_lshl_add_u32 v13, v12, 2, v13
    v_and_b32 v3, 3, v3
    v_add_u32 v13, v13, v3
    v_mul_u32_u24 v13, s56, v13
    v_lshl_add_u32 v61, v14, 4, v13
    v_add_u32 v14, 128, v1
    v_mul_u32_u24 v3, s55, v14
    v_lshrrev_b32 v3, 16, v3
    v_mul_u32_u24 v13, 6, v3
    v_sub_u32 v14, v14, v13
    v_bfe_u32 v13, v3, 2, 2
    v_lshlrev_b32 v13, 3, v13
    v_lshrrev_b32 v12, 4, v3
    v_lshl_add_u32 v13, v12, 2, v13
    v_and_b32 v3, 3, v3
    v_add_u32 v13, v13, v3
    v_mul_u32_u24 v13, s56, v13
    v_lshl_add_u32 v62, v14, 4, v13
    s_waitcnt lgkmcnt(0)
    s_bitcmp1_b32 s3, 0
    s_cselect_b32 s48, s32, s28
    s_cselect_b32 s49, s33, s29
    s_add_u32 s69, s88, s98
    s_mul_i32 s70, s87, 88
    s_mul_i32 s76, s99, 49152
    s_mul_i32 s56, s98, 3072
    s_add_u32 s76, s76, s56
    s_mul_i32 s56, s98, 18560
    s_lshl_b32 s57, s99, 11
    s_add_u32 s56, s56, s57
    s_add_u32 s56, s56, 98812
    v_add_u32 v44, s56, v9
    v_add_u32 v45, 4636, v44
    v_add_u32 v46, 9272, v44
    v_add_u32 v47, 13908, v44
    v_mov_b32 v3, 152704
    s_lshl_b32 s55, s2, 1
    s_add_u32 s55, s55, s98
    s_mul_i32 s55, s55, 2752
    v_lshlrev_b32 v12, 7, v1
    s_mov_b64 exec, 0x3fffff
    buffer_load_dword v11, v12, s[48:51], s55 offen
    s_mov_b64 exec, -1
    v_mov_b32 v21, 0x3f803f80
    s_waitcnt vmcnt(6)
    ds_write2_b32 v5, v32, v36 offset0:0 offset1:1
    ds_write2_b32 v16, v33, v37 offset0:0 offset1:1
    ds_write2_b32 v17, v34, v38 offset0:0 offset1:1
    ds_write2_b32 v18, v35, v39 offset0:0 offset1:1
    v_mov_b32 v14, 1
    s_waitcnt lgkmcnt(0)
    s_mov_b64 exec, 1
    ds_add_u32 v3, v14 offset:20
    s_mov_b64 exec, -1
    s_add_u32 s84, s84, 1
    s_or_b32 s84, s84, 0x80000000
    v_dot2c_f32_bf16 v42, v32, v21
    v_dot2c_f32_bf16 v40, v32, v32
    v_dot2c_f32_bf16 v43, v36, v21
    v_dot2c_f32_bf16 v41, v36, v36
    v_dot2c_f32_bf16 v42, v33, v21
    v_dot2c_f32_bf16 v40, v33, v33
    v_dot2c_f32_bf16 v43, v37, v21
    v_dot2c_f32_bf16 v41, v37, v37
    v_dot2c_f32_bf16 v42, v34, v21
    v_dot2c_f32_bf16 v40, v34, v34
    v_dot2c_f32_bf16 v43, v38, v21
    v_dot2c_f32_bf16 v41, v38, v38
    v_dot2c_f32_bf16 v42, v35, v21
    v_dot2c_f32_bf16 v40, v35, v35
    v_dot2c_f32_bf16 v43, v39, v21
    v_dot2c_f32_bf16 v41, v39, v39
    s_nop 0
    v_add_f32_dpp v40, v40, v40 row_shr:1
    s_nop 0
    v_add_f32_dpp v41, v41, v41 row_shr:1
    v_add_f32_dpp v42, v42, v42 row_shr:1
    v_add_f32_dpp v43, v43, v43 row_shr:1
    v_add_f32_dpp v40, v40, v40 row_shr:2
    v_add_f32_dpp v41, v41, v41 row_shr:2
    v_add_f32_dpp v42, v42, v42 row_shr:2
    v_add_f32_dpp v43, v43, v43 row_shr:2
    v_add_f32_dpp v40, v40, v40 row_shr:4
    v_add_f32_dpp v41, v41, v41 row_shr:4
    v_add_f32_dpp v42, v42, v42 row_shr:4
    v_add_f32_dpp v43, v43, v43 row_shr:4
    v_add_f32_dpp v40, v40, v40 row_shr:8
    v_add_f32_dpp v41, v41, v41 row_shr:8
    v_add_f32_dpp v42, v42, v42 row_shr:8
    v_add_f32_dpp v43, v43, v43 row_shr:8
    v_add_f32_dpp v40, v40, v40 row_bcast:15 row_mask:0xa
    v_add_f32_dpp v41, v41, v41 row_bcast:15 row_mask:0xa
    v_add_f32_dpp v42, v42, v42 row_bcast:15 row_mask:0xa
    v_add_f32_dpp v43, v43, v43 row_bcast:15 row_mask:0xa
    v_add_f32_dpp v40, v40, v40 row_bcast:31 row_mask:0xc
    v_add_f32_dpp v41, v41, v41 row_bcast:31 row_mask:0xc
    v_add_f32_dpp v42, v42, v42 row_bcast:31 row_mask:0xc
    v_add_f32_dpp v43, v43, v43 row_bcast:31 row_mask:0xc
    s_mov_b32 s56, 0x3b000000
    s_mov_b32 s57, 0x3727c5ac
    v_mul_f32 v40, s56, v40
    v_mul_f32 v41, s56, v41
    v_mul_f32 v42, s56, v42
    v_mul_f32 v43, s56, v43
    v_fma_f32 v40, -v42, v42, v40
    v_fma_f32 v41, -v43, v43, v41
    v_max_f32 v40, 0, v40
    v_max_f32 v41, 0, v41
    v_add_f32 v40, s57, v40
    v_add_f32 v41, s57, v41
    v_rsq_f32 v40, v40
    v_rsq_f32 v41, v41
    v_mul_f32_e64 v42, -v42, v40
    v_mul_f32_e64 v43, -v43, v41
    v_mov_b32 v19, v6
    v_mov_b32 v20, v8
    ds_read2_b32 v[12:13], v3 offset0:5 offset1:5
    s_waitcnt lgkmcnt(0)
    v_add_u32 v12, v12, v13
    v_cmp_ne_u32 vcc, 8, v12
    s_cbranch_vccnz L_rqw
L_oqw:
    ds_read_b128 v[48:51], v19
    ds_read_b128 v[52:55], v19 offset:1024
    s_waitcnt lgkmcnt(1)
    buffer_store_dwordx4 v[48:51], v20, s[44:47], s95 offen sc0 sc1
    s_waitcnt lgkmcnt(0)
    buffer_store_dwordx4 v[52:55], v20, s[44:47], s97 offen sc0 sc1
    s_waitcnt vmcnt(6)
    ds_write2_b32 v44, v24, v25 offset0:0 offset1:1
    ds_write2_b32 v44, v26, v27 offset0:2 offset1:3
    ds_write2_b32 v46, v24, v25 offset0:0 offset1:1
    ds_write2_b32 v46, v26, v27 offset0:2 offset1:3
    ds_write2_b64 v45, v[24:25], v[26:27] offset0:0 offset1:1
    ds_write_b128 v47, v[24:27] offset:0
    v_add_u32 v44, 0x400, v44
    v_add_u32 v46, 0x400, v46
    ds_write2_b32 v44, v28, v29 offset0:0 offset1:1
    ds_write2_b32 v44, v30, v31 offset0:2 offset1:3
    ds_write2_b32 v46, v28, v29 offset0:0 offset1:1
    ds_write2_b32 v46, v30, v31 offset0:2 offset1:3
    ds_write2_b64 v45, v[28:29], v[30:31] offset0:128 offset1:129
    ds_write_b128 v47, v[28:31] offset:1024
    v_mov_b32 v14, 1
    s_mov_b64 exec, 1
    ds_add_u32 v3, v14 offset:40
    s_mov_b64 exec, -1
    s_lshl_b32 s55, s3, 4
    s_add_u32 s55, s55, 152768
    v_mov_b32 v12, s55
    v_mov_b32 v13, 152704
    v_mov_b32 v14, 1
    s_mov_b32 exec_lo, 0
    s_mov_b32 exec_hi, 0x80000000
    ds_write_b128 v12, v[40:43]
    s_waitcnt vmcnt(0) lgkmcnt(0)
    ds_add_rtn_u32 v14, v13, v14 offset:8
    s_waitcnt lgkmcnt(0)
    v_readfirstlane_b32 s55, v14
    s_mov_b64 exec, -1
    s_cmp_lg_u32 s55, 3
    s_cbranch_scc1 L_nost
    v_and_b32 v12, 3, v1
    v_lshlrev_b32 v12, 4, v12
    v_add_u32 v12, 152768, v12
    ds_read_b128 v[40:43], v12
    v_and_b32 v13, 7, v1
    v_cmp_lt_u32 vcc, 3, v13
    v_mov_b32 v14, s84
    s_nop 0
    v_cndmask_b32 v14, 0, v14, vcc
    v_lshrrev_b32 v12, 3, v1
    v_mul_u32_u24 v12, 33024, v12
    v_lshl_add_u32 v12, v13, 4, v12
    s_lshl_b32 s55, s2, 7
    s_add_u32 s55, s55, 524288
    s_waitcnt lgkmcnt(0)
    v_xor_b32 v40, v14, v40
    v_xor_b32 v41, v14, v41
    v_xor_b32 v42, v14, v42
    v_xor_b32 v43, v14, v43
    s_mov_b64 exec, -1
    buffer_store_dwordx4 v[40:43], v12, s[44:47], s55 offen sc0 sc1
    s_mov_b64 exec, -1
L_nost:
    s_and_b32 s55, s54, 0xffff
    s_lshr_b32 s56, s54, 16
    v_mov_b32 v13, s55
    v_mov_b32 v14, s56
    v_lshl_add_u32 v12, v4, 2, 3
    v_sub_u32 v12, v12, v2
    v_cmp_eq_u32 vcc, 0, v12
    s_nop 1
    v_cndmask_b32 v72, 0, v13, vcc
    v_cndmask_b32 v76, 0, v14, vcc
    v_cmp_eq_u32 vcc, 1, v12
    s_nop 1
    v_cndmask_b32 v73, 0, v13, vcc
    v_cndmask_b32 v77, 0, v14, vcc
    v_cmp_eq_u32 vcc, 2, v12
    s_nop 1
    v_cndmask_b32 v74, 0, v13, vcc
    v_cndmask_b32 v78, 0, v14, vcc
    v_cmp_eq_u32 vcc, 3, v12
    s_nop 1
    v_cndmask_b32 v75, 0, v13, vcc
    v_cndmask_b32 v79, 0, v14, vcc
    v_and_b32 v5, 1, v2
    s_movk_i32 s55, 4224
    v_mul_lo_u32 v5, v5, s55
    v_lshrrev_b32 v14, 1, v2
    v_lshl_add_u32 v5, v14, 4, v5
    v_lshl_add_u32 v5, v4, 7, v5
    s_lshl_b32 s56, s3, 10
    s_add_u32 s56, s56, 135552
    v_add_u32 v5, s56, v5
    s_lshl_b32 s56, s3, 11
    s_add_u32 s57, s56, 98304
    v_add_u32 v6, s57, v9
    v_add_u32 v7, 16384, v6
    s_lshr_b32 s68, s66, 2
    s_mul_i32 s68, s68, 33024
    s_and_b32 s57, s66, 3
    s_lshl_b32 s57, s57, 5
    s_add_u32 s68, s68, s57
    s_lshl_b32 s58, s3, 13
    s_add_u32 s68, s68, s58
    s_add_u32 s68, s68, 3145728
    s_add_u32 s60, s68, 0x1000
    s_add_u32 s58, s58, 524288
    s_mul_i32 s57, s4, 33024
    s_add_u32 s58, s58, s57
    s_add_u32 s59, s58, 0x1000
    v_lshrrev_b32 v8, 1, v1
    v_lshlrev_b32 v8, 7, v8
    v_and_b32 v14, 1, v1
    v_lshl_add_u32 v10, v14, 4, v8
    v_lshl_add_u32 v8, v14, 5, v8
    s_mul_i32 s61, s99, 49152
    s_lshl_b32 s57, s98, 13
    s_add_u32 s61, s61, s57
    s_add_u32 s61, s61, 0x8000
    v_lshlrev_b32 v14, 3, v1
    v_and_b32 v14, 0x70, v14
    v_xor_b32 v8, v8, v14
    v_add_u32 v8, s61, v8
    v_xor_b32 v57, 16, v8
    v_xor_b32 v58, 64, v8
    v_xor_b32 v59, 0x50, v8
    v_lshlrev_b32 v14, 1, v1
    v_and_b32 v14, 0x70, v14
    v_xor_b32 v56, v9, v14
    ds_read_b32 v12, v3 offset:24
    s_waitcnt lgkmcnt(0)
    v_cmp_ne_u32 vcc, 4, v12
    s_cbranch_vccnz L_ruw
L_ouw:
    s_and_b32 s77, s69, 15
    s_mul_i32 s77, s77, 88064
    s_add_u32 s77, s77, s70
    s_add_u32 s69, s69, 2
    s_add_u32 m0, s76, 0
    s_nop 0
    buffer_load_dwordx4 v60, s[48:51], s77 offen  lds
    s_add_u32 m0, s76, 1024
    s_nop 0
    buffer_load_dwordx4 v61, s[48:51], s77 offen  lds
    s_add_u32 m0, s76, 2048
    s_nop 0
    buffer_load_dwordx4 v62, s[48:51], s77 offen  lds
    s_and_b32 s77, s69, 15
    s_mul_i32 s77, s77, 88064
    s_add_u32 s77, s77, s70
    s_add_u32 s69, s69, 2
    s_add_u32 m0, s76, 6144
    s_nop 0
    buffer_load_dwordx4 v60, s[48:51], s77 offen  lds
    s_add_u32 m0, s76, 7168
    s_nop 0
    buffer_load_dwordx4 v61, s[48:51], s77 offen  lds
    s_add_u32 m0, s76, 8192
    s_nop 0
    buffer_load_dwordx4 v62, s[48:51], s77 offen  lds
    s_lshl_b32 s55, s2, 2
    s_add_u32 s55, s55, s3
    s_mul_i32 s55, s55, 1408
    v_lshlrev_b32 v12, 7, v1
    s_mov_b64 exec, 0x7ff
    buffer_load_dword v11, v12, s[36:39], s55 offen
    s_mov_b64 exec, -1
    ds_read_b32 v12, v3 offset:40
    s_waitcnt lgkmcnt(0)
    v_cmp_ne_u32 vcc, 8, v12
    s_cbranch_vccnz L_rb4b
L_ob4b:
    ds_read_b128 v[80:83], v5 offset:0
    ds_read_b128 v[84:87], v5 offset:8448
    ds_read_b128 v[88:91], v5 offset:512
    ds_read_b128 v[92:95], v5 offset:8960
    s_waitcnt lgkmcnt(0)
    v_mfma_f32_16x16x32_bf16 v[96:99], v[72:75], v[80:83], 0
    v_mfma_f32_16x16x32_bf16 v[100:103], v[76:79], v[84:87], 0
    v_mfma_f32_16x16x32_bf16 v[104:107], v[72:75], v[88:91], 0
    v_mfma_f32_16x16x32_bf16 v[108:111], v[76:79], v[92:95], 0
    s_mov_b32 m0, s61
    s_nop 0
    buffer_load_dwordx4 v56, s[44:47], s58 offen offset:0 sc1 lds
    buffer_load_dwordx4 v56, s[44:47], s58 offen offset:1024 sc1 lds
    buffer_load_dwordx4 v56, s[44:47], s58 offen offset:2048 sc1 lds
    buffer_load_dwordx4 v56, s[44:47], s58 offen offset:3072 sc1 lds
    s_add_u32 m0, s61, 0x1000
    s_nop 0
    buffer_load_dwordx4 v56, s[44:47], s59 offen offset:0 sc1 lds
    buffer_load_dwordx4 v56, s[44:47], s59 offen offset:1024 sc1 lds
    buffer_load_dwordx4 v56, s[44:47], s59 offen offset:2048 sc1 lds
    buffer_load_dwordx4 v56, s[44:47], s59 offen offset:3072 sc1 lds
    s_and_b32 s77, s69, 15
    s_mul_i32 s77, s77, 88064
    s_add_u32 s77, s77, s70
    s_add_u32 s69, s69, 2
    s_add_u32 m0, s76, 12288
    s_nop 0
    buffer_load_dwordx4 v60, s[48:51], s77 offen  lds
    s_add_u32 m0, s76, 13312
    s_nop 0
    buffer_load_dwordx4 v61, s[48:51], s77 offen  lds
    s_add_u32 m0, s76, 14336
    s_nop 0
    buffer_load_dwordx4 v62, s[48:51], s77 offen  lds
    s_waitcnt vmcnt(3)
    ds_read_b128 v[16:19], v8 offset:0
    ds_read_b128 v[32:35], v58 offset:0
    ds_read_b128 v[20:23], v57 offset:0
    ds_read_b128 v[36:39], v59 offset:0
    ds_read_b128 v[24:27], v8 offset:4096
    ds_read_b128 v[40:43], v58 offset:4096
    ds_read_b128 v[28:31], v57 offset:4096
    ds_read_b128 v[44:47], v59 offset:4096
    s_waitcnt lgkmcnt(0)
    v_bitop3_b32 v32, v32, v16, s84 bitop3:0x96
    v_bitop3_b32 v33, v33, v17, s84 bitop3:0x96
    v_bitop3_b32 v34, v34, v18, s84 bitop3:0x96
    v_bitop3_b32 v35, v35, v19, s84 bitop3:0x96
    v_bitop3_b32 v36, v36, v20, s84 bitop3:0x96
    v_bitop3_b32 v37, v37, v21, s84 bitop3:0x96
    v_bitop3_b32 v38, v38, v22, s84 bitop3:0x96
    v_bitop3_b32 v39, v39, v23, s84 bitop3:0x96
    v_bitop3_b32 v40, v40, v24, s84 bitop3:0x96
    v_bitop3_b32 v41, v41, v25, s84 bitop3:0x96
    v_bitop3_b32 v42, v42, v26, s84 bitop3:0x96
    v_bitop3_b32 v43, v43, v27, s84 bitop3:0x96
    v_bitop3_b32 v44, v44, v28, s84 bitop3:0x96
    v_bitop3_b32 v45, v45, v29, s84 bitop3:0x96
    v_bitop3_b32 v46, v46, v30, s84 bitop3:0x96
    v_bitop3_b32 v47, v47, v31, s84 bitop3:0x96
    v_or3_b32 v32, v32, v33, v34
    v_or3_b32 v35, v35, v36, v37
    v_or3_b32 v38, v38, v39, v40
    v_or3_b32 v41, v41, v42, v43
    v_or3_b32 v44, v44, v45, v46
    v_or3_b32 v32, v32, v35, v38
    v_or3_b32 v41, v41, v44, v47
    v_or_b32 v32, v32, v41
    v_cmp_ne_u32 vcc, 0, v32
    s_cbranch_vccnz L_rst
L_ost:
    buffer_load_dwordx4 v[48:51], v10, s[44:47], s68 offen sc1
    buffer_load_dwordx4 v[52:55], v10, s[44:47], s60 offen sc1
    s_and_b32 s77, s69, 15
    s_mul_i32 s77, s77, 88064
    s_add_u32 s77, s77, s70
    s_add_u32 s69, s69, 2
    s_add_u32 m0, s76, 18432
    s_nop 0
    buffer_load_dwordx4 v60, s[48:51], s77 offen  lds
    s_add_u32 m0, s76, 19456
    s_nop 0
    buffer_load_dwordx4 v61, s[48:51], s77 offen  lds
    s_add_u32 m0, s76, 20480
    s_nop 0
    buffer_load_dwordx4 v62, s[48:51], s77 offen  lds
    s_and_b32 s77, s69, 15
    s_mul_i32 s77, s77, 88064
    s_add_u32 s77, s77, s70
    s_add_u32 s69, s69, 2
    s_add_u32 m0, s76, 24576
    s_nop 0
    buffer_load_dwordx4 v60, s[48:51], s77 offen  lds
    s_add_u32 m0, s76, 25600
    s_nop 0
    buffer_load_dwordx4 v61, s[48:51], s77 offen  lds
    s_add_u32 m0, s76, 26624
    s_nop 0
    buffer_load_dwordx4 v62, s[48:51], s77 offen  lds
    s_waitcnt vmcnt(6)
    v_lshlrev_b32 v112, 16, v48
    v_and_b32 v116, s65, v48
    v_lshlrev_b32 v113, 16, v49
    v_and_b32 v117, s65, v49
    v_lshlrev_b32 v114, 16, v50
    v_and_b32 v118, s65, v50
    v_lshlrev_b32 v115, 16, v51
    v_and_b32 v119, s65, v51
    v_lshlrev_b32 v120, 16, v52
    v_and_b32 v124, s65, v52
    v_lshlrev_b32 v121, 16, v53
    v_and_b32 v125, s65, v53
    v_lshlrev_b32 v122, 16, v54
    v_and_b32 v126, s65, v54
    v_lshlrev_b32 v123, 16, v55
    v_and_b32 v127, s65, v55
    v_pk_fma_f32 v[128:129], v[112:113], v[16:17], v[18:19]
    v_pk_fma_f32 v[130:131], v[114:115], v[20:21], v[22:23]
    v_pk_fma_f32 v[132:133], v[116:117], v[16:17], v[18:19]
    v_pk_fma_f32 v[134:135], v[118:119], v[20:21], v[22:23]
    v_pk_fma_f32 v[136:137], v[120:121], v[24:25], v[26:27]
    v_pk_fma_f32 v[138:139], v[122:123], v[28:29], v[30:31]
    v_pk_fma_f32 v[140:141], v[124:125], v[24:25], v[26:27]
    v_pk_fma_f32 v[142:143], v[126:127], v[28:29], v[30:31]
    s_barrier
    ds_read_b128 v[16:19], v6 offset:0
    ds_read_b128 v[20:23], v6 offset:8192
    ds_read_b128 v[24:27], v7 offset:0
    ds_read_b128 v[28:31], v7 offset:8192
    ds_read_b128 v[32:35], v6 offset:1024
    ds_read_b128 v[36:39], v6 offset:9216
    ds_read_b128 v[40:43], v7 offset:1024
    ds_read_b128 v[44:47], v7 offset:9216
    s_waitcnt lgkmcnt(6)
    v_pk_add_f32 v[96:97], v[96:97], v[16:17]
    v_pk_add_f32 v[98:99], v[98:99], v[18:19]
    v_pk_add_f32 v[96:97], v[96:97], v[20:21]
    v_pk_add_f32 v[98:99], v[98:99], v[22:23]
    v_pk_fma_f32 v[96:97], v[96:97], v[128:129], v[112:113]
    v_pk_fma_f32 v[98:99], v[98:99], v[130:131], v[114:115]
    s_waitcnt lgkmcnt(4)
    v_pk_add_f32 v[100:101], v[100:101], v[24:25]
    v_pk_add_f32 v[102:103], v[102:103], v[26:27]
    v_pk_add_f32 v[100:101], v[100:101], v[28:29]
    v_pk_add_f32 v[102:103], v[102:103], v[30:31]
    v_pk_fma_f32 v[100:101], v[100:101], v[132:133], v[116:117]
    v_pk_fma_f32 v[102:103], v[102:103], v[134:135], v[118:119]
    v_cvt_pk_bf16_f32 v48, v96, v100
    v_cvt_pk_bf16_f32 v49, v97, v101
    v_cvt_pk_bf16_f32 v50, v98, v102
    v_cvt_pk_bf16_f32 v51, v99, v103
    buffer_store_dwordx4 v[48:51], v63, s[44:47], s72 offen sc0 sc1
    s_waitcnt lgkmcnt(2)
    v_pk_add_f32 v[104:105], v[104:105], v[32:33]
    v_pk_add_f32 v[106:107], v[106:107], v[34:35]
    v_pk_add_f32 v[104:105], v[104:105], v[36:37]
    v_pk_add_f32 v[106:107], v[106:107], v[38:39]
    v_pk_fma_f32 v[104:105], v[104:105], v[136:137], v[120:121]
    v_pk_fma_f32 v[106:107], v[106:107], v[138:139], v[122:123]
    s_waitcnt lgkmcnt(0)
    v_pk_add_f32 v[108:109], v[108:109], v[40:41]
    v_pk_add_f32 v[110:111], v[110:111], v[42:43]
    v_pk_add_f32 v[108:109], v[108:109], v[44:45]
    v_pk_add_f32 v[110:111], v[110:111], v[46:47]
    v_pk_fma_f32 v[108:109], v[108:109], v[140:141], v[124:125]
    v_pk_fma_f32 v[110:111], v[110:111], v[142:143], v[126:127]
    v_cvt_pk_bf16_f32 v52, v104, v108
    v_cvt_pk_bf16_f32 v53, v105, v109
    v_cvt_pk_bf16_f32 v54, v106, v110
    v_cvt_pk_bf16_f32 v55, v107, v111
    buffer_store_dwordx4 v[52:55], v63, s[44:47], s73 offen sc0 sc1
    v_mov_b32 v56, 0x3f803f80
    v_mov_b32 v57, 0x3f803f80
    v_mov_b32 v58, 0x3f803f80
    v_mov_b32 v59, 0x3f803f80
    v_and_b32 v14, 31, v1
    v_mul_u32_u24 v14, 96, v14
    s_add_u32 s55, s76, 88
    v_add_u32 v14, s55, v14
    v_mov_b32 v3, 152704
    v_mov_b32 v13, 1
    s_waitcnt vmcnt(2)
    ds_write_b64 v14, v[56:57] offset:0
    ds_write_b64 v14, v[56:57] offset:6144
    ds_write_b64 v14, v[56:57] offset:12288
    ds_write_b64 v14, v[56:57] offset:18432
    ds_write_b64 v14, v[56:57] offset:24576
    s_waitcnt lgkmcnt(0)
    s_barrier
    s_and_b32 s77, s69, 15
    s_mul_i32 s77, s77, 88064
    s_add_u32 s77, s77, s70
    s_add_u32 s69, s69, 2
    s_add_u32 m0, s76, 30720
    s_nop 0
    buffer_load_dwordx4 v60, s[48:51], s77 offen  lds
    s_add_u32 m0, s76, 31744
    s_nop 0
    buffer_load_dwordx4 v61, s[48:51], s77 offen  lds
    s_add_u32 m0, s76, 32768
    s_nop 0
    buffer_load_dwordx4 v62, s[48:51], s77 offen  lds
    s_and_b32 s77, s69, 15
    s_mul_i32 s77, s77, 88064
    s_add_u32 s77, s77, s70
    s_add_u32 s69, s69, 2
    s_add_u32 m0, s76, 36864
    s_nop 0
    buffer_load_dwordx4 v60, s[48:51], s77 offen  lds
    s_add_u32 m0, s76, 37888
    s_nop 0
    buffer_load_dwordx4 v61, s[48:51], s77 offen  lds
    s_add_u32 m0, s76, 38912
    s_nop 0
    buffer_load_dwordx4 v62, s[48:51], s77 offen  lds
    s_and_b32 s77, s69, 15
    s_mul_i32 s77, s77, 88064
    s_add_u32 s77, s77, s70
    s_add_u32 s69, s69, 2
    s_add_u32 m0, s76, 43008
    s_nop 0
    buffer_load_dwordx4 v60, s[48:51], s77 offen  lds
    s_add_u32 m0, s76, 44032
    s_nop 0
    buffer_load_dwordx4 v61, s[48:51], s77 offen  lds
    s_add_u32 m0, s76, 45056
    s_nop 0
    buffer_load_dwordx4 v62, s[48:51], s77 offen  lds
    s_lshl_b32 s55, s86, 2
    s_add_u32 s55, s55, s3
    s_mul_i32 s55, s55, 176128
    s_mul_i32 s56, s87, 2816
    s_add_u32 s55, s55, s56
    s_add_u32 s89, s55, 11534336
    s_add_u32 s90, s89, 88064
    v_mov_b32 v12, 0x40000000
    v_cmp_eq_u32 vcc, 3, v4
    s_nop 1
    v_cndmask_b32 v13, v9, v12, vcc
    s_cmp_eq_u32 s87, 31
    s_cselect_b64 vcc, -1, 0
    v_cndmask_b32 v68, v9, v13, vcc
    v_cndmask_b32 v69, v9, v12, vcc
    v_cndmask_b32 v70, v13, v12, vcc
    v_lshrrev_b32 v13, 2, v2
    v_lshlrev_b32 v71, 4, v2
    v_cmp_eq_u32 vcc, v13, v4
    s_nop 1
    v_cndmask_b32 v71, v12, v71, vcc
    s_lshl_b32 s55, s86, 10
    s_lshl_b32 s56, s3, 8
    s_add_u32 s55, s55, s56
    s_add_u32 s55, s55, 32768
    s_cmp_eq_u32 s87, 31
    s_cselect_b32 s91, s55, 0x40000000
    v_mov_b32 v13, 1
    s_and_b32 s72, s5, 7
    s_lshr_b32 s71, s5, 3
    s_mul_i32 s56, s71, 0
    s_mul_i32 s55, s72, 0
    s_add_u32 s55, s55, s56
    s_sub_u32 s56, s55, 11
    s_cmp_ge_u32 s55, 11
    s_cselect_b32 s55, s56, s55
    s_mul_i32 s56, s3, 11
    s_add_u32 s57, s56, 11
    s_add_u32 s55, s55, s56
    s_lshl_b32 s8, s55, 11
    s_add_u32 s55, s55, 1
    s_cmp_eq_u32 s55, s57
    s_cselect_b32 s55, s56, s55
    s_lshl_b32 s9, s55, 11
    s_add_u32 s55, s55, 1
    s_cmp_eq_u32 s55, s57
    s_cselect_b32 s55, s56, s55
    s_lshl_b32 s10, s55, 11
    s_add_u32 s55, s55, 1
    s_cmp_eq_u32 s55, s57
    s_cselect_b32 s55, s56, s55
    s_lshl_b32 s11, s55, 11
    s_add_u32 s55, s55, 1
    s_cmp_eq_u32 s55, s57
    s_cselect_b32 s55, s56, s55
    s_lshl_b32 s12, s55, 11
    s_add_u32 s55, s55, 1
    s_cmp_eq_u32 s55, s57
    s_cselect_b32 s55, s56, s55
    s_lshl_b32 s13, s55, 11
    s_add_u32 s55, s55, 1
    s_cmp_eq_u32 s55, s57
    s_cselect_b32 s55, s56, s55
    s_lshl_b32 s14, s55, 11
    s_add_u32 s55, s55, 1
    s_cmp_eq_u32 s55, s57
    s_cselect_b32 s55, s56, s55
    s_lshl_b32 s15, s55, 11
    s_add_u32 s55, s55, 1
    s_cmp_eq_u32 s55, s57
    s_cselect_b32 s55, s56, s55
    s_lshl_b32 s16, s55, 11
    s_add_u32 s55, s55, 1
    s_cmp_eq_u32 s55, s57
    s_cselect_b32 s55, s56, s55
    s_lshl_b32 s17, s55, 11
    s_add_u32 s55, s55, 1
    s_cmp_eq_u32 s55, s57
    s_cselect_b32 s55, s56, s55
    s_lshl_b32 s18, s55, 11
    s_add_u32 s55, s55, 1
    s_cmp_eq_u32 s55, s57
    s_cselect_b32 s55, s56, s55
    v_lshrrev_b32 v5, 3, v1
    v_and_b32 v6, 2, v5
    v_lshlrev_b32 v6, 1, v6
    v_and_b32 v7, 7, v1
    v_xor_b32 v6, v6, v7
    v_lshlrev_b32 v5, 10, v5
    v_lshl_add_u32 v5, v6, 4, v5
    s_mul_i32 s92, s3, 12288
    s_add_u32 s92, s92, 98304
    v_lshrrev_b32 v6, 2, v1
    v_and_b32 v7, 2, v6
    v_lshlrev_b32 v7, 5, v7
    v_lshlrev_b32 v6, 7, v6
    v_and_b32 v8, 3, v1
    v_lshl_add_u32 v6, v8, 4, v6
    v_add_u32 v6, v6, v7
    s_lshl_b32 s55, s99, 6
    v_xor_b32 v7, s55, v6
    v_xor_b32 v6, 64, v7
    v_add_u32 v6, s92, v6
    v_add_u32 v7, s92, v7
    s_lshl_b32 s93, s72, 7
    v_lshrrev_b32 v10, 2, v1
    v_mul_u32_u24 v10, 96, v10
    v_lshl_add_u32 v10, v8, 3, v10
    s_lshl_b32 s56, s99, 5
    s_add_u32 s56, s56, 49184
    v_add_u32 v11, s56, v10
    s_lshl_b32 s55, s3, 5
    s_cmp_eq_u32 s3, 3
    s_cselect_b32 s55, 49152, s55
    v_add_u32 v10, s55, v10
    ds_read_b64_tr_b16 v[16:17], v10 offset:0
    ds_read_b64_tr_b16 v[18:19], v10 offset:1536
    ds_read_b64_tr_b16 v[20:21], v11 offset:0
    ds_read_b64_tr_b16 v[22:23], v11 offset:1536
    ds_read_b64_tr_b16 v[24:25], v10 offset:3072
    ds_read_b64_tr_b16 v[26:27], v10 offset:4608
    ds_read_b64_tr_b16 v[28:29], v11 offset:3072
    ds_read_b64_tr_b16 v[30:31], v11 offset:4608
    ds_read_b64_tr_b16 v[32:33], v10 offset:6144
    ds_read_b64_tr_b16 v[34:35], v10 offset:7680
    ds_read_b64_tr_b16 v[36:37], v11 offset:6144
    ds_read_b64_tr_b16 v[38:39], v11 offset:7680
    s_waitcnt lgkmcnt(8)
    v_mfma_f32_16x16x32_bf16 v[48:51], v[56:59], v[16:19], 0
    v_mfma_f32_16x16x32_bf16 v[52:55], v[56:59], v[20:23], 0
    ds_read_b64_tr_b16 v[40:41], v10 offset:9216
    ds_read_b64_tr_b16 v[42:43], v10 offset:10752
    ds_read_b64_tr_b16 v[44:45], v11 offset:9216
    ds_read_b64_tr_b16 v[46:47], v11 offset:10752
    s_waitcnt lgkmcnt(8)
    v_mfma_f32_16x16x32_bf16 v[48:51], v[56:59], v[24:27], v[48:51]
    v_mfma_f32_16x16x32_bf16 v[52:55], v[56:59], v[28:31], v[52:55]
    ds_read_b64_tr_b16 v[16:17], v10 offset:12288
    ds_read_b64_tr_b16 v[18:19], v10 offset:13824
    ds_read_b64_tr_b16 v[20:21], v11 offset:12288
    ds_read_b64_tr_b16 v[22:23], v11 offset:13824
    s_waitcnt lgkmcnt(8)
    v_mfma_f32_16x16x32_bf16 v[48:51], v[56:59], v[32:35], v[48:51]
    v_mfma_f32_16x16x32_bf16 v[52:55], v[56:59], v[36:39], v[52:55]
    ds_read_b64_tr_b16 v[24:25], v10 offset:15360
    ds_read_b64_tr_b16 v[26:27], v10 offset:16896
    ds_read_b64_tr_b16 v[28:29], v11 offset:15360
    ds_read_b64_tr_b16 v[30:31], v11 offset:16896
    s_waitcnt lgkmcnt(8)
    v_mfma_f32_16x16x32_bf16 v[48:51], v[56:59], v[40:43], v[48:51]
    v_mfma_f32_16x16x32_bf16 v[52:55], v[56:59], v[44:47], v[52:55]
    ds_read_b64_tr_b16 v[32:33], v10 offset:18432
    ds_read_b64_tr_b16 v[34:35], v10 offset:19968
    ds_read_b64_tr_b16 v[36:37], v11 offset:18432
    ds_read_b64_tr_b16 v[38:39], v11 offset:19968
    s_waitcnt lgkmcnt(8)
    v_mfma_f32_16x16x32_bf16 v[48:51], v[56:59], v[16:19], v[48:51]
    v_mfma_f32_16x16x32_bf16 v[52:55], v[56:59], v[20:23], v[52:55]
    ds_read_b64_tr_b16 v[40:41], v10 offset:21504
    ds_read_b64_tr_b16 v[42:43], v10 offset:23040
    ds_read_b64_tr_b16 v[44:45], v11 offset:21504
    ds_read_b64_tr_b16 v[46:47], v11 offset:23040
    s_waitcnt lgkmcnt(8)
    v_mfma_f32_16x16x32_bf16 v[48:51], v[56:59], v[24:27], v[48:51]
    v_mfma_f32_16x16x32_bf16 v[52:55], v[56:59], v[28:31], v[52:55]
    ds_read_b64_tr_b16 v[16:17], v10 offset:24576
    ds_read_b64_tr_b16 v[18:19], v10 offset:26112
    ds_read_b64_tr_b16 v[20:21], v11 offset:24576
    ds_read_b64_tr_b16 v[22:23], v11 offset:26112
    s_waitcnt lgkmcnt(8)
    v_mfma_f32_16x16x32_bf16 v[48:51], v[56:59], v[32:35], v[48:51]
    v_mfma_f32_16x16x32_bf16 v[52:55], v[56:59], v[36:39], v[52:55]
    ds_read_b64_tr_b16 v[24:25], v10 offset:27648
    ds_read_b64_tr_b16 v[26:27], v10 offset:29184
    ds_read_b64_tr_b16 v[28:29], v11 offset:27648
    ds_read_b64_tr_b16 v[30:31], v11 offset:29184
    s_waitcnt lgkmcnt(8)
    v_mfma_f32_16x16x32_bf16 v[48:51], v[56:59], v[40:43], v[48:51]
    v_mfma_f32_16x16x32_bf16 v[52:55], v[56:59], v[44:47], v[52:55]
    s_waitcnt lgkmcnt(4)
    v_mfma_f32_16x16x32_bf16 v[48:51], v[56:59], v[16:19], v[48:51]
    v_mfma_f32_16x16x32_bf16 v[52:55], v[56:59], v[20:23], v[52:55]
    s_waitcnt lgkmcnt(0)
    v_mfma_f32_16x16x32_bf16 v[48:51], v[56:59], v[24:27], v[48:51]
    v_mfma_f32_16x16x32_bf16 v[52:55], v[56:59], v[28:31], v[52:55]
    s_lshl_b32 s94, s8, 4
    s_add_u32 s94, s94, s93
    s_add_u32 m0, s92, 0
    s_nop 0
    buffer_load_dwordx4 v5, s[36:39], s94 offen lds
    s_add_u32 s94, s94, 0x2000
    s_add_u32 m0, s92, 1024
    s_nop 0
    buffer_load_dwordx4 v5, s[36:39], s94 offen lds
    s_add_u32 s94, s94, 0x2000
    s_add_u32 m0, s92, 2048
    s_nop 0
    buffer_load_dwordx4 v5, s[36:39], s94 offen lds
    s_add_u32 s94, s94, 0x2000
    s_add_u32 m0, s92, 3072
    s_nop 0
    buffer_load_dwordx4 v5, s[36:39], s94 offen lds
    s_waitcnt vmcnt(4)
    ds_write_b64 v14, v[56:57] offset:30720
    ds_write_b64 v14, v[56:57] offset:36864
    ds_write_b64 v14, v[56:57] offset:43008
    s_waitcnt lgkmcnt(0)
    s_mov_b64 exec, 1
    ds_add_u32 v3, v13
    s_mov_b64 exec, -1
    s_waitcnt vmcnt(0)
    ds_read_b64_tr_b16 a[0:1], v6 offset:0
    ds_read_b64_tr_b16 a[2:3], v6 offset:2048
    ds_read_b64_tr_b16 a[4:5], v6 offset:8
    ds_read_b64_tr_b16 a[6:7], v6 offset:2056
    ds_read_b64_tr_b16 a[8:9], v7 offset:0
    ds_read_b64_tr_b16 a[10:11], v7 offset:2048
    ds_read_b64_tr_b16 a[12:13], v7 offset:8
    ds_read_b64_tr_b16 a[14:15], v7 offset:2056
    s_waitcnt lgkmcnt(0)
    ds_read_b32 v12, v3
    s_waitcnt lgkmcnt(0)
    v_cmp_ne_u32 vcc, 4, v12
    s_cbranch_vccnz L_rfB
L_ofB:
    ds_read_b64_tr_b16 v[32:33], v10 offset:30720
    ds_read_b64_tr_b16 v[34:35], v10 offset:32256
    ds_read_b64_tr_b16 v[36:37], v11 offset:30720
    ds_read_b64_tr_b16 v[38:39], v11 offset:32256
    ds_read_b64_tr_b16 v[40:41], v10 offset:33792
    ds_read_b64_tr_b16 v[42:43], v10 offset:35328
    ds_read_b64_tr_b16 v[44:45], v11 offset:33792
    ds_read_b64_tr_b16 v[46:47], v11 offset:35328
    ds_read_b64_tr_b16 v[16:17], v10 offset:36864
    ds_read_b64_tr_b16 v[18:19], v10 offset:38400
    ds_read_b64_tr_b16 v[20:21], v11 offset:36864
    ds_read_b64_tr_b16 v[22:23], v11 offset:38400
    s_waitcnt lgkmcnt(8)
    v_mfma_f32_16x16x32_bf16 v[48:51], v[56:59], v[32:35], v[48:51]
    v_mfma_f32_16x16x32_bf16 v[52:55], v[56:59], v[36:39], v[52:55]
    ds_read_b64_tr_b16 v[24:25], v10 offset:39936
    ds_read_b64_tr_b16 v[26:27], v10 offset:41472
    ds_read_b64_tr_b16 v[28:29], v11 offset:39936
    ds_read_b64_tr_b16 v[30:31], v11 offset:41472
    s_waitcnt lgkmcnt(8)
    v_mfma_f32_16x16x32_bf16 v[48:51], v[56:59], v[40:43], v[48:51]
    v_mfma_f32_16x16x32_bf16 v[52:55], v[56:59], v[44:47], v[52:55]
    ds_read_b64_tr_b16 v[32:33], v10 offset:43008
    ds_read_b64_tr_b16 v[34:35], v10 offset:44544
    ds_read_b64_tr_b16 v[36:37], v11 offset:43008
    ds_read_b64_tr_b16 v[38:39], v11 offset:44544
    s_waitcnt lgkmcnt(8)
    v_mfma_f32_16x16x32_bf16 v[48:51], v[56:59], v[16:19], v[48:51]
    v_mfma_f32_16x16x32_bf16 v[52:55], v[56:59], v[20:23], v[52:55]
    ds_read_b64_tr_b16 v[40:41], v10 offset:46080
    ds_read_b64_tr_b16 v[42:43], v10 offset:47616
    ds_read_b64_tr_b16 v[44:45], v11 offset:46080
    ds_read_b64_tr_b16 v[46:47], v11 offset:47616
    s_waitcnt lgkmcnt(8)
    v_mfma_f32_16x16x32_bf16 v[48:51], v[56:59], v[24:27], v[48:51]
    v_mfma_f32_16x16x32_bf16 v[52:55], v[56:59], v[28:31], v[52:55]
    s_waitcnt lgkmcnt(4)
    v_mfma_f32_16x16x32_bf16 v[48:51], v[56:59], v[32:35], v[48:51]
    v_mfma_f32_16x16x32_bf16 v[52:55], v[56:59], v[36:39], v[52:55]
    s_waitcnt lgkmcnt(0)
    v_mfma_f32_16x16x32_bf16 v[48:51], v[56:59], v[40:43], v[48:51]
    v_mfma_f32_16x16x32_bf16 v[52:55], v[56:59], v[44:47], v[52:55]
    s_lshl_b32 s55, s72, 1
    s_add_u32 s55, s55, s99
    s_lshl_b32 s55, s55, 14
    s_lshl_b32 s56, s71, 12
    s_add_u32 s55, s55, s56
    s_lshl_b32 s56, s98, 3
    s_add_u32 s55, s55, s56
    s_lshl_b32 s56, s4, 18
    s_add_u32 s55, s55, s56
    s_add_u32 s95, s55, 7340032
    s_lshl_b32 s55, s4, 2
    s_add_u32 s55, s55, s71
    s_lshl_b32 s64, s55, 12
    s_add_u32 s64, s64, 393216
    s_lshl_b32 s56, s55, 1
    s_add_u32 s57, s56, s98
    s_xor_b32 s56, s57, 1
    s_mul_i32 s68, s56, 88064
    s_mul_i32 s69, s57, 88064
    s_add_u32 s68, s68, 11534336
    s_add_u32 s69, s69, 11534336
    s_lshl_b32 s77, s55, 16
    s_lshl_b32 s56, s98, 12
    s_add_u32 s77, s77, s56
    s_lshl_b32 s56, s72, 7
    s_add_u32 s77, s77, s56
    s_lshl_b32 s56, s99, 6
    s_add_u32 s77, s77, s56
    s_lshl_b32 s67, s55, 8
    s_lshl_b32 s56, s98, 3
    s_add_u32 s67, s67, s56
    s_add_u32 s67, s67, 32768
    s_mul_i32 s97, s3, 12288
    s_add_u32 s97, s97, 49152
    v_add_u32 v14, s97, v9
    s_lshl_b32 s56, s3, 3
    v_add_u32 v8, s56, v1
    v_cmp_lt_u32 vcc, 7, v1
    s_nop 1
    v_cndmask_b32 v8, v8, 31, vcc
    v_lshlrev_b32 v8, 7, v8
    s_min_u32 s20, s8, 86016
    s_min_u32 s21, s9, 86016
    s_min_u32 s22, s10, 86016
    s_min_u32 s23, s11, 86016
    s_min_u32 s24, s12, 86016
    s_min_u32 s25, s13, 86016
    s_min_u32 s26, s14, 86016
    s_min_u32 s27, s15, 86016
    s_min_u32 s28, s16, 86016
    s_min_u32 s29, s17, 86016
    s_min_u32 s30, s18, 86016
    s_xor_b32 s56, s3, 1
    s_mul_i32 s56, s56, 12288
    s_add_u32 s32, s56, 0
    s_xor_b32 s56, s3, 2
    s_mul_i32 s56, s56, 12288
    s_add_u32 s33, s56, 4096
    s_xor_b32 s56, s3, 3
    s_mul_i32 s56, s56, 12288
    s_add_u32 s34, s56, 8192
    ds_read_b32 v12, v3 offset:36
    s_waitcnt lgkmcnt(0)
    v_cmp_gt_u32 vcc, 1, v12
    s_cbranch_vccnz L_rws1
L_ows1:
    buffer_store_dwordx4 v[64:67], v68, s[44:47], s89 offen offset:0 sc0 sc1
    ds_read_b32 v12, v3 offset:36
    s_waitcnt lgkmcnt(0)
    v_cmp_gt_u32 vcc, 2, v12
    s_cbranch_vccnz L_rws2
L_ows2:
    buffer_store_dwordx4 v[64:67], v68, s[44:47], s90 offen offset:0 sc0 sc1
    ds_read_b32 v12, v3 offset:36
    s_waitcnt lgkmcnt(0)
    v_cmp_gt_u32 vcc, 3, v12
    s_cbranch_vccnz L_rws3
L_ows3:
    buffer_store_dwordx4 v[64:67], v69, s[44:47], s89 offen offset:1024 sc0 sc1
    ds_read_b32 v12, v3 offset:36
    s_waitcnt lgkmcnt(0)
    v_cmp_gt_u32 vcc, 4, v12
    s_cbranch_vccnz L_rws4
L_ows4:
    buffer_store_dwordx4 v[64:67], v69, s[44:47], s90 offen offset:1024 sc0 sc1
    ds_read_b32 v12, v3 offset:36
    s_waitcnt lgkmcnt(0)
    v_cmp_gt_u32 vcc, 5, v12
    s_cbranch_vccnz L_rws5
L_ows5:
    buffer_store_dwordx4 v[64:67], v70, s[44:47], s89 offen offset:2048 sc0 sc1
    ds_read_b32 v12, v3 offset:36
    s_waitcnt lgkmcnt(0)
    v_cmp_gt_u32 vcc, 6, v12
    s_cbranch_vccnz L_rws6
L_ows6:
    buffer_store_dwordx4 v[64:67], v70, s[44:47], s90 offen offset:2048 sc0 sc1
    buffer_store_dwordx4 v[64:67], v71, s[44:47], s91 offen sc0 sc1
    s_lshl_b32 s94, s9, 4
    s_add_u32 s94, s94, s93
    s_add_u32 m0, s92, 4096
    s_nop 0
    buffer_load_dwordx4 v5, s[36:39], s94 offen lds
    s_add_u32 s94, s94, 0x2000
    s_add_u32 m0, s92, 5120
    s_nop 0
    buffer_load_dwordx4 v5, s[36:39], s94 offen lds
    s_add_u32 s94, s94, 0x2000
    ds_read_b32 v12, v3 offset:36
    s_waitcnt lgkmcnt(0)
    v_cmp_gt_u32 vcc, 7, v12
    s_cbranch_vccnz L_rws7
L_ows7:
    s_add_u32 m0, s92, 6144
    s_nop 0
    buffer_load_dwordx4 v5, s[36:39], s94 offen lds
    s_add_u32 s94, s94, 0x2000
    s_add_u32 m0, s92, 7168
    s_nop 0
    buffer_load_dwordx4 v5, s[36:39], s94 offen lds
    ds_read_b32 v12, v3 offset:36
    s_waitcnt lgkmcnt(0)
    v_cmp_gt_u32 vcc, 8, v12
    s_cbranch_vccnz L_rws8
L_ows8:
    s_lshl_b32 s55, s86, 2
    s_add_u32 s55, s55, s3
    s_lshl_b32 s55, s55, 5
    s_add_u32 s55, s55, s87
    s_lshl_b32 s55, s55, 7
    s_add_u32 s55, s55, 393216
    v_mov_b32 v64, s84
    v_mov_b32 v65, s84
    v_mov_b32 v66, s84
    v_mov_b32 v67, s84
    s_mov_b64 exec, 0xff
    s_waitcnt vmcnt(4)
    buffer_store_dwordx4 v[64:67], v9, s[44:47], s55 offen sc0 sc1
    s_mov_b64 exec, -1
    s_lshl_b32 s55, s3, 6
    s_add_u32 s55, s55, 152320
    v_lshl_add_u32 v10, v2, 2, s55
    s_lshl_b32 s56, s99, 6
    s_add_u32 s56, s56, 152576
    v_lshl_add_u32 v11, v2, 2, s56
    ds_write_b32 v10, v48
    ds_write_b32 v11, v52
    s_waitcnt lgkmcnt(0)
    s_mov_b64 exec, 1
    ds_add_u32 v3, v13 offset:4
    s_mov_b64 exec, -1
    s_lshl_b32 s94, s10, 4
    s_add_u32 s94, s94, s93
    s_add_u32 m0, s92, 8192
    s_nop 0
    buffer_load_dwordx4 v5, s[36:39], s94 offen lds
    s_add_u32 s94, s94, 0x2000
    s_add_u32 m0, s92, 9216
    s_nop 0
    buffer_load_dwordx4 v5, s[36:39], s94 offen lds
    s_add_u32 s94, s94, 0x2000
    ds_read_b32 v12, v3 offset:36
    s_waitcnt lgkmcnt(0)
    v_cmp_gt_u32 vcc, 9, v12
    s_cbranch_vccnz L_rws9
L_ows9:
    s_add_u32 m0, s92, 10240
    s_nop 0
    buffer_load_dwordx4 v5, s[36:39], s94 offen lds
    s_add_u32 s94, s94, 0x2000
    s_add_u32 m0, s92, 11264
    s_nop 0
    buffer_load_dwordx4 v5, s[36:39], s94 offen lds
    ds_read_b32 v12, v3 offset:36
    s_waitcnt lgkmcnt(0)
    v_cmp_gt_u32 vcc, 10, v12
    s_cbranch_vccnz L_rws10
L_ows10:
    s_lshl_b32 s94, s11, 4
    s_add_u32 s94, s94, s93
    s_add_u32 m0, s92, 0
    s_nop 0
    buffer_load_dwordx4 v5, s[36:39], s94 offen lds
    s_add_u32 s94, s94, 0x2000
    s_add_u32 m0, s92, 1024
    s_nop 0
    buffer_load_dwordx4 v5, s[36:39], s94 offen lds
    s_add_u32 s94, s94, 0x2000
    ds_read_b32 v12, v3 offset:36
    s_waitcnt lgkmcnt(0)
    v_cmp_gt_u32 vcc, 11, v12
    s_cbranch_vccnz L_rws11
L_ows11:
    s_add_u32 m0, s92, 2048
    s_nop 0
    buffer_load_dwordx4 v5, s[36:39], s94 offen lds
    s_add_u32 s94, s94, 0x2000
    ds_read_b32 v12, v3 offset:36
    s_waitcnt lgkmcnt(0)
    v_cmp_gt_u32 vcc, 12, v12
    s_cbranch_vccnz L_rws12
L_ows12:
    s_add_u32 m0, s92, 3072
    s_nop 0
    buffer_load_dwordx4 v5, s[36:39], s94 offen lds
    ds_read_b32 v12, v3 offset:36
    s_waitcnt lgkmcnt(0)
    v_cmp_gt_u32 vcc, 13, v12
    s_cbranch_vccnz L_rws13
L_ows13:
    buffer_load_dword v10, v8, s[44:47], s64 offen sc1
    s_waitcnt vmcnt(10)
    ds_read_b64_tr_b16 a[16:17], v6 offset:4096
    ds_read_b64_tr_b16 a[18:19], v6 offset:6144
    ds_read_b64_tr_b16 a[20:21], v6 offset:4104
    ds_read_b64_tr_b16 a[22:23], v6 offset:6152
    ds_read_b64_tr_b16 a[24:25], v7 offset:4096
    ds_read_b64_tr_b16 a[26:27], v7 offset:6144
    ds_read_b64_tr_b16 a[28:29], v7 offset:4104
    ds_read_b64_tr_b16 a[30:31], v7 offset:6152
    s_waitcnt lgkmcnt(0)
    s_lshl_b32 s94, s12, 4
    s_add_u32 s94, s94, s93
    s_add_u32 m0, s92, 4096
    s_nop 0
    buffer_load_dwordx4 v5, s[36:39], s94 offen lds
    s_add_u32 s94, s94, 0x2000
    s_add_u32 m0, s92, 5120
    s_nop 0
    buffer_load_dwordx4 v5, s[36:39], s94 offen lds
    s_add_u32 s94, s94, 0x2000
    s_add_u32 m0, s92, 6144
    s_nop 0
    buffer_load_dwordx4 v5, s[36:39], s94 offen lds
    s_add_u32 s94, s94, 0x2000
    s_add_u32 m0, s92, 7168
    s_nop 0
    buffer_load_dwordx4 v5, s[36:39], s94 offen lds
    s_waitcnt vmcnt(9)
    ds_read_b64_tr_b16 a[32:33], v6 offset:8192
    ds_read_b64_tr_b16 a[34:35], v6 offset:10240
    ds_read_b64_tr_b16 a[36:37], v6 offset:8200
    ds_read_b64_tr_b16 a[38:39], v6 offset:10248
    ds_read_b64_tr_b16 a[40:41], v7 offset:8192
    ds_read_b64_tr_b16 a[42:43], v7 offset:10240
    ds_read_b64_tr_b16 a[44:45], v7 offset:8200
    ds_read_b64_tr_b16 a[46:47], v7 offset:10248
    s_waitcnt lgkmcnt(0)
    s_lshl_b32 s94, s13, 4
    s_add_u32 s94, s94, s93
    s_add_u32 m0, s92, 8192
    s_nop 0
    buffer_load_dwordx4 v5, s[36:39], s94 offen lds
    s_add_u32 s94, s94, 0x2000
    s_add_u32 m0, s92, 9216
    s_nop 0
    buffer_load_dwordx4 v5, s[36:39], s94 offen lds
    s_add_u32 s94, s94, 0x2000
    s_add_u32 m0, s92, 10240
    s_nop 0
    buffer_load_dwordx4 v5, s[36:39], s94 offen lds
    s_add_u32 s94, s94, 0x2000
    s_add_u32 m0, s92, 11264
    s_nop 0
    buffer_load_dwordx4 v5, s[36:39], s94 offen lds
    s_waitcnt vmcnt(9)
    ds_read_b64_tr_b16 a[48:49], v6 offset:0
    ds_read_b64_tr_b16 a[50:51], v6 offset:2048
    ds_read_b64_tr_b16 a[52:53], v6 offset:8
    ds_read_b64_tr_b16 a[54:55], v6 offset:2056
    ds_read_b64_tr_b16 a[56:57], v7 offset:0
    ds_read_b64_tr_b16 a[58:59], v7 offset:2048
    ds_read_b64_tr_b16 a[60:61], v7 offset:8
    ds_read_b64_tr_b16 a[62:63], v7 offset:2056
    s_waitcnt lgkmcnt(0)
    s_lshl_b32 s94, s14, 4
    s_add_u32 s94, s94, s93
    s_add_u32 m0, s92, 0
    s_nop 0
    buffer_load_dwordx4 v5, s[36:39], s94 offen lds
    s_add_u32 s94, s94, 0x2000
    s_add_u32 m0, s92, 1024
    s_nop 0
    buffer_load_dwordx4 v5, s[36:39], s94 offen lds
    s_add_u32 s94, s94, 0x2000
    s_add_u32 m0, s92, 2048
    s_nop 0
    buffer_load_dwordx4 v5, s[36:39], s94 offen lds
    s_add_u32 s94, s94, 0x2000
    s_add_u32 m0, s92, 3072
    s_nop 0
    buffer_load_dwordx4 v5, s[36:39], s94 offen lds
    s_waitcnt vmcnt(8)
    ds_read_b64_tr_b16 v[72:73], v6 offset:4096
    ds_read_b64_tr_b16 v[74:75], v6 offset:6144
    ds_read_b64_tr_b16 v[76:77], v6 offset:4104
    ds_read_b64_tr_b16 v[78:79], v6 offset:6152
    ds_read_b64_tr_b16 v[80:81], v7 offset:4096
    ds_read_b64_tr_b16 v[82:83], v7 offset:6144
    ds_read_b64_tr_b16 v[84:85], v7 offset:4104
    ds_read_b64_tr_b16 v[86:87], v7 offset:6152
    s_waitcnt lgkmcnt(0)
    s_lshl_b32 s94, s15, 4
    s_add_u32 s94, s94, s93
    s_add_u32 m0, s92, 4096
    s_nop 0
    buffer_load_dwordx4 v5, s[36:39], s94 offen lds
    s_add_u32 s94, s94, 0x2000
    s_add_u32 m0, s92, 5120
    s_nop 0
    buffer_load_dwordx4 v5, s[36:39], s94 offen lds
    s_add_u32 s94, s94, 0x2000
    s_add_u32 m0, s92, 6144
    s_nop 0
    buffer_load_dwordx4 v5, s[36:39], s94 offen lds
    s_add_u32 s94, s94, 0x2000
    s_add_u32 m0, s92, 7168
    s_nop 0
    buffer_load_dwordx4 v5, s[36:39], s94 offen lds
    s_waitcnt vmcnt(8)
    ds_read_b64_tr_b16 v[88:89], v6 offset:8192
    ds_read_b64_tr_b16 v[90:91], v6 offset:10240
    ds_read_b64_tr_b16 v[92:93], v6 offset:8200
    ds_read_b64_tr_b16 v[94:95], v6 offset:10248
    ds_read_b64_tr_b16 v[96:97], v7 offset:8192
    ds_read_b64_tr_b16 v[98:99], v7 offset:10240
    ds_read_b64_tr_b16 v[100:101], v7 offset:8200
    ds_read_b64_tr_b16 v[102:103], v7 offset:10248
    s_waitcnt lgkmcnt(0)
    s_waitcnt vmcnt(4)
    ds_read_b64_tr_b16 v[104:105], v6 offset:0
    ds_read_b64_tr_b16 v[106:107], v6 offset:2048
    ds_read_b64_tr_b16 v[108:109], v6 offset:8
    ds_read_b64_tr_b16 v[110:111], v6 offset:2056
    ds_read_b64_tr_b16 v[112:113], v7 offset:0
    ds_read_b64_tr_b16 v[114:115], v7 offset:2048
    ds_read_b64_tr_b16 v[116:117], v7 offset:8
    ds_read_b64_tr_b16 v[118:119], v7 offset:2056
    s_waitcnt lgkmcnt(0)
    s_waitcnt vmcnt(0)
    ds_read_b64_tr_b16 v[120:121], v6 offset:4096
    ds_read_b64_tr_b16 v[122:123], v6 offset:6144
    ds_read_b64_tr_b16 v[124:125], v6 offset:4104
    ds_read_b64_tr_b16 v[126:127], v6 offset:6152
    ds_read_b64_tr_b16 v[128:129], v7 offset:4096
    ds_read_b64_tr_b16 v[130:131], v7 offset:6144
    ds_read_b64_tr_b16 v[132:133], v7 offset:4104
    ds_read_b64_tr_b16 v[134:135], v7 offset:6152
    s_waitcnt lgkmcnt(0)
    s_waitcnt vmcnt(0)
    v_cmp_ne_u32 vcc, s84, v10
    s_cbranch_vccnz L_rfh
L_ofh:
    s_barrier
    s_lshl_b32 s94, s16, 4
    s_add_u32 s94, s94, s93
    s_add_u32 m0, s92, 8192
    s_nop 0
    buffer_load_dwordx4 v5, s[36:39], s94 offen lds
    s_add_u32 s94, s94, 0x2000
    s_add_u32 m0, s92, 9216
    s_nop 0
    buffer_load_dwordx4 v5, s[36:39], s94 offen lds
    s_add_u32 s94, s94, 0x2000
    s_add_u32 m0, s92, 10240
    s_nop 0
    buffer_load_dwordx4 v5, s[36:39], s94 offen lds
    s_add_u32 s94, s94, 0x2000
    s_add_u32 m0, s92, 11264
    s_nop 0
    buffer_load_dwordx4 v5, s[36:39], s94 offen lds
    s_lshl_b32 s94, s17, 4
    s_add_u32 s94, s94, s93
    s_add_u32 m0, s92, 0
    s_nop 0
    buffer_load_dwordx4 v5, s[36:39], s94 offen lds
    s_add_u32 s94, s94, 0x2000
    s_add_u32 m0, s92, 1024
    s_nop 0
    buffer_load_dwordx4 v5, s[36:39], s94 offen lds
    s_add_u32 s94, s94, 0x2000
    s_add_u32 m0, s92, 2048
    s_nop 0
    buffer_load_dwordx4 v5, s[36:39], s94 offen lds
    s_add_u32 s94, s94, 0x2000
    s_add_u32 m0, s92, 3072
    s_nop 0
    buffer_load_dwordx4 v5, s[36:39], s94 offen lds
    s_lshl_b32 s94, s18, 4
    s_add_u32 s94, s94, s93
    s_add_u32 m0, s92, 4096
    s_nop 0
    buffer_load_dwordx4 v5, s[36:39], s94 offen lds
    s_add_u32 s94, s94, 0x2000
    s_add_u32 m0, s92, 5120
    s_nop 0
    buffer_load_dwordx4 v5, s[36:39], s94 offen lds
    s_add_u32 s94, s94, 0x2000
    s_add_u32 m0, s92, 6144
    s_nop 0
    buffer_load_dwordx4 v5, s[36:39], s94 offen lds
    s_add_u32 s94, s94, 0x2000
    s_add_u32 m0, s92, 7168
    s_nop 0
    buffer_load_dwordx4 v5, s[36:39], s94 offen lds
    s_add_u32 m0, s97, 0
    s_add_u32 s96, s68, s20
    buffer_load_dwordx4 v9, s[44:47], s96 offen sc1 lds
    buffer_load_dwordx4 v9, s[44:47], s96 offen offset:1024 sc1 lds
    s_add_u32 m0, s97, 2048
    s_add_u32 s96, s68, s21
    buffer_load_dwordx4 v9, s[44:47], s96 offen sc1 lds
    buffer_load_dwordx4 v9, s[44:47], s96 offen offset:1024 sc1 lds
    s_add_u32 m0, s97, 4096
    s_add_u32 s96, s68, s22
    buffer_load_dwordx4 v9, s[44:47], s96 offen sc1 lds
    buffer_load_dwordx4 v9, s[44:47], s96 offen offset:1024 sc1 lds
    s_add_u32 m0, s97, 6144
    s_add_u32 s96, s68, s23
    buffer_load_dwordx4 v9, s[44:47], s96 offen sc1 lds
    buffer_load_dwordx4 v9, s[44:47], s96 offen offset:1024 sc1 lds
    s_add_u32 m0, s97, 8192
    s_add_u32 s96, s68, s24
    buffer_load_dwordx4 v9, s[44:47], s96 offen sc1 lds
    buffer_load_dwordx4 v9, s[44:47], s96 offen offset:1024 sc1 lds
    s_add_u32 m0, s97, 10240
    s_add_u32 s96, s68, s25
    buffer_load_dwordx4 v9, s[44:47], s96 offen sc1 lds
    buffer_load_dwordx4 v9, s[44:47], s96 offen offset:1024 sc1 lds
    s_waitcnt vmcnt(20)
    ds_read_b64_tr_b16 v[136:137], v6 offset:8192
    ds_read_b64_tr_b16 v[138:139], v6 offset:10240
    ds_read_b64_tr_b16 v[140:141], v6 offset:8200
    ds_read_b64_tr_b16 v[142:143], v6 offset:10248
    ds_read_b64_tr_b16 v[144:145], v7 offset:8192
    ds_read_b64_tr_b16 v[146:147], v7 offset:10240
    ds_read_b64_tr_b16 v[148:149], v7 offset:8200
    ds_read_b64_tr_b16 v[150:151], v7 offset:10248
    s_waitcnt lgkmcnt(0)
    s_waitcnt vmcnt(16)
    ds_read_b64_tr_b16 v[152:153], v6 offset:0
    ds_read_b64_tr_b16 v[154:155], v6 offset:2048
    ds_read_b64_tr_b16 v[156:157], v6 offset:8
    ds_read_b64_tr_b16 v[158:159], v6 offset:2056
    ds_read_b64_tr_b16 v[160:161], v7 offset:0
    ds_read_b64_tr_b16 v[162:163], v7 offset:2048
    ds_read_b64_tr_b16 v[164:165], v7 offset:8
    ds_read_b64_tr_b16 v[166:167], v7 offset:2056
    s_waitcnt lgkmcnt(0)
    s_waitcnt vmcnt(12)
    ds_read_b64_tr_b16 v[168:169], v6 offset:4096
    ds_read_b64_tr_b16 v[170:171], v6 offset:6144
    ds_read_b64_tr_b16 v[172:173], v6 offset:4104
    ds_read_b64_tr_b16 v[174:175], v6 offset:6152
    ds_read_b64_tr_b16 v[176:177], v7 offset:4096
    ds_read_b64_tr_b16 v[178:179], v7 offset:6144
    ds_read_b64_tr_b16 v[180:181], v7 offset:4104
    ds_read_b64_tr_b16 v[182:183], v7 offset:6152
    s_waitcnt lgkmcnt(0)
    v_lshrrev_b32 v5, 1, v2
    v_lshlrev_b32 v5, 13, v5
    v_and_b32 v12, 1, v2
    v_lshl_add_u32 v5, v12, 10, v5
    v_lshl_add_u32 v5, v4, 4, v5
    v_lshlrev_b32 v12, 4, v2
    v_subrev_u32 v10, 0xc000, v14
    v_add_u32 v6, s32, v9
    v_add_u32 v7, s33, v9
    v_add_u32 v8, s34, v9
    s_waitcnt vmcnt(10)
    ds_read_b64 v[16:17], v14 offset:0
    ds_read_b64 v[18:19], v14 offset:1024
    ds_read_b64 v[20:21], v14 offset:8
    ds_read_b64 v[22:23], v14 offset:1032
    s_waitcnt lgkmcnt(0)
    v_max_u32 v11, v16, v18
    v_cmp_eq_u32 vcc, -1, v11
    s_cbranch_vccnz L_rh0
L_oh0:
    s_waitcnt vmcnt(8)
    ds_read_b64 v[24:25], v14 offset:2048
    ds_read_b64 v[26:27], v14 offset:3072
    ds_read_b64 v[28:29], v14 offset:2056
    ds_read_b64 v[30:31], v14 offset:3080
    v_mfma_f32_16x16x32_bf16 v[56:59], a[0:3], v[16:19], 0
    s_add_u32 m0, s97, 0
    s_add_u32 s96, s68, s26
    buffer_load_dwordx4 v9, s[44:47], s96 offen sc1 lds
    buffer_load_dwordx4 v9, s[44:47], s96 offen offset:1024 sc1 lds
    v_mfma_f32_16x16x32_bf16 v[60:63], a[0:3], v[20:23], 0
    s_waitcnt lgkmcnt(0)
    v_max_u32 v11, v24, v26
    v_cmp_eq_u32 vcc, -1, v11
    v_mfma_f32_16x16x32_bf16 v[64:67], a[4:7], v[16:19], 0
    v_mfma_f32_16x16x32_bf16 v[68:71], a[4:7], v[20:23], 0
    s_cbranch_vccnz L_rh1
L_oh1:
    s_waitcnt vmcnt(8)
    ds_read_b64 v[32:33], v14 offset:4096
    v_mfma_f32_16x16x32_bf16 v[40:43], a[8:11], v[16:19], 0
    ds_read_b64 v[34:35], v14 offset:5120
    v_mfma_f32_16x16x32_bf16 v[44:47], a[8:11], v[20:23], 0
    ds_read_b64 v[36:37], v14 offset:4104
    v_mfma_f32_16x16x32_bf16 v[48:51], a[12:15], v[16:19], 0
    ds_read_b64 v[38:39], v14 offset:5128
    v_mfma_f32_16x16x32_bf16 v[52:55], a[12:15], v[20:23], 0
    v_mfma_f32_16x16x32_bf16 v[56:59], a[16:19], v[24:27], v[56:59]
    s_add_u32 m0, s97, 2048
    s_add_u32 s96, s68, s27
    buffer_load_dwordx4 v9, s[44:47], s96 offen sc1 lds
    buffer_load_dwordx4 v9, s[44:47], s96 offen offset:1024 sc1 lds
    v_mfma_f32_16x16x32_bf16 v[60:63], a[16:19], v[28:31], v[60:63]
    s_waitcnt lgkmcnt(0)
    v_max_u32 v11, v32, v34
    v_cmp_eq_u32 vcc, -1, v11
    v_mfma_f32_16x16x32_bf16 v[64:67], a[20:23], v[24:27], v[64:67]
    v_mfma_f32_16x16x32_bf16 v[68:71], a[20:23], v[28:31], v[68:71]
    s_cbranch_vccnz L_rh2
L_oh2:
    s_waitcnt vmcnt(8)
    ds_read_b64 v[16:17], v14 offset:6144
    v_mfma_f32_16x16x32_bf16 v[40:43], a[24:27], v[24:27], v[40:43]
    ds_read_b64 v[18:19], v14 offset:7168
    v_mfma_f32_16x16x32_bf16 v[44:47], a[24:27], v[28:31], v[44:47]
    ds_read_b64 v[20:21], v14 offset:6152
    v_mfma_f32_16x16x32_bf16 v[48:51], a[28:31], v[24:27], v[48:51]
    ds_read_b64 v[22:23], v14 offset:7176
    v_mfma_f32_16x16x32_bf16 v[52:55], a[28:31], v[28:31], v[52:55]
    v_mfma_f32_16x16x32_bf16 v[56:59], a[32:35], v[32:35], v[56:59]
    s_add_u32 m0, s97, 4096
    s_add_u32 s96, s68, s28
    buffer_load_dwordx4 v9, s[44:47], s96 offen sc1 lds
    buffer_load_dwordx4 v9, s[44:47], s96 offen offset:1024 sc1 lds
    v_mfma_f32_16x16x32_bf16 v[60:63], a[32:35], v[36:39], v[60:63]
    s_waitcnt lgkmcnt(0)
    v_max_u32 v11, v16, v18
    v_cmp_eq_u32 vcc, -1, v11
    v_mfma_f32_16x16x32_bf16 v[64:67], a[36:39], v[32:35], v[64:67]
    v_mfma_f32_16x16x32_bf16 v[68:71], a[36:39], v[36:39], v[68:71]
    s_cbranch_vccnz L_rh3
L_oh3:
    s_waitcnt vmcnt(8)
    ds_read_b64 v[24:25], v14 offset:8192
    v_mfma_f32_16x16x32_bf16 v[40:43], a[40:43], v[32:35], v[40:43]
    ds_read_b64 v[26:27], v14 offset:9216
    v_mfma_f32_16x16x32_bf16 v[44:47], a[40:43], v[36:39], v[44:47]
    ds_read_b64 v[28:29], v14 offset:8200
    v_mfma_f32_16x16x32_bf16 v[48:51], a[44:47], v[32:35], v[48:51]
    ds_read_b64 v[30:31], v14 offset:9224
    v_mfma_f32_16x16x32_bf16 v[52:55], a[44:47], v[36:39], v[52:55]
    v_mfma_f32_16x16x32_bf16 v[56:59], a[48:51], v[16:19], v[56:59]
    s_add_u32 m0, s97, 6144
    s_add_u32 s96, s68, s29
    buffer_load_dwordx4 v9, s[44:47], s96 offen sc1 lds
    buffer_load_dwordx4 v9, s[44:47], s96 offen offset:1024 sc1 lds
    v_mfma_f32_16x16x32_bf16 v[60:63], a[48:51], v[20:23], v[60:63]
    s_waitcnt lgkmcnt(0)
    v_max_u32 v11, v24, v26
    v_cmp_eq_u32 vcc, -1, v11
    v_mfma_f32_16x16x32_bf16 v[64:67], a[52:55], v[16:19], v[64:67]
    v_mfma_f32_16x16x32_bf16 v[68:71], a[52:55], v[20:23], v[68:71]
    s_cbranch_vccnz L_rh4
L_oh4:
    s_waitcnt vmcnt(8)
    ds_read_b64 v[32:33], v14 offset:10240
    v_mfma_f32_16x16x32_bf16 v[40:43], a[56:59], v[16:19], v[40:43]
    ds_read_b64 v[34:35], v14 offset:11264
    v_mfma_f32_16x16x32_bf16 v[44:47], a[56:59], v[20:23], v[44:47]
    ds_read_b64 v[36:37], v14 offset:10248
    v_mfma_f32_16x16x32_bf16 v[48:51], a[60:63], v[16:19], v[48:51]
    ds_read_b64 v[38:39], v14 offset:11272
    v_mfma_f32_16x16x32_bf16 v[52:55], a[60:63], v[20:23], v[52:55]
    v_mfma_f32_16x16x32_bf16 v[56:59], v[72:75], v[24:27], v[56:59]
    s_add_u32 m0, s97, 8192
    s_add_u32 s96, s68, s30
    buffer_load_dwordx4 v9, s[44:47], s96 offen sc1 lds
    buffer_load_dwordx4 v9, s[44:47], s96 offen offset:1024 sc1 lds
    v_mfma_f32_16x16x32_bf16 v[60:63], v[72:75], v[28:31], v[60:63]
    s_waitcnt lgkmcnt(0)
    v_max_u32 v11, v32, v34
    v_cmp_eq_u32 vcc, -1, v11
    v_mfma_f32_16x16x32_bf16 v[64:67], v[76:79], v[24:27], v[64:67]
    v_mfma_f32_16x16x32_bf16 v[68:71], v[76:79], v[28:31], v[68:71]
    s_cbranch_vccnz L_rh5
L_oh5:
    s_waitcnt vmcnt(8)
    ds_read_b64 v[16:17], v14 offset:0
    v_mfma_f32_16x16x32_bf16 v[40:43], v[80:83], v[24:27], v[40:43]
    ds_read_b64 v[18:19], v14 offset:1024
    v_mfma_f32_16x16x32_bf16 v[44:47], v[80:83], v[28:31], v[44:47]
    ds_read_b64 v[20:21], v14 offset:8
    v_mfma_f32_16x16x32_bf16 v[48:51], v[84:87], v[24:27], v[48:51]
    ds_read_b64 v[22:23], v14 offset:1032
    v_mfma_f32_16x16x32_bf16 v[52:55], v[84:87], v[28:31], v[52:55]
    v_mfma_f32_16x16x32_bf16 v[56:59], v[88:91], v[32:35], v[56:59]
    s_add_u32 m0, s97, 10240
    s_add_u32 s96, s69, s20
    buffer_load_dwordx4 v9, s[44:47], s96 offen sc1 lds
    buffer_load_dwordx4 v9, s[44:47], s96 offen offset:1024 sc1 lds
    v_mfma_f32_16x16x32_bf16 v[60:63], v[88:91], v[36:39], v[60:63]
    s_waitcnt lgkmcnt(0)
    v_max_u32 v11, v16, v18
    v_cmp_eq_u32 vcc, -1, v11
    v_mfma_f32_16x16x32_bf16 v[64:67], v[92:95], v[32:35], v[64:67]
    v_mfma_f32_16x16x32_bf16 v[68:71], v[92:95], v[36:39], v[68:71]
    s_cbranch_vccnz L_rh6
L_oh6:
    s_waitcnt vmcnt(8)
    ds_read_b64 v[24:25], v14 offset:2048
    v_mfma_f32_16x16x32_bf16 v[40:43], v[96:99], v[32:35], v[40:43]
    ds_read_b64 v[26:27], v14 offset:3072
    v_mfma_f32_16x16x32_bf16 v[44:47], v[96:99], v[36:39], v[44:47]
    ds_read_b64 v[28:29], v14 offset:2056
    v_mfma_f32_16x16x32_bf16 v[48:51], v[100:103], v[32:35], v[48:51]
    ds_read_b64 v[30:31], v14 offset:3080
    v_mfma_f32_16x16x32_bf16 v[52:55], v[100:103], v[36:39], v[52:55]
    v_mfma_f32_16x16x32_bf16 v[56:59], v[104:107], v[16:19], v[56:59]
    s_add_u32 m0, s97, 0
    s_add_u32 s96, s69, s21
    buffer_load_dwordx4 v9, s[44:47], s96 offen sc1 lds
    buffer_load_dwordx4 v9, s[44:47], s96 offen offset:1024 sc1 lds
    v_mfma_f32_16x16x32_bf16 v[60:63], v[104:107], v[20:23], v[60:63]
    s_waitcnt lgkmcnt(0)
    v_max_u32 v11, v24, v26
    v_cmp_eq_u32 vcc, -1, v11
    v_mfma_f32_16x16x32_bf16 v[64:67], v[108:111], v[16:19], v[64:67]
    v_mfma_f32_16x16x32_bf16 v[68:71], v[108:111], v[20:23], v[68:71]
    s_cbranch_vccnz L_rh7
L_oh7:
    s_waitcnt vmcnt(8)
    ds_read_b64 v[32:33], v14 offset:4096
    v_mfma_f32_16x16x32_bf16 v[40:43], v[112:115], v[16:19], v[40:43]
    ds_read_b64 v[34:35], v14 offset:5120
    v_mfma_f32_16x16x32_bf16 v[44:47], v[112:115], v[20:23], v[44:47]
    ds_read_b64 v[36:37], v14 offset:4104
    v_mfma_f32_16x16x32_bf16 v[48:51], v[116:119], v[16:19], v[48:51]
    ds_read_b64 v[38:39], v14 offset:5128
    v_mfma_f32_16x16x32_bf16 v[52:55], v[116:119], v[20:23], v[52:55]
    v_mfma_f32_16x16x32_bf16 v[56:59], v[120:123], v[24:27], v[56:59]
    s_add_u32 m0, s97, 2048
    s_add_u32 s96, s69, s22
    buffer_load_dwordx4 v9, s[44:47], s96 offen sc1 lds
    buffer_load_dwordx4 v9, s[44:47], s96 offen offset:1024 sc1 lds
    v_mfma_f32_16x16x32_bf16 v[60:63], v[120:123], v[28:31], v[60:63]
    s_waitcnt lgkmcnt(0)
    v_max_u32 v11, v32, v34
    v_cmp_eq_u32 vcc, -1, v11
    v_mfma_f32_16x16x32_bf16 v[64:67], v[124:127], v[24:27], v[64:67]
    v_mfma_f32_16x16x32_bf16 v[68:71], v[124:127], v[28:31], v[68:71]
    s_cbranch_vccnz L_rh8
L_oh8:
    s_waitcnt vmcnt(8)
    ds_read_b64 v[16:17], v14 offset:6144
    v_mfma_f32_16x16x32_bf16 v[40:43], v[128:131], v[24:27], v[40:43]
    ds_read_b64 v[18:19], v14 offset:7168
    v_mfma_f32_16x16x32_bf16 v[44:47], v[128:131], v[28:31], v[44:47]
    ds_read_b64 v[20:21], v14 offset:6152
    v_mfma_f32_16x16x32_bf16 v[48:51], v[132:135], v[24:27], v[48:51]
    ds_read_b64 v[22:23], v14 offset:7176
    v_mfma_f32_16x16x32_bf16 v[52:55], v[132:135], v[28:31], v[52:55]
    v_mfma_f32_16x16x32_bf16 v[56:59], v[136:139], v[32:35], v[56:59]
    s_add_u32 m0, s97, 4096
    s_add_u32 s96, s69, s23
    buffer_load_dwordx4 v9, s[44:47], s96 offen sc1 lds
    buffer_load_dwordx4 v9, s[44:47], s96 offen offset:1024 sc1 lds
    v_mfma_f32_16x16x32_bf16 v[60:63], v[136:139], v[36:39], v[60:63]
    s_waitcnt lgkmcnt(0)
    v_max_u32 v11, v16, v18
    v_cmp_eq_u32 vcc, -1, v11
    v_mfma_f32_16x16x32_bf16 v[64:67], v[140:143], v[32:35], v[64:67]
    v_mfma_f32_16x16x32_bf16 v[68:71], v[140:143], v[36:39], v[68:71]
    s_cbranch_vccnz L_rh9
L_oh9:
    s_waitcnt vmcnt(8)
    ds_read_b64 v[24:25], v14 offset:8192
    v_mfma_f32_16x16x32_bf16 v[40:43], v[144:147], v[32:35], v[40:43]
    ds_read_b64 v[26:27], v14 offset:9216
    v_mfma_f32_16x16x32_bf16 v[44:47], v[144:147], v[36:39], v[44:47]
    ds_read_b64 v[28:29], v14 offset:8200
    v_mfma_f32_16x16x32_bf16 v[48:51], v[148:151], v[32:35], v[48:51]
    ds_read_b64 v[30:31], v14 offset:9224
    v_mfma_f32_16x16x32_bf16 v[52:55], v[148:151], v[36:39], v[52:55]
    v_mfma_f32_16x16x32_bf16 v[56:59], v[152:155], v[16:19], v[56:59]
    s_add_u32 m0, s97, 6144
    s_add_u32 s96, s69, s24
    buffer_load_dwordx4 v9, s[44:47], s96 offen sc1 lds
    buffer_load_dwordx4 v9, s[44:47], s96 offen offset:1024 sc1 lds
    v_mfma_f32_16x16x32_bf16 v[60:63], v[152:155], v[20:23], v[60:63]
    s_waitcnt lgkmcnt(0)
    v_max_u32 v11, v24, v26
    v_cmp_eq_u32 vcc, -1, v11
    v_mfma_f32_16x16x32_bf16 v[64:67], v[156:159], v[16:19], v[64:67]
    v_mfma_f32_16x16x32_bf16 v[68:71], v[156:159], v[20:23], v[68:71]
    s_cbranch_vccnz L_rh10
L_oh10:
    s_waitcnt vmcnt(8)
    ds_read_b64 v[32:33], v14 offset:10240
    v_mfma_f32_16x16x32_bf16 v[40:43], v[160:163], v[16:19], v[40:43]
    ds_read_b64 v[34:35], v14 offset:11264
    v_mfma_f32_16x16x32_bf16 v[44:47], v[160:163], v[20:23], v[44:47]
    ds_read_b64 v[36:37], v14 offset:10248
    v_mfma_f32_16x16x32_bf16 v[48:51], v[164:167], v[16:19], v[48:51]
    ds_read_b64 v[38:39], v14 offset:11272
    v_mfma_f32_16x16x32_bf16 v[52:55], v[164:167], v[20:23], v[52:55]
    v_mfma_f32_16x16x32_bf16 v[56:59], v[168:171], v[24:27], v[56:59]
    s_add_u32 m0, s97, 8192
    s_add_u32 s96, s69, s25
    buffer_load_dwordx4 v9, s[44:47], s96 offen sc1 lds
    buffer_load_dwordx4 v9, s[44:47], s96 offen offset:1024 sc1 lds
    v_mfma_f32_16x16x32_bf16 v[60:63], v[168:171], v[28:31], v[60:63]
    s_waitcnt lgkmcnt(0)
    v_max_u32 v11, v32, v34
    v_cmp_eq_u32 vcc, -1, v11
    v_mfma_f32_16x16x32_bf16 v[64:67], v[172:175], v[24:27], v[64:67]
    v_mfma_f32_16x16x32_bf16 v[68:71], v[172:175], v[28:31], v[68:71]
    s_cbranch_vccnz L_rh11
L_oh11:
    s_waitcnt vmcnt(8)
    ds_read_b64 v[16:17], v14 offset:0
    ds_read_b64 v[18:19], v14 offset:1024
    ds_read_b64 v[20:21], v14 offset:8
    ds_read_b64 v[22:23], v14 offset:1032
    v_mfma_f32_16x16x32_bf16 v[40:43], v[176:179], v[24:27], v[40:43]
    ds_write_b128 v8, v[56:59] offset:0
    v_mfma_f32_16x16x32_bf16 v[44:47], v[176:179], v[28:31], v[44:47]
    ds_write_b128 v8, v[60:63] offset:1024
    v_mfma_f32_16x16x32_bf16 v[48:51], v[180:183], v[24:27], v[48:51]
    ds_write_b128 v8, v[64:67] offset:2048
    v_mfma_f32_16x16x32_bf16 v[52:55], v[180:183], v[28:31], v[52:55]
    ds_write_b128 v8, v[68:71] offset:3072
    s_nop 0
    ds_write_b128 v7, v[40:43] offset:0
    s_nop 0
    ds_write_b128 v7, v[44:47] offset:1024
    s_nop 0
    ds_write_b128 v7, v[48:51] offset:2048
    s_nop 0
    ds_write_b128 v7, v[52:55] offset:3072
    s_waitcnt lgkmcnt(7)
    v_mfma_f32_16x16x32_bf16 v[56:59], a[0:3], v[32:35], 0
    s_add_u32 m0, s97, 10240
    s_add_u32 s96, s69, s26
    buffer_load_dwordx4 v9, s[44:47], s96 offen sc1 lds
    buffer_load_dwordx4 v9, s[44:47], s96 offen offset:1024 sc1 lds
    s_waitcnt lgkmcnt(6)
    v_mfma_f32_16x16x32_bf16 v[60:63], a[0:3], v[36:39], 0
    v_max_u32 v11, v16, v18
    v_cmp_eq_u32 vcc, -1, v11
    s_waitcnt lgkmcnt(5)
    v_mfma_f32_16x16x32_bf16 v[64:67], a[4:7], v[32:35], 0
    s_waitcnt lgkmcnt(4)
    v_mfma_f32_16x16x32_bf16 v[68:71], a[4:7], v[36:39], 0
    s_cbranch_vccnz L_rh12
L_oh12:
    s_waitcnt lgkmcnt(3)
    v_mfma_f32_16x16x32_bf16 v[40:43], a[8:11], v[32:35], 0
    s_waitcnt lgkmcnt(2)
    v_mfma_f32_16x16x32_bf16 v[44:47], a[8:11], v[36:39], 0
    s_waitcnt lgkmcnt(1)
    v_mfma_f32_16x16x32_bf16 v[48:51], a[12:15], v[32:35], 0
    s_waitcnt lgkmcnt(0)
    v_mfma_f32_16x16x32_bf16 v[52:55], a[12:15], v[36:39], 0
    s_waitcnt vmcnt(8)
    ds_read_b64 v[24:25], v14 offset:2048
    ds_read_b64 v[26:27], v14 offset:3072
    ds_read_b64 v[28:29], v14 offset:2056
    ds_read_b64 v[30:31], v14 offset:3080
    v_mfma_f32_16x16x32_bf16 v[56:59], a[16:19], v[16:19], v[56:59]
    s_add_u32 m0, s97, 0
    s_add_u32 s96, s69, s27
    buffer_load_dwordx4 v9, s[44:47], s96 offen sc1 lds
    buffer_load_dwordx4 v9, s[44:47], s96 offen offset:1024 sc1 lds
    v_mfma_f32_16x16x32_bf16 v[60:63], a[16:19], v[20:23], v[60:63]
    s_waitcnt lgkmcnt(0)
    v_max_u32 v11, v24, v26
    v_cmp_eq_u32 vcc, -1, v11
    v_mfma_f32_16x16x32_bf16 v[64:67], a[20:23], v[16:19], v[64:67]
    v_mfma_f32_16x16x32_bf16 v[68:71], a[20:23], v[20:23], v[68:71]
    s_cbranch_vccnz L_rh13
L_oh13:
    s_waitcnt vmcnt(8)
    ds_read_b64 v[32:33], v14 offset:4096
    v_mfma_f32_16x16x32_bf16 v[40:43], a[24:27], v[16:19], v[40:43]
    ds_read_b64 v[34:35], v14 offset:5120
    v_mfma_f32_16x16x32_bf16 v[44:47], a[24:27], v[20:23], v[44:47]
    ds_read_b64 v[36:37], v14 offset:4104
    v_mfma_f32_16x16x32_bf16 v[48:51], a[28:31], v[16:19], v[48:51]
    ds_read_b64 v[38:39], v14 offset:5128
    v_mfma_f32_16x16x32_bf16 v[52:55], a[28:31], v[20:23], v[52:55]
    v_mfma_f32_16x16x32_bf16 v[56:59], a[32:35], v[24:27], v[56:59]
    s_add_u32 m0, s97, 2048
    s_add_u32 s96, s69, s28
    buffer_load_dwordx4 v9, s[44:47], s96 offen sc1 lds
    buffer_load_dwordx4 v9, s[44:47], s96 offen offset:1024 sc1 lds
    v_mfma_f32_16x16x32_bf16 v[60:63], a[32:35], v[28:31], v[60:63]
    s_waitcnt lgkmcnt(0)
    v_max_u32 v11, v32, v34
    v_cmp_eq_u32 vcc, -1, v11
    v_mfma_f32_16x16x32_bf16 v[64:67], a[36:39], v[24:27], v[64:67]
    v_mfma_f32_16x16x32_bf16 v[68:71], a[36:39], v[28:31], v[68:71]
    s_cbranch_vccnz L_rh14
L_oh14:
    s_waitcnt vmcnt(8)
    ds_read_b64 v[16:17], v14 offset:6144
    v_mfma_f32_16x16x32_bf16 v[40:43], a[40:43], v[24:27], v[40:43]
    ds_read_b64 v[18:19], v14 offset:7168
    v_mfma_f32_16x16x32_bf16 v[44:47], a[40:43], v[28:31], v[44:47]
    ds_read_b64 v[20:21], v14 offset:6152
    v_mfma_f32_16x16x32_bf16 v[48:51], a[44:47], v[24:27], v[48:51]
    ds_read_b64 v[22:23], v14 offset:7176
    v_mfma_f32_16x16x32_bf16 v[52:55], a[44:47], v[28:31], v[52:55]
    v_mfma_f32_16x16x32_bf16 v[56:59], a[48:51], v[32:35], v[56:59]
    s_add_u32 m0, s97, 4096
    s_add_u32 s96, s69, s29
    buffer_load_dwordx4 v9, s[44:47], s96 offen sc1 lds
    buffer_load_dwordx4 v9, s[44:47], s96 offen offset:1024 sc1 lds
    v_mfma_f32_16x16x32_bf16 v[60:63], a[48:51], v[36:39], v[60:63]
    s_waitcnt lgkmcnt(0)
    v_max_u32 v11, v16, v18
    v_cmp_eq_u32 vcc, -1, v11
    v_mfma_f32_16x16x32_bf16 v[64:67], a[52:55], v[32:35], v[64:67]
    v_mfma_f32_16x16x32_bf16 v[68:71], a[52:55], v[36:39], v[68:71]
    s_cbranch_vccnz L_rh15
L_oh15:
    s_waitcnt vmcnt(8)
    ds_read_b64 v[24:25], v14 offset:8192
    v_mfma_f32_16x16x32_bf16 v[40:43], a[56:59], v[32:35], v[40:43]
    ds_read_b64 v[26:27], v14 offset:9216
    v_mfma_f32_16x16x32_bf16 v[44:47], a[56:59], v[36:39], v[44:47]
    ds_read_b64 v[28:29], v14 offset:8200
    v_mfma_f32_16x16x32_bf16 v[48:51], a[60:63], v[32:35], v[48:51]
    ds_read_b64 v[30:31], v14 offset:9224
    v_mfma_f32_16x16x32_bf16 v[52:55], a[60:63], v[36:39], v[52:55]
    v_mfma_f32_16x16x32_bf16 v[56:59], v[72:75], v[16:19], v[56:59]
    s_add_u32 m0, s97, 6144
    s_add_u32 s96, s69, s30
    buffer_load_dwordx4 v9, s[44:47], s96 offen sc1 lds
    buffer_load_dwordx4 v9, s[44:47], s96 offen offset:1024 sc1 lds
    v_mfma_f32_16x16x32_bf16 v[60:63], v[72:75], v[20:23], v[60:63]
    s_waitcnt lgkmcnt(0)
    v_max_u32 v11, v24, v26
    v_cmp_eq_u32 vcc, -1, v11
    v_mfma_f32_16x16x32_bf16 v[64:67], v[76:79], v[16:19], v[64:67]
    v_mfma_f32_16x16x32_bf16 v[68:71], v[76:79], v[20:23], v[68:71]
    s_cbranch_vccnz L_rh16
L_oh16:
    s_waitcnt vmcnt(8)
    ds_read_b64 v[32:33], v14 offset:10240
    v_mfma_f32_16x16x32_bf16 v[40:43], v[80:83], v[16:19], v[40:43]
    ds_read_b64 v[34:35], v14 offset:11264
    v_mfma_f32_16x16x32_bf16 v[44:47], v[80:83], v[20:23], v[44:47]
    ds_read_b64 v[36:37], v14 offset:10248
    v_mfma_f32_16x16x32_bf16 v[48:51], v[84:87], v[16:19], v[48:51]
    ds_read_b64 v[38:39], v14 offset:11272
    v_mfma_f32_16x16x32_bf16 v[52:55], v[84:87], v[20:23], v[52:55]
    s_barrier
    v_mfma_f32_16x16x32_bf16 v[56:59], v[88:91], v[24:27], v[56:59]
    v_mfma_f32_16x16x32_bf16 v[60:63], v[88:91], v[28:31], v[60:63]
    s_waitcnt lgkmcnt(0)
    v_max_u32 v11, v32, v34
    v_cmp_eq_u32 vcc, -1, v11
    v_mfma_f32_16x16x32_bf16 v[64:67], v[92:95], v[24:27], v[64:67]
    v_mfma_f32_16x16x32_bf16 v[68:71], v[92:95], v[28:31], v[68:71]
    s_cbranch_vccnz L_rh17
L_oh17:
    s_waitcnt vmcnt(6)
    ds_read_b64 v[16:17], v14 offset:0
    v_mfma_f32_16x16x32_bf16 v[40:43], v[96:99], v[24:27], v[40:43]
    ds_read_b64 v[18:19], v14 offset:1024
    v_mfma_f32_16x16x32_bf16 v[44:47], v[96:99], v[28:31], v[44:47]
    ds_read_b64 v[20:21], v14 offset:8
    v_mfma_f32_16x16x32_bf16 v[48:51], v[100:103], v[24:27], v[48:51]
    ds_read_b64 v[22:23], v14 offset:1032
    v_mfma_f32_16x16x32_bf16 v[52:55], v[100:103], v[28:31], v[52:55]
    v_mfma_f32_16x16x32_bf16 v[56:59], v[104:107], v[32:35], v[56:59]
    v_mfma_f32_16x16x32_bf16 v[60:63], v[104:107], v[36:39], v[60:63]
    s_waitcnt lgkmcnt(0)
    v_max_u32 v11, v16, v18
    v_cmp_eq_u32 vcc, -1, v11
    v_mfma_f32_16x16x32_bf16 v[64:67], v[108:111], v[32:35], v[64:67]
    buffer_load_dwordx2 v[72:73], v9, s[44:47], s95 offen offset:0 sc1
    buffer_load_dwordx2 v[74:75], v9, s[44:47], s95 offen offset:1024 sc1
    buffer_load_dwordx2 v[76:77], v9, s[44:47], s95 offen offset:2048 sc1
    buffer_load_dwordx2 v[78:79], v9, s[44:47], s95 offen offset:3072 sc1
    buffer_load_dwordx2 v[80:81], v12, s[44:47], s67 offen sc1
    v_mfma_f32_16x16x32_bf16 v[68:71], v[108:111], v[36:39], v[68:71]
    s_cbranch_vccnz L_rh18
L_oh18:
    s_waitcnt vmcnt(9)
    ds_read_b64 v[24:25], v14 offset:2048
    v_mfma_f32_16x16x32_bf16 v[40:43], v[112:115], v[32:35], v[40:43]
    ds_read_b64 v[26:27], v14 offset:3072
    v_mfma_f32_16x16x32_bf16 v[44:47], v[112:115], v[36:39], v[44:47]
    ds_read_b64 v[28:29], v14 offset:2056
    v_mfma_f32_16x16x32_bf16 v[48:51], v[116:119], v[32:35], v[48:51]
    ds_read_b64 v[30:31], v14 offset:3080
    v_mfma_f32_16x16x32_bf16 v[52:55], v[116:119], v[36:39], v[52:55]
    v_mfma_f32_16x16x32_bf16 v[56:59], v[120:123], v[16:19], v[56:59]
    v_mfma_f32_16x16x32_bf16 v[60:63], v[120:123], v[20:23], v[60:63]
    s_waitcnt lgkmcnt(0)
    v_max_u32 v11, v24, v26
    v_cmp_eq_u32 vcc, -1, v11
    v_mfma_f32_16x16x32_bf16 v[64:67], v[124:127], v[16:19], v[64:67]
    v_mfma_f32_16x16x32_bf16 v[68:71], v[124:127], v[20:23], v[68:71]
    s_cbranch_vccnz L_rh19
L_oh19:
    s_waitcnt vmcnt(7)
    ds_read_b64 v[32:33], v14 offset:4096
    v_mfma_f32_16x16x32_bf16 v[40:43], v[128:131], v[16:19], v[40:43]
    ds_read_b64 v[34:35], v14 offset:5120
    v_mfma_f32_16x16x32_bf16 v[44:47], v[128:131], v[20:23], v[44:47]
    ds_read_b64 v[36:37], v14 offset:4104
    v_mfma_f32_16x16x32_bf16 v[48:51], v[132:135], v[16:19], v[48:51]
    ds_read_b64 v[38:39], v14 offset:5128
    v_mfma_f32_16x16x32_bf16 v[52:55], v[132:135], v[20:23], v[52:55]
    v_mfma_f32_16x16x32_bf16 v[56:59], v[136:139], v[24:27], v[56:59]
    v_mfma_f32_16x16x32_bf16 v[60:63], v[136:139], v[28:31], v[60:63]
    s_waitcnt lgkmcnt(0)
    v_max_u32 v11, v32, v34
    v_cmp_eq_u32 vcc, -1, v11
    v_mfma_f32_16x16x32_bf16 v[64:67], v[140:143], v[24:27], v[64:67]
    v_mfma_f32_16x16x32_bf16 v[68:71], v[140:143], v[28:31], v[68:71]
    s_cbranch_vccnz L_rh20
L_oh20:
    s_waitcnt vmcnt(5)
    ds_read_b64 v[16:17], v14 offset:6144
    v_mfma_f32_16x16x32_bf16 v[40:43], v[144:147], v[24:27], v[40:43]
    ds_read_b64 v[18:19], v14 offset:7168
    v_mfma_f32_16x16x32_bf16 v[44:47], v[144:147], v[28:31], v[44:47]
    ds_read_b64 v[20:21], v14 offset:6152
    v_mfma_f32_16x16x32_bf16 v[48:51], v[148:151], v[24:27], v[48:51]
    ds_read_b64 v[22:23], v14 offset:7176
    v_mfma_f32_16x16x32_bf16 v[52:55], v[148:151], v[28:31], v[52:55]
    v_mfma_f32_16x16x32_bf16 v[56:59], v[152:155], v[32:35], v[56:59]
    v_mfma_f32_16x16x32_bf16 v[60:63], v[152:155], v[36:39], v[60:63]
    s_waitcnt lgkmcnt(0)
    v_max_u32 v11, v16, v18
    v_cmp_eq_u32 vcc, -1, v11
    v_mfma_f32_16x16x32_bf16 v[64:67], v[156:159], v[32:35], v[64:67]
    v_mfma_f32_16x16x32_bf16 v[68:71], v[156:159], v[36:39], v[68:71]
    s_cbranch_vccnz L_rh21
L_oh21:
    ds_read_b128 v[104:107], v10 offset:4096
    v_mfma_f32_16x16x32_bf16 v[40:43], v[160:163], v[32:35], v[40:43]
    ds_read_b128 v[108:111], v10 offset:5120
    ds_read_b128 v[112:115], v10 offset:6144
    v_mfma_f32_16x16x32_bf16 v[44:47], v[160:163], v[36:39], v[44:47]
    ds_read_b128 v[116:119], v10 offset:7168
    ds_read_b128 v[120:123], v10 offset:8192
    v_mfma_f32_16x16x32_bf16 v[48:51], v[164:167], v[32:35], v[48:51]
    ds_read_b128 v[124:127], v10 offset:9216
    ds_read_b128 v[128:131], v10 offset:10240
    v_mfma_f32_16x16x32_bf16 v[52:55], v[164:167], v[36:39], v[52:55]
    ds_read_b128 v[132:135], v10 offset:11264
    s_waitcnt vmcnt(0)
    v_mfma_f32_16x16x32_bf16 v[56:59], v[168:171], v[16:19], v[56:59]
    v_lshlrev_b32 v88, 16, v72
    v_and_b32 v89, s65, v72
    v_mfma_f32_16x16x32_bf16 v[60:63], v[168:171], v[20:23], v[60:63]
    v_lshlrev_b32 v96, 16, v73
    v_and_b32 v97, s65, v73
    v_mfma_f32_16x16x32_bf16 v[64:67], v[172:175], v[16:19], v[64:67]
    v_lshlrev_b32 v90, 16, v74
    v_and_b32 v91, s65, v74
    v_mfma_f32_16x16x32_bf16 v[68:71], v[172:175], v[20:23], v[68:71]
    v_lshlrev_b32 v98, 16, v75
    v_and_b32 v99, s65, v75
    v_mfma_f32_16x16x32_bf16 v[40:43], v[176:179], v[16:19], v[40:43]
    v_lshlrev_b32 v92, 16, v76
    v_and_b32 v93, s65, v76
    ds_write_b128 v6, v[56:59] offset:0
    v_mfma_f32_16x16x32_bf16 v[44:47], v[176:179], v[20:23], v[44:47]
    v_lshlrev_b32 v100, 16, v77
    v_and_b32 v101, s65, v77
    ds_write_b128 v6, v[60:63] offset:1024
    v_mfma_f32_16x16x32_bf16 v[48:51], v[180:183], v[16:19], v[48:51]
    v_lshlrev_b32 v94, 16, v78
    v_and_b32 v95, s65, v78
    ds_write_b128 v6, v[64:67] offset:2048
    v_mfma_f32_16x16x32_bf16 v[52:55], v[180:183], v[20:23], v[52:55]
    v_lshlrev_b32 v102, 16, v79
    v_and_b32 v103, s65, v79
    ds_write_b128 v6, v[68:71] offset:3072
    v_cmp_eq_u32 vcc, -1, v80
    s_waitcnt lgkmcnt(0)
    s_cbranch_vccnz L_rr2
L_or2:
    s_barrier
    ds_read_b128 v[136:139], v10 offset:0
    ds_read_b128 v[140:143], v10 offset:1024
    ds_read_b128 v[144:147], v10 offset:2048
    ds_read_b128 v[148:151], v10 offset:3072
    v_pk_add_f32 v[104:105], v[104:105], v[120:121]
    v_pk_add_f32 v[106:107], v[106:107], v[122:123]
    v_pk_add_f32 v[108:109], v[108:109], v[124:125]
    v_pk_add_f32 v[110:111], v[110:111], v[126:127]
    v_pk_add_f32 v[112:113], v[112:113], v[128:129]
    v_pk_add_f32 v[114:115], v[114:115], v[130:131]
    v_pk_add_f32 v[116:117], v[116:117], v[132:133]
    v_pk_add_f32 v[118:119], v[118:119], v[134:135]
    v_pk_add_f32 v[40:41], v[40:41], v[104:105]
    v_pk_add_f32 v[42:43], v[42:43], v[106:107]
    v_pk_add_f32 v[44:45], v[44:45], v[108:109]
    v_pk_add_f32 v[46:47], v[46:47], v[110:111]
    v_pk_add_f32 v[48:49], v[48:49], v[112:113]
    v_pk_add_f32 v[50:51], v[50:51], v[114:115]
    v_pk_add_f32 v[52:53], v[52:53], v[116:117]
    v_pk_add_f32 v[54:55], v[54:55], v[118:119]
    s_waitcnt lgkmcnt(0)
    v_pk_add_f32 v[40:41], v[40:41], v[136:137]
    v_pk_add_f32 v[42:43], v[42:43], v[138:139]
    v_pk_add_f32 v[44:45], v[44:45], v[140:141]
    v_pk_add_f32 v[46:47], v[46:47], v[142:143]
    v_pk_add_f32 v[48:49], v[48:49], v[144:145]
    v_pk_add_f32 v[50:51], v[50:51], v[146:147]
    v_pk_add_f32 v[52:53], v[52:53], v[148:149]
    v_pk_add_f32 v[54:55], v[54:55], v[150:151]
    v_pk_fma_f32 v[40:41], v[40:41], v[80:81], v[88:89] op_sel:[0,0,0] op_sel_hi:[1,0,1]
    v_pk_fma_f32 v[42:43], v[42:43], v[80:81], v[90:91] op_sel:[0,0,0] op_sel_hi:[1,0,1]
    v_pk_fma_f32 v[48:49], v[48:49], v[80:81], v[92:93] op_sel:[0,0,0] op_sel_hi:[1,0,1]
    v_pk_fma_f32 v[50:51], v[50:51], v[80:81], v[94:95] op_sel:[0,0,0] op_sel_hi:[1,0,1]
    v_cvt_pk_bf16_f32 v16, v40, v41
    v_cvt_pk_bf16_f32 v17, v42, v43
    v_cvt_pk_bf16_f32 v18, v48, v49
    v_cvt_pk_bf16_f32 v19, v50, v51
    buffer_store_dwordx4 v[16:19], v5, s[40:43], s77 offen offset:0
    v_pk_fma_f32 v[44:45], v[44:45], v[80:81], v[96:97] op_sel:[0,1,0] op_sel_hi:[1,1,1]
    v_pk_fma_f32 v[46:47], v[46:47], v[80:81], v[98:99] op_sel:[0,1,0] op_sel_hi:[1,1,1]
    v_pk_fma_f32 v[52:53], v[52:53], v[80:81], v[100:101] op_sel:[0,1,0] op_sel_hi:[1,1,1]
    v_pk_fma_f32 v[54:55], v[54:55], v[80:81], v[102:103] op_sel:[0,1,0] op_sel_hi:[1,1,1]
    v_cvt_pk_bf16_f32 v20, v44, v45
    v_cvt_pk_bf16_f32 v21, v46, v47
    v_cvt_pk_bf16_f32 v22, v52, v53
    v_cvt_pk_bf16_f32 v23, v54, v55
    buffer_store_dwordx4 v[20:23], v5, s[40:43], s77 offen offset:2048
    s_or_b32 s55, s2, s3
    s_cmp_lg_u32 s55, 0
    s_cselect_b32 s55, 0x40000000, 0
    v_mov_b32 v14, s84
    s_mov_b64 exec, 1
    buffer_store_dword v14, v9, s[44:47], s55 offen
    s_mov_b64 exec, -1
L_end:
    s_endpgm
    s_nop 7
L_rup:
    s_sub_u32 s85, s85, 1
    s_cbranch_scc1 L_xup
    buffer_load_dword v14, v8, s[44:47], s63 offen sc1
    s_waitcnt vmcnt(0)
    v_cmp_ne_u32 vcc, s84, v14
    s_cbranch_vccnz L_rup
    s_branch L_oup
L_xup:
    s_mov_b32 s85, 0
    s_branch L_oup
    s_nop 7
L_rb4a:
    s_sub_u32 s85, s85, 1
    s_cbranch_scc1 L_xb4a
    ds_read_b32 v12, v3 offset:40
    s_waitcnt lgkmcnt(0)
    v_cmp_ne_u32 vcc, 8, v12
    s_cbranch_vccnz L_rb4a
    s_branch L_ob4a
L_xb4a:
    s_mov_b32 s85, 0
    s_branch L_ob4a
    s_nop 7
L_rkc:
    s_sub_u32 s85, s85, 1
    s_cbranch_scc1 L_xkc
    ds_read_b32 v12, v3 offset:16
    s_waitcnt lgkmcnt(0)
    v_cmp_ne_u32 vcc, 4, v12
    s_cbranch_vccnz L_rkc
    s_branch L_okc
L_xkc:
    s_mov_b32 s85, 0
    s_branch L_okc
    s_nop 7
L_rxP:
    s_sub_u32 s85, s85, 1
    s_cbranch_scc1 L_xxP
    s_add_u32 s55, s88, 0
    s_and_b32 s55, s55, 15
    s_lshl_b32 s55, s55, 14
    s_add_u32 s97, s55, s67
    buffer_load_dwordx4 v[16:19], v7, s[44:47], s97 offen offset:0 sc1
    buffer_load_dwordx4 v[20:23], v7, s[44:47], s97 offen offset:1024 sc1
    buffer_load_dwordx4 v[24:27], v7, s[44:47], s97 offen offset:2048 sc1
    buffer_load_dwordx4 v[28:31], v7, s[44:47], s97 offen offset:3072 sc1
    s_waitcnt vmcnt(0)
    v_max3_u32 v11, v16, v20, v24
    v_max_u32 v11, v11, v28
    v_cmp_eq_u32 vcc, -1, v11
    s_cbranch_vccnz L_rxP
    s_branch L_oxP
L_xxP:
    s_mov_b32 s85, 0
    s_branch L_oxP
    s_nop 7
L_rxa1:
    s_sub_u32 s85, s85, 1
    s_cbranch_scc1 L_xxa1
    s_add_u32 s55, s88, 1
    s_and_b32 s55, s55, 15
    s_lshl_b32 s55, s55, 14
    s_add_u32 s97, s55, s67
    buffer_load_dwordx4 v[32:35], v7, s[44:47], s97 offen offset:0 sc1
    buffer_load_dwordx4 v[36:39], v7, s[44:47], s97 offen offset:1024 sc1
    buffer_load_dwordx4 v[40:43], v7, s[44:47], s97 offen offset:2048 sc1
    buffer_load_dwordx4 v[44:47], v7, s[44:47], s97 offen offset:3072 sc1
    s_waitcnt vmcnt(0)
    v_max3_u32 v11, v32, v36, v40
    v_max_u32 v11, v11, v44
    v_cmp_eq_u32 vcc, -1, v11
    s_cbranch_vccnz L_rxa1
    s_branch L_oxa1
L_xxa1:
    s_mov_b32 s85, 0
    s_branch L_oxa1
    s_nop 7
L_rxa2:
    s_sub_u32 s85, s85, 1
    s_cbranch_scc1 L_xxa2
    s_add_u32 s55, s88, 2
    s_and_b32 s55, s55, 15
    s_lshl_b32 s55, s55, 14
    s_add_u32 s97, s55, s67
    buffer_load_dwordx4 v[48:51], v7, s[44:47], s97 offen offset:0 sc1
    buffer_load_dwordx4 v[52:55], v7, s[44:47], s97 offen offset:1024 sc1
    buffer_load_dwordx4 v[56:59], v7, s[44:47], s97 offen offset:2048 sc1
    buffer_load_dwordx4 v[60:63], v7, s[44:47], s97 offen offset:3072 sc1
    s_waitcnt vmcnt(0)
    v_max3_u32 v11, v48, v52, v56
    v_max_u32 v11, v11, v60
    v_cmp_eq_u32 vcc, -1, v11
    s_cbranch_vccnz L_rxa2
    s_branch L_oxa2
L_xxa2:
    s_mov_b32 s85, 0
    s_branch L_oxa2
    s_nop 7
L_rxa3:
    s_sub_u32 s85, s85, 1
    s_cbranch_scc1 L_xxa3
    s_add_u32 s55, s88, 3
    s_and_b32 s55, s55, 15
    s_lshl_b32 s55, s55, 14
    s_add_u32 s97, s55, s67
    buffer_load_dwordx4 v[64:67], v7, s[44:47], s97 offen offset:0 sc1
    buffer_load_dwordx4 v[68:71], v7, s[44:47], s97 offen offset:1024 sc1
    buffer_load_dwordx4 v[72:75], v7, s[44:47], s97 offen offset:2048 sc1
    buffer_load_dwordx4 v[76:79], v7, s[44:47], s97 offen offset:3072 sc1
    s_waitcnt vmcnt(0)
    v_max3_u32 v11, v64, v68, v72
    v_max_u32 v11, v11, v76
    v_cmp_eq_u32 vcc, -1, v11
    s_cbranch_vccnz L_rxa3
    s_branch L_oxa3
L_xxa3:
    s_mov_b32 s85, 0
    s_branch L_oxa3
    s_nop 7
L_rxa4:
    s_sub_u32 s85, s85, 1
    s_cbranch_scc1 L_xxa4
    s_add_u32 s55, s88, 4
    s_and_b32 s55, s55, 15
    s_lshl_b32 s55, s55, 14
    s_add_u32 s97, s55, s67
    buffer_load_dwordx4 v[16:19], v7, s[44:47], s97 offen offset:0 sc1
    buffer_load_dwordx4 v[20:23], v7, s[44:47], s97 offen offset:1024 sc1
    buffer_load_dwordx4 v[24:27], v7, s[44:47], s97 offen offset:2048 sc1
    buffer_load_dwordx4 v[28:31], v7, s[44:47], s97 offen offset:3072 sc1
    s_waitcnt vmcnt(0)
    v_max3_u32 v11, v16, v20, v24
    v_max_u32 v11, v11, v28
    v_cmp_eq_u32 vcc, -1, v11
    s_cbranch_vccnz L_rxa4
    s_branch L_oxa4
L_xxa4:
    s_mov_b32 s85, 0
    s_branch L_oxa4
    s_nop 7
L_rxa5:
    s_sub_u32 s85, s85, 1
    s_cbranch_scc1 L_xxa5
    s_add_u32 s55, s88, 5
    s_and_b32 s55, s55, 15
    s_lshl_b32 s55, s55, 14
    s_add_u32 s97, s55, s67
    buffer_load_dwordx4 v[32:35], v7, s[44:47], s97 offen offset:0 sc1
    buffer_load_dwordx4 v[36:39], v7, s[44:47], s97 offen offset:1024 sc1
    buffer_load_dwordx4 v[40:43], v7, s[44:47], s97 offen offset:2048 sc1
    buffer_load_dwordx4 v[44:47], v7, s[44:47], s97 offen offset:3072 sc1
    s_waitcnt vmcnt(0)
    v_max3_u32 v11, v32, v36, v40
    v_max_u32 v11, v11, v44
    v_cmp_eq_u32 vcc, -1, v11
    s_cbranch_vccnz L_rxa5
    s_branch L_oxa5
L_xxa5:
    s_mov_b32 s85, 0
    s_branch L_oxa5
    s_nop 7
L_rxa6:
    s_sub_u32 s85, s85, 1
    s_cbranch_scc1 L_xxa6
    s_add_u32 s55, s88, 6
    s_and_b32 s55, s55, 15
    s_lshl_b32 s55, s55, 14
    s_add_u32 s97, s55, s67
    buffer_load_dwordx4 v[48:51], v7, s[44:47], s97 offen offset:0 sc1
    buffer_load_dwordx4 v[52:55], v7, s[44:47], s97 offen offset:1024 sc1
    buffer_load_dwordx4 v[56:59], v7, s[44:47], s97 offen offset:2048 sc1
    buffer_load_dwordx4 v[60:63], v7, s[44:47], s97 offen offset:3072 sc1
    s_waitcnt vmcnt(0)
    v_max3_u32 v11, v48, v52, v56
    v_max_u32 v11, v11, v60
    v_cmp_eq_u32 vcc, -1, v11
    s_cbranch_vccnz L_rxa6
    s_branch L_oxa6
L_xxa6:
    s_mov_b32 s85, 0
    s_branch L_oxa6
    s_nop 7
L_rxa7:
    s_sub_u32 s85, s85, 1
    s_cbranch_scc1 L_xxa7
    s_add_u32 s55, s88, 7
    s_and_b32 s55, s55, 15
    s_lshl_b32 s55, s55, 14
    s_add_u32 s97, s55, s67
    buffer_load_dwordx4 v[64:67], v7, s[44:47], s97 offen offset:0 sc1
    buffer_load_dwordx4 v[68:71], v7, s[44:47], s97 offen offset:1024 sc1
    buffer_load_dwordx4 v[72:75], v7, s[44:47], s97 offen offset:2048 sc1
    buffer_load_dwordx4 v[76:79], v7, s[44:47], s97 offen offset:3072 sc1
    s_waitcnt vmcnt(0)
    v_max3_u32 v11, v64, v68, v72
    v_max_u32 v11, v11, v76
    v_cmp_eq_u32 vcc, -1, v11
    s_cbranch_vccnz L_rxa7
    s_branch L_oxa7
L_xxa7:
    s_mov_b32 s85, 0
    s_branch L_oxa7
    s_nop 7
L_rxa8:
    s_sub_u32 s85, s85, 1
    s_cbranch_scc1 L_xxa8
    s_add_u32 s55, s88, 8
    s_and_b32 s55, s55, 15
    s_lshl_b32 s55, s55, 14
    s_add_u32 s97, s55, s67
    buffer_load_dwordx4 v[16:19], v7, s[44:47], s97 offen offset:0 sc1
    buffer_load_dwordx4 v[20:23], v7, s[44:47], s97 offen offset:1024 sc1
    buffer_load_dwordx4 v[24:27], v7, s[44:47], s97 offen offset:2048 sc1
    buffer_load_dwordx4 v[28:31], v7, s[44:47], s97 offen offset:3072 sc1
    s_waitcnt vmcnt(0)
    v_max3_u32 v11, v16, v20, v24
    v_max_u32 v11, v11, v28
    v_cmp_eq_u32 vcc, -1, v11
    s_cbranch_vccnz L_rxa8
    s_branch L_oxa8
L_xxa8:
    s_mov_b32 s85, 0
    s_branch L_oxa8
    s_nop 7
L_rxa9:
    s_sub_u32 s85, s85, 1
    s_cbranch_scc1 L_xxa9
    s_add_u32 s55, s88, 9
    s_and_b32 s55, s55, 15
    s_lshl_b32 s55, s55, 14
    s_add_u32 s97, s55, s67
    buffer_load_dwordx4 v[32:35], v7, s[44:47], s97 offen offset:0 sc1
    buffer_load_dwordx4 v[36:39], v7, s[44:47], s97 offen offset:1024 sc1
    buffer_load_dwordx4 v[40:43], v7, s[44:47], s97 offen offset:2048 sc1
    buffer_load_dwordx4 v[44:47], v7, s[44:47], s97 offen offset:3072 sc1
    s_waitcnt vmcnt(0)
    v_max3_u32 v11, v32, v36, v40
    v_max_u32 v11, v11, v44
    v_cmp_eq_u32 vcc, -1, v11
    s_cbranch_vccnz L_rxa9
    s_branch L_oxa9
L_xxa9:
    s_mov_b32 s85, 0
    s_branch L_oxa9
    s_nop 7
L_rfa9:
    s_sub_u32 s85, s85, 1
    s_cbranch_scc1 L_xfa9
    ds_read_b32 v12, v3 offset:0
    s_waitcnt lgkmcnt(0)
    v_cmp_ne_u32 vcc, 4, v12
    s_cbranch_vccnz L_rfa9
    s_branch L_ofa9
L_xfa9:
    s_mov_b32 s85, 0
    s_branch L_ofa9
    s_nop 7
L_rxa10:
    s_sub_u32 s85, s85, 1
    s_cbranch_scc1 L_xxa10
    s_add_u32 s55, s88, 10
    s_and_b32 s55, s55, 15
    s_lshl_b32 s55, s55, 14
    s_add_u32 s97, s55, s67
    buffer_load_dwordx4 v[48:51], v7, s[44:47], s97 offen offset:0 sc1
    buffer_load_dwordx4 v[52:55], v7, s[44:47], s97 offen offset:1024 sc1
    buffer_load_dwordx4 v[56:59], v7, s[44:47], s97 offen offset:2048 sc1
    buffer_load_dwordx4 v[60:63], v7, s[44:47], s97 offen offset:3072 sc1
    s_waitcnt vmcnt(0)
    v_max3_u32 v11, v48, v52, v56
    v_max_u32 v11, v11, v60
    v_cmp_eq_u32 vcc, -1, v11
    s_cbranch_vccnz L_rxa10
    s_branch L_oxa10
L_xxa10:
    s_mov_b32 s85, 0
    s_branch L_oxa10
    s_nop 7
L_rxa11:
    s_sub_u32 s85, s85, 1
    s_cbranch_scc1 L_xxa11
    s_add_u32 s55, s88, 11
    s_and_b32 s55, s55, 15
    s_lshl_b32 s55, s55, 14
    s_add_u32 s97, s55, s67
    buffer_load_dwordx4 v[64:67], v7, s[44:47], s97 offen offset:0 sc1
    buffer_load_dwordx4 v[68:71], v7, s[44:47], s97 offen offset:1024 sc1
    buffer_load_dwordx4 v[72:75], v7, s[44:47], s97 offen offset:2048 sc1
    buffer_load_dwordx4 v[76:79], v7, s[44:47], s97 offen offset:3072 sc1
    s_waitcnt vmcnt(0)
    v_max3_u32 v11, v64, v68, v72
    v_max_u32 v11, v11, v76
    v_cmp_eq_u32 vcc, -1, v11
    s_cbranch_vccnz L_rxa11
    s_branch L_oxa11
L_xxa11:
    s_mov_b32 s85, 0
    s_branch L_oxa11
    s_nop 7
L_rxa12:
    s_sub_u32 s85, s85, 1
    s_cbranch_scc1 L_xxa12
    s_add_u32 s55, s88, 12
    s_and_b32 s55, s55, 15
    s_lshl_b32 s55, s55, 14
    s_add_u32 s97, s55, s67
    buffer_load_dwordx4 v[16:19], v7, s[44:47], s97 offen offset:0 sc1
    buffer_load_dwordx4 v[20:23], v7, s[44:47], s97 offen offset:1024 sc1
    buffer_load_dwordx4 v[24:27], v7, s[44:47], s97 offen offset:2048 sc1
    buffer_load_dwordx4 v[28:31], v7, s[44:47], s97 offen offset:3072 sc1
    s_waitcnt vmcnt(0)
    v_max3_u32 v11, v16, v20, v24
    v_max_u32 v11, v11, v28
    v_cmp_eq_u32 vcc, -1, v11
    s_cbranch_vccnz L_rxa12
    s_branch L_oxa12
L_xxa12:
    s_mov_b32 s85, 0
    s_branch L_oxa12
    s_nop 7
L_rxa13:
    s_sub_u32 s85, s85, 1
    s_cbranch_scc1 L_xxa13
    s_add_u32 s55, s88, 13
    s_and_b32 s55, s55, 15
    s_lshl_b32 s55, s55, 14
    s_add_u32 s97, s55, s67
    buffer_load_dwordx4 v[32:35], v7, s[44:47], s97 offen offset:0 sc1
    buffer_load_dwordx4 v[36:39], v7, s[44:47], s97 offen offset:1024 sc1
    buffer_load_dwordx4 v[40:43], v7, s[44:47], s97 offen offset:2048 sc1
    buffer_load_dwordx4 v[44:47], v7, s[44:47], s97 offen offset:3072 sc1
    s_waitcnt vmcnt(0)
    v_max3_u32 v11, v32, v36, v40
    v_max_u32 v11, v11, v44
    v_cmp_eq_u32 vcc, -1, v11
    s_cbranch_vccnz L_rxa13
    s_branch L_oxa13
L_xxa13:
    s_mov_b32 s85, 0
    s_branch L_oxa13
    s_nop 7
L_rxa14:
    s_sub_u32 s85, s85, 1
    s_cbranch_scc1 L_xxa14
    s_add_u32 s55, s88, 14
    s_and_b32 s55, s55, 15
    s_lshl_b32 s55, s55, 14
    s_add_u32 s97, s55, s67
    buffer_load_dwordx4 v[48:51], v7, s[44:47], s97 offen offset:0 sc1
    buffer_load_dwordx4 v[52:55], v7, s[44:47], s97 offen offset:1024 sc1
    buffer_load_dwordx4 v[56:59], v7, s[44:47], s97 offen offset:2048 sc1
    buffer_load_dwordx4 v[60:63], v7, s[44:47], s97 offen offset:3072 sc1
    s_waitcnt vmcnt(0)
    v_max3_u32 v11, v48, v52, v56
    v_max_u32 v11, v11, v60
    v_cmp_eq_u32 vcc, -1, v11
    s_cbranch_vccnz L_rxa14
    s_branch L_oxa14
L_xxa14:
    s_mov_b32 s85, 0
    s_branch L_oxa14
    s_nop 7
L_rxa15:
    s_sub_u32 s85, s85, 1
    s_cbranch_scc1 L_xxa15
    s_add_u32 s55, s88, 15
    s_and_b32 s55, s55, 15
    s_lshl_b32 s55, s55, 14
    s_add_u32 s97, s55, s67
    buffer_load_dwordx4 v[64:67], v7, s[44:47], s97 offen offset:0 sc1
    buffer_load_dwordx4 v[68:71], v7, s[44:47], s97 offen offset:1024 sc1
    buffer_load_dwordx4 v[72:75], v7, s[44:47], s97 offen offset:2048 sc1
    buffer_load_dwordx4 v[76:79], v7, s[44:47], s97 offen offset:3072 sc1
    s_waitcnt vmcnt(0)
    v_max3_u32 v11, v64, v68, v72
    v_max_u32 v11, v11, v76
    v_cmp_eq_u32 vcc, -1, v11
    s_cbranch_vccnz L_rxa15
    s_branch L_oxa15
L_xxa15:
    s_mov_b32 s85, 0
    s_branch L_oxa15
    s_nop 7
L_rfa15:
    s_sub_u32 s85, s85, 1
    s_cbranch_scc1 L_xfa15
    ds_read_b32 v12, v3 offset:4
    s_waitcnt lgkmcnt(0)
    v_cmp_ne_u32 vcc, 4, v12
    s_cbranch_vccnz L_rfa15
    s_branch L_ofa15
L_xfa15:
    s_mov_b32 s85, 0
    s_branch L_ofa15
    s_nop 7
L_rxb1:
    s_sub_u32 s85, s85, 1
    s_cbranch_scc1 L_xxb1
    s_add_u32 s55, s88, 1
    s_and_b32 s55, s55, 15
    s_lshl_b32 s55, s55, 14
    s_add_u32 s97, s55, s67
    buffer_load_dwordx4 v[32:35], v7, s[44:47], s97 offen offset:0 sc1
    buffer_load_dwordx4 v[36:39], v7, s[44:47], s97 offen offset:1024 sc1
    buffer_load_dwordx4 v[40:43], v7, s[44:47], s97 offen offset:2048 sc1
    buffer_load_dwordx4 v[44:47], v7, s[44:47], s97 offen offset:3072 sc1
    s_waitcnt vmcnt(0)
    v_max3_u32 v11, v32, v36, v40
    v_max_u32 v11, v11, v44
    v_cmp_eq_u32 vcc, -1, v11
    s_cbranch_vccnz L_rxb1
    s_branch L_oxb1
L_xxb1:
    s_mov_b32 s85, 0
    s_branch L_oxb1
    s_nop 7
L_rxb2:
    s_sub_u32 s85, s85, 1
    s_cbranch_scc1 L_xxb2
    s_add_u32 s55, s88, 2
    s_and_b32 s55, s55, 15
    s_lshl_b32 s55, s55, 14
    s_add_u32 s97, s55, s67
    buffer_load_dwordx4 v[48:51], v7, s[44:47], s97 offen offset:0 sc1
    buffer_load_dwordx4 v[52:55], v7, s[44:47], s97 offen offset:1024 sc1
    buffer_load_dwordx4 v[56:59], v7, s[44:47], s97 offen offset:2048 sc1
    buffer_load_dwordx4 v[60:63], v7, s[44:47], s97 offen offset:3072 sc1
    s_waitcnt vmcnt(0)
    v_max3_u32 v11, v48, v52, v56
    v_max_u32 v11, v11, v60
    v_cmp_eq_u32 vcc, -1, v11
    s_cbranch_vccnz L_rxb2
    s_branch L_oxb2
L_xxb2:
    s_mov_b32 s85, 0
    s_branch L_oxb2
    s_nop 7
L_rxb3:
    s_sub_u32 s85, s85, 1
    s_cbranch_scc1 L_xxb3
    s_add_u32 s55, s88, 3
    s_and_b32 s55, s55, 15
    s_lshl_b32 s55, s55, 14
    s_add_u32 s97, s55, s67
    buffer_load_dwordx4 v[64:67], v7, s[44:47], s97 offen offset:0 sc1
    buffer_load_dwordx4 v[68:71], v7, s[44:47], s97 offen offset:1024 sc1
    buffer_load_dwordx4 v[72:75], v7, s[44:47], s97 offen offset:2048 sc1
    buffer_load_dwordx4 v[76:79], v7, s[44:47], s97 offen offset:3072 sc1
    s_waitcnt vmcnt(0)
    v_max3_u32 v11, v64, v68, v72
    v_max_u32 v11, v11, v76
    v_cmp_eq_u32 vcc, -1, v11
    s_cbranch_vccnz L_rxb3
    s_branch L_oxb3
L_xxb3:
    s_mov_b32 s85, 0
    s_branch L_oxb3
    s_nop 7
L_rxb4:
    s_sub_u32 s85, s85, 1
    s_cbranch_scc1 L_xxb4
    s_add_u32 s55, s88, 4
    s_and_b32 s55, s55, 15
    s_lshl_b32 s55, s55, 14
    s_add_u32 s97, s55, s67
    buffer_load_dwordx4 v[16:19], v7, s[44:47], s97 offen offset:0 sc1
    buffer_load_dwordx4 v[20:23], v7, s[44:47], s97 offen offset:1024 sc1
    buffer_load_dwordx4 v[24:27], v7, s[44:47], s97 offen offset:2048 sc1
    buffer_load_dwordx4 v[28:31], v7, s[44:47], s97 offen offset:3072 sc1
    s_waitcnt vmcnt(0)
    v_max3_u32 v11, v16, v20, v24
    v_max_u32 v11, v11, v28
    v_cmp_eq_u32 vcc, -1, v11
    s_cbranch_vccnz L_rxb4
    s_branch L_oxb4
L_xxb4:
    s_mov_b32 s85, 0
    s_branch L_oxb4
    s_nop 7
L_rxb5:
    s_sub_u32 s85, s85, 1
    s_cbranch_scc1 L_xxb5
    s_add_u32 s55, s88, 5
    s_and_b32 s55, s55, 15
    s_lshl_b32 s55, s55, 14
    s_add_u32 s97, s55, s67
    buffer_load_dwordx4 v[32:35], v7, s[44:47], s97 offen offset:0 sc1
    buffer_load_dwordx4 v[36:39], v7, s[44:47], s97 offen offset:1024 sc1
    buffer_load_dwordx4 v[40:43], v7, s[44:47], s97 offen offset:2048 sc1
    buffer_load_dwordx4 v[44:47], v7, s[44:47], s97 offen offset:3072 sc1
    s_waitcnt vmcnt(0)
    v_max3_u32 v11, v32, v36, v40
    v_max_u32 v11, v11, v44
    v_cmp_eq_u32 vcc, -1, v11
    s_cbranch_vccnz L_rxb5
    s_branch L_oxb5
L_xxb5:
    s_mov_b32 s85, 0
    s_branch L_oxb5
    s_nop 7
L_rxb6:
    s_sub_u32 s85, s85, 1
    s_cbranch_scc1 L_xxb6
    s_add_u32 s55, s88, 6
    s_and_b32 s55, s55, 15
    s_lshl_b32 s55, s55, 14
    s_add_u32 s97, s55, s67
    buffer_load_dwordx4 v[48:51], v7, s[44:47], s97 offen offset:0 sc1
    buffer_load_dwordx4 v[52:55], v7, s[44:47], s97 offen offset:1024 sc1
    buffer_load_dwordx4 v[56:59], v7, s[44:47], s97 offen offset:2048 sc1
    buffer_load_dwordx4 v[60:63], v7, s[44:47], s97 offen offset:3072 sc1
    s_waitcnt vmcnt(0)
    v_max3_u32 v11, v48, v52, v56
    v_max_u32 v11, v11, v60
    v_cmp_eq_u32 vcc, -1, v11
    s_cbranch_vccnz L_rxb6
    s_branch L_oxb6
L_xxb6:
    s_mov_b32 s85, 0
    s_branch L_oxb6
    s_nop 7
L_rxb7:
    s_sub_u32 s85, s85, 1
    s_cbranch_scc1 L_xxb7
    s_add_u32 s55, s88, 7
    s_and_b32 s55, s55, 15
    s_lshl_b32 s55, s55, 14
    s_add_u32 s97, s55, s67
    buffer_load_dwordx4 v[64:67], v7, s[44:47], s97 offen offset:0 sc1
    buffer_load_dwordx4 v[68:71], v7, s[44:47], s97 offen offset:1024 sc1
    buffer_load_dwordx4 v[72:75], v7, s[44:47], s97 offen offset:2048 sc1
    buffer_load_dwordx4 v[76:79], v7, s[44:47], s97 offen offset:3072 sc1
    s_waitcnt vmcnt(0)
    v_max3_u32 v11, v64, v68, v72
    v_max_u32 v11, v11, v76
    v_cmp_eq_u32 vcc, -1, v11
    s_cbranch_vccnz L_rxb7
    s_branch L_oxb7
L_xxb7:
    s_mov_b32 s85, 0
    s_branch L_oxb7
    s_nop 7
L_rxb8:
    s_sub_u32 s85, s85, 1
    s_cbranch_scc1 L_xxb8
    s_add_u32 s55, s88, 8
    s_and_b32 s55, s55, 15
    s_lshl_b32 s55, s55, 14
    s_add_u32 s97, s55, s67
    buffer_load_dwordx4 v[16:19], v7, s[44:47], s97 offen offset:0 sc1
    buffer_load_dwordx4 v[20:23], v7, s[44:47], s97 offen offset:1024 sc1
    buffer_load_dwordx4 v[24:27], v7, s[44:47], s97 offen offset:2048 sc1
    buffer_load_dwordx4 v[28:31], v7, s[44:47], s97 offen offset:3072 sc1
    s_waitcnt vmcnt(0)
    v_max3_u32 v11, v16, v20, v24
    v_max_u32 v11, v11, v28
    v_cmp_eq_u32 vcc, -1, v11
    s_cbranch_vccnz L_rxb8
    s_branch L_oxb8
L_xxb8:
    s_mov_b32 s85, 0
    s_branch L_oxb8
    s_nop 7
L_rxb9:
    s_sub_u32 s85, s85, 1
    s_cbranch_scc1 L_xxb9
    s_add_u32 s55, s88, 9
    s_and_b32 s55, s55, 15
    s_lshl_b32 s55, s55, 14
    s_add_u32 s97, s55, s67
    buffer_load_dwordx4 v[32:35], v7, s[44:47], s97 offen offset:0 sc1
    buffer_load_dwordx4 v[36:39], v7, s[44:47], s97 offen offset:1024 sc1
    buffer_load_dwordx4 v[40:43], v7, s[44:47], s97 offen offset:2048 sc1
    buffer_load_dwordx4 v[44:47], v7, s[44:47], s97 offen offset:3072 sc1
    s_waitcnt vmcnt(0)
    v_max3_u32 v11, v32, v36, v40
    v_max_u32 v11, v11, v44
    v_cmp_eq_u32 vcc, -1, v11
    s_cbranch_vccnz L_rxb9
    s_branch L_oxb9
L_xxb9:
    s_mov_b32 s85, 0
    s_branch L_oxb9
    s_nop 7
L_rfb9:
    s_sub_u32 s85, s85, 1
    s_cbranch_scc1 L_xfb9
    ds_read_b32 v12, v3 offset:0
    s_waitcnt lgkmcnt(0)
    v_cmp_ne_u32 vcc, 4, v12
    s_cbranch_vccnz L_rfb9
    s_branch L_ofb9
L_xfb9:
    s_mov_b32 s85, 0
    s_branch L_ofb9
    s_nop 7
L_rxb10:
    s_sub_u32 s85, s85, 1
    s_cbranch_scc1 L_xxb10
    s_add_u32 s55, s88, 10
    s_and_b32 s55, s55, 15
    s_lshl_b32 s55, s55, 14
    s_add_u32 s97, s55, s67
    buffer_load_dwordx4 v[48:51], v7, s[44:47], s97 offen offset:0 sc1
    buffer_load_dwordx4 v[52:55], v7, s[44:47], s97 offen offset:1024 sc1
    buffer_load_dwordx4 v[56:59], v7, s[44:47], s97 offen offset:2048 sc1
    buffer_load_dwordx4 v[60:63], v7, s[44:47], s97 offen offset:3072 sc1
    s_waitcnt vmcnt(0)
    v_max3_u32 v11, v48, v52, v56
    v_max_u32 v11, v11, v60
    v_cmp_eq_u32 vcc, -1, v11
    s_cbranch_vccnz L_rxb10
    s_branch L_oxb10
L_xxb10:
    s_mov_b32 s85, 0
    s_branch L_oxb10
    s_nop 7
L_rxb11:
    s_sub_u32 s85, s85, 1
    s_cbranch_scc1 L_xxb11
    s_add_u32 s55, s88, 11
    s_and_b32 s55, s55, 15
    s_lshl_b32 s55, s55, 14
    s_add_u32 s97, s55, s67
    buffer_load_dwordx4 v[64:67], v7, s[44:47], s97 offen offset:0 sc1
    buffer_load_dwordx4 v[68:71], v7, s[44:47], s97 offen offset:1024 sc1
    buffer_load_dwordx4 v[72:75], v7, s[44:47], s97 offen offset:2048 sc1
    buffer_load_dwordx4 v[76:79], v7, s[44:47], s97 offen offset:3072 sc1
    s_waitcnt vmcnt(0)
    v_max3_u32 v11, v64, v68, v72
    v_max_u32 v11, v11, v76
    v_cmp_eq_u32 vcc, -1, v11
    s_cbranch_vccnz L_rxb11
    s_branch L_oxb11
L_xxb11:
    s_mov_b32 s85, 0
    s_branch L_oxb11
    s_nop 7
L_rxb12:
    s_sub_u32 s85, s85, 1
    s_cbranch_scc1 L_xxb12
    s_add_u32 s55, s88, 12
    s_and_b32 s55, s55, 15
    s_lshl_b32 s55, s55, 14
    s_add_u32 s97, s55, s67
    buffer_load_dwordx4 v[16:19], v7, s[44:47], s97 offen offset:0 sc1
    buffer_load_dwordx4 v[20:23], v7, s[44:47], s97 offen offset:1024 sc1
    buffer_load_dwordx4 v[24:27], v7, s[44:47], s97 offen offset:2048 sc1
    buffer_load_dwordx4 v[28:31], v7, s[44:47], s97 offen offset:3072 sc1
    s_waitcnt vmcnt(0)
    v_max3_u32 v11, v16, v20, v24
    v_max_u32 v11, v11, v28
    v_cmp_eq_u32 vcc, -1, v11
    s_cbranch_vccnz L_rxb12
    s_branch L_oxb12
L_xxb12:
    s_mov_b32 s85, 0
    s_branch L_oxb12
    s_nop 7
L_rxb13:
    s_sub_u32 s85, s85, 1
    s_cbranch_scc1 L_xxb13
    s_add_u32 s55, s88, 13
    s_and_b32 s55, s55, 15
    s_lshl_b32 s55, s55, 14
    s_add_u32 s97, s55, s67
    buffer_load_dwordx4 v[32:35], v7, s[44:47], s97 offen offset:0 sc1
    buffer_load_dwordx4 v[36:39], v7, s[44:47], s97 offen offset:1024 sc1
    buffer_load_dwordx4 v[40:43], v7, s[44:47], s97 offen offset:2048 sc1
    buffer_load_dwordx4 v[44:47], v7, s[44:47], s97 offen offset:3072 sc1
    s_waitcnt vmcnt(0)
    v_max3_u32 v11, v32, v36, v40
    v_max_u32 v11, v11, v44
    v_cmp_eq_u32 vcc, -1, v11
    s_cbranch_vccnz L_rxb13
    s_branch L_oxb13
L_xxb13:
    s_mov_b32 s85, 0
    s_branch L_oxb13
    s_nop 7
L_rxb14:
    s_sub_u32 s85, s85, 1
    s_cbranch_scc1 L_xxb14
    s_add_u32 s55, s88, 14
    s_and_b32 s55, s55, 15
    s_lshl_b32 s55, s55, 14
    s_add_u32 s97, s55, s67
    buffer_load_dwordx4 v[48:51], v7, s[44:47], s97 offen offset:0 sc1
    buffer_load_dwordx4 v[52:55], v7, s[44:47], s97 offen offset:1024 sc1
    buffer_load_dwordx4 v[56:59], v7, s[44:47], s97 offen offset:2048 sc1
    buffer_load_dwordx4 v[60:63], v7, s[44:47], s97 offen offset:3072 sc1
    s_waitcnt vmcnt(0)
    v_max3_u32 v11, v48, v52, v56
    v_max_u32 v11, v11, v60
    v_cmp_eq_u32 vcc, -1, v11
    s_cbranch_vccnz L_rxb14
    s_branch L_oxb14
L_xxb14:
    s_mov_b32 s85, 0
    s_branch L_oxb14
    s_nop 7
L_rxb15:
    s_sub_u32 s85, s85, 1
    s_cbranch_scc1 L_xxb15
    s_add_u32 s55, s88, 15
    s_and_b32 s55, s55, 15
    s_lshl_b32 s55, s55, 14
    s_add_u32 s97, s55, s67
    buffer_load_dwordx4 v[64:67], v7, s[44:47], s97 offen offset:0 sc1
    buffer_load_dwordx4 v[68:71], v7, s[44:47], s97 offen offset:1024 sc1
    buffer_load_dwordx4 v[72:75], v7, s[44:47], s97 offen offset:2048 sc1
    buffer_load_dwordx4 v[76:79], v7, s[44:47], s97 offen offset:3072 sc1
    s_waitcnt vmcnt(0)
    v_max3_u32 v11, v64, v68, v72
    v_max_u32 v11, v11, v76
    v_cmp_eq_u32 vcc, -1, v11
    s_cbranch_vccnz L_rxb15
    s_branch L_oxb15
L_xxb15:
    s_mov_b32 s85, 0
    s_branch L_oxb15
    s_nop 7
L_rfb15:
    s_sub_u32 s85, s85, 1
    s_cbranch_scc1 L_xfb15
    ds_read_b32 v12, v3 offset:4
    s_waitcnt lgkmcnt(0)
    v_cmp_ne_u32 vcc, 4, v12
    s_cbranch_vccnz L_rfb15
    s_branch L_ofb15
L_xfb15:
    s_mov_b32 s85, 0
    s_branch L_ofb15
    s_nop 7
L_rqw:
    s_sub_u32 s85, s85, 1
    s_cbranch_scc1 L_xqw
    s_sleep 1
    ds_read2_b32 v[12:13], v3 offset0:5 offset1:5
    s_waitcnt lgkmcnt(0)
    v_add_u32 v12, v12, v13
    v_cmp_ne_u32 vcc, 8, v12
    s_cbranch_vccnz L_rqw
    s_branch L_oqw
L_xqw:
    s_mov_b32 s85, 0
    s_branch L_oqw
    s_nop 7
L_ruw:
    s_sub_u32 s85, s85, 1
    s_cbranch_scc1 L_xuw
    s_sleep 1
    ds_read_b32 v12, v3 offset:24
    s_waitcnt lgkmcnt(0)
    v_cmp_ne_u32 vcc, 4, v12
    s_cbranch_vccnz L_ruw
    s_branch L_ouw
L_xuw:
    s_mov_b32 s85, 0
    s_branch L_ouw
    s_nop 7
L_rb4b:
    s_sub_u32 s85, s85, 1
    s_cbranch_scc1 L_xb4b
    s_sleep 1
    ds_read_b32 v12, v3 offset:40
    s_waitcnt lgkmcnt(0)
    v_cmp_ne_u32 vcc, 8, v12
    s_cbranch_vccnz L_rb4b
    s_branch L_ob4b
L_xb4b:
    s_mov_b32 s85, 0
    s_branch L_ob4b
    s_nop 7
L_rst:
    s_sub_u32 s85, s85, 1
    s_cbranch_scc1 L_xst
    s_sleep 4
    s_mov_b32 m0, s61
    s_nop 0
    buffer_load_dwordx4 v56, s[44:47], s58 offen offset:0 sc1 lds
    buffer_load_dwordx4 v56, s[44:47], s58 offen offset:1024 sc1 lds
    buffer_load_dwordx4 v56, s[44:47], s58 offen offset:2048 sc1 lds
    buffer_load_dwordx4 v56, s[44:47], s58 offen offset:3072 sc1 lds
    s_add_u32 m0, s61, 0x1000
    s_nop 0
    buffer_load_dwordx4 v56, s[44:47], s59 offen offset:0 sc1 lds
    buffer_load_dwordx4 v56, s[44:47], s59 offen offset:1024 sc1 lds
    buffer_load_dwordx4 v56, s[44:47], s59 offen offset:2048 sc1 lds
    buffer_load_dwordx4 v56, s[44:47], s59 offen offset:3072 sc1 lds
    s_waitcnt vmcnt(0)
    ds_read_b128 v[16:19], v8 offset:0
    ds_read_b128 v[32:35], v58 offset:0
    ds_read_b128 v[20:23], v57 offset:0
    ds_read_b128 v[36:39], v59 offset:0
    ds_read_b128 v[24:27], v8 offset:4096
    ds_read_b128 v[40:43], v58 offset:4096
    ds_read_b128 v[28:31], v57 offset:4096
    ds_read_b128 v[44:47], v59 offset:4096
    s_waitcnt lgkmcnt(0)
    v_bitop3_b32 v32, v32, v16, s84 bitop3:0x96
    v_bitop3_b32 v33, v33, v17, s84 bitop3:0x96
    v_bitop3_b32 v34, v34, v18, s84 bitop3:0x96
    v_bitop3_b32 v35, v35, v19, s84 bitop3:0x96
    v_bitop3_b32 v36, v36, v20, s84 bitop3:0x96
    v_bitop3_b32 v37, v37, v21, s84 bitop3:0x96
    v_bitop3_b32 v38, v38, v22, s84 bitop3:0x96
    v_bitop3_b32 v39, v39, v23, s84 bitop3:0x96
    v_bitop3_b32 v40, v40, v24, s84 bitop3:0x96
    v_bitop3_b32 v41, v41, v25, s84 bitop3:0x96
    v_bitop3_b32 v42, v42, v26, s84 bitop3:0x96
    v_bitop3_b32 v43, v43, v27, s84 bitop3:0x96
    v_bitop3_b32 v44, v44, v28, s84 bitop3:0x96
    v_bitop3_b32 v45, v45, v29, s84 bitop3:0x96
    v_bitop3_b32 v46, v46, v30, s84 bitop3:0x96
    v_bitop3_b32 v47, v47, v31, s84 bitop3:0x96
    v_or3_b32 v32, v32, v33, v34
    v_or3_b32 v35, v35, v36, v37
    v_or3_b32 v38, v38, v39, v40
    v_or3_b32 v41, v41, v42, v43
    v_or3_b32 v44, v44, v45, v46
    v_or3_b32 v32, v32, v35, v38
    v_or3_b32 v41, v41, v44, v47
    v_or_b32 v32, v32, v41
    v_cmp_ne_u32 vcc, 0, v32
    s_cbranch_vccnz L_rst
    s_branch L_ost
L_xst:
    s_mov_b32 s85, 0
    s_branch L_ost
    s_nop 7
L_rfB:
    s_sub_u32 s85, s85, 1
    s_cbranch_scc1 L_xfB
    ds_read_b32 v12, v3
    s_waitcnt lgkmcnt(0)
    v_cmp_ne_u32 vcc, 4, v12
    s_cbranch_vccnz L_rfB
    s_branch L_ofB
L_xfB:
    s_mov_b32 s85, 0
    s_branch L_ofB
    s_nop 7
L_rws1:
    s_sub_u32 s85, s85, 1
    s_cbranch_scc1 L_xws1
    s_sleep 2
    ds_read_b32 v12, v3 offset:36
    s_waitcnt lgkmcnt(0)
    v_cmp_gt_u32 vcc, 1, v12
    s_cbranch_vccnz L_rws1
    s_branch L_ows1
L_xws1:
    s_mov_b32 s85, 0
    s_branch L_ows1
    s_nop 7
L_rws2:
    s_sub_u32 s85, s85, 1
    s_cbranch_scc1 L_xws2
    s_sleep 2
    ds_read_b32 v12, v3 offset:36
    s_waitcnt lgkmcnt(0)
    v_cmp_gt_u32 vcc, 2, v12
    s_cbranch_vccnz L_rws2
    s_branch L_ows2
L_xws2:
    s_mov_b32 s85, 0
    s_branch L_ows2
    s_nop 7
L_rws3:
    s_sub_u32 s85, s85, 1
    s_cbranch_scc1 L_xws3
    s_sleep 2
    ds_read_b32 v12, v3 offset:36
    s_waitcnt lgkmcnt(0)
    v_cmp_gt_u32 vcc, 3, v12
    s_cbranch_vccnz L_rws3
    s_branch L_ows3
L_xws3:
    s_mov_b32 s85, 0
    s_branch L_ows3
    s_nop 7
L_rws4:
    s_sub_u32 s85, s85, 1
    s_cbranch_scc1 L_xws4
    s_sleep 2
    ds_read_b32 v12, v3 offset:36
    s_waitcnt lgkmcnt(0)
    v_cmp_gt_u32 vcc, 4, v12
    s_cbranch_vccnz L_rws4
    s_branch L_ows4
L_xws4:
    s_mov_b32 s85, 0
    s_branch L_ows4
    s_nop 7
L_rws5:
    s_sub_u32 s85, s85, 1
    s_cbranch_scc1 L_xws5
    s_sleep 2
    ds_read_b32 v12, v3 offset:36
    s_waitcnt lgkmcnt(0)
    v_cmp_gt_u32 vcc, 5, v12
    s_cbranch_vccnz L_rws5
    s_branch L_ows5
L_xws5:
    s_mov_b32 s85, 0
    s_branch L_ows5
    s_nop 7
L_rws6:
    s_sub_u32 s85, s85, 1
    s_cbranch_scc1 L_xws6
    s_sleep 2
    ds_read_b32 v12, v3 offset:36
    s_waitcnt lgkmcnt(0)
    v_cmp_gt_u32 vcc, 6, v12
    s_cbranch_vccnz L_rws6
    s_branch L_ows6
L_xws6:
    s_mov_b32 s85, 0
    s_branch L_ows6
    s_nop 7
L_rws7:
    s_sub_u32 s85, s85, 1
    s_cbranch_scc1 L_xws7
    s_sleep 2
    ds_read_b32 v12, v3 offset:36
    s_waitcnt lgkmcnt(0)
    v_cmp_gt_u32 vcc, 7, v12
    s_cbranch_vccnz L_rws7
    s_branch L_ows7
L_xws7:
    s_mov_b32 s85, 0
    s_branch L_ows7
    s_nop 7
L_rws8:
    s_sub_u32 s85, s85, 1
    s_cbranch_scc1 L_xws8
    s_sleep 2
    ds_read_b32 v12, v3 offset:36
    s_waitcnt lgkmcnt(0)
    v_cmp_gt_u32 vcc, 8, v12
    s_cbranch_vccnz L_rws8
    s_branch L_ows8
L_xws8:
    s_mov_b32 s85, 0
    s_branch L_ows8
    s_nop 7
L_rws9:
    s_sub_u32 s85, s85, 1
    s_cbranch_scc1 L_xws9
    s_sleep 2
    ds_read_b32 v12, v3 offset:36
    s_waitcnt lgkmcnt(0)
    v_cmp_gt_u32 vcc, 9, v12
    s_cbranch_vccnz L_rws9
    s_branch L_ows9
L_xws9:
    s_mov_b32 s85, 0
    s_branch L_ows9
    s_nop 7
L_rws10:
    s_sub_u32 s85, s85, 1
    s_cbranch_scc1 L_xws10
    s_sleep 2
    ds_read_b32 v12, v3 offset:36
    s_waitcnt lgkmcnt(0)
    v_cmp_gt_u32 vcc, 10, v12
    s_cbranch_vccnz L_rws10
    s_branch L_ows10
L_xws10:
    s_mov_b32 s85, 0
    s_branch L_ows10
    s_nop 7
L_rws11:
    s_sub_u32 s85, s85, 1
    s_cbranch_scc1 L_xws11
    s_sleep 2
    ds_read_b32 v12, v3 offset:36
    s_waitcnt lgkmcnt(0)
    v_cmp_gt_u32 vcc, 11, v12
    s_cbranch_vccnz L_rws11
    s_branch L_ows11
L_xws11:
    s_mov_b32 s85, 0
    s_branch L_ows11
    s_nop 7
L_rws12:
    s_sub_u32 s85, s85, 1
    s_cbranch_scc1 L_xws12
    s_sleep 2
    ds_read_b32 v12, v3 offset:36
    s_waitcnt lgkmcnt(0)
    v_cmp_gt_u32 vcc, 12, v12
    s_cbranch_vccnz L_rws12
    s_branch L_ows12
L_xws12:
    s_mov_b32 s85, 0
    s_branch L_ows12
    s_nop 7
L_rws13:
    s_sub_u32 s85, s85, 1
    s_cbranch_scc1 L_xws13
    s_sleep 2
    ds_read_b32 v12, v3 offset:36
    s_waitcnt lgkmcnt(0)
    v_cmp_gt_u32 vcc, 13, v12
    s_cbranch_vccnz L_rws13
    s_branch L_ows13
L_xws13:
    s_mov_b32 s85, 0
    s_branch L_ows13
    s_nop 7
L_rfh:
    s_sub_u32 s85, s85, 1
    s_cbranch_scc1 L_xfh
    buffer_load_dword v10, v8, s[44:47], s64 offen sc1
    s_waitcnt vmcnt(0)
    v_cmp_ne_u32 vcc, s84, v10
    s_cbranch_vccnz L_rfh
    s_branch L_ofh
L_xfh:
    s_mov_b32 s85, 0
    s_branch L_ofh
    s_nop 7
L_rh0:
    s_sub_u32 s85, s85, 1
    s_cbranch_scc1 L_xh0
    s_add_u32 m0, s97, 0
    s_add_u32 s96, s68, s20
    buffer_load_dwordx4 v9, s[44:47], s96 offen sc1 lds
    buffer_load_dwordx4 v9, s[44:47], s96 offen offset:1024 sc1 lds
    s_add_u32 m0, s97, 2048
    s_add_u32 s96, s68, s21
    buffer_load_dwordx4 v9, s[44:47], s96 offen sc1 lds
    buffer_load_dwordx4 v9, s[44:47], s96 offen offset:1024 sc1 lds
    s_add_u32 m0, s97, 4096
    s_add_u32 s96, s68, s22
    buffer_load_dwordx4 v9, s[44:47], s96 offen sc1 lds
    buffer_load_dwordx4 v9, s[44:47], s96 offen offset:1024 sc1 lds
    s_add_u32 m0, s97, 6144
    s_add_u32 s96, s68, s23
    buffer_load_dwordx4 v9, s[44:47], s96 offen sc1 lds
    buffer_load_dwordx4 v9, s[44:47], s96 offen offset:1024 sc1 lds
    s_add_u32 m0, s97, 8192
    s_add_u32 s96, s68, s24
    buffer_load_dwordx4 v9, s[44:47], s96 offen sc1 lds
    buffer_load_dwordx4 v9, s[44:47], s96 offen offset:1024 sc1 lds
    s_add_u32 m0, s97, 10240
    s_add_u32 s96, s68, s25
    buffer_load_dwordx4 v9, s[44:47], s96 offen sc1 lds
    buffer_load_dwordx4 v9, s[44:47], s96 offen offset:1024 sc1 lds
    s_waitcnt vmcnt(10)
    ds_read_b64 v[16:17], v14 offset:0
    ds_read_b64 v[18:19], v14 offset:1024
    ds_read_b64 v[20:21], v14 offset:8
    ds_read_b64 v[22:23], v14 offset:1032
    s_waitcnt lgkmcnt(0)
    v_max_u32 v11, v16, v18
    v_cmp_eq_u32 vcc, -1, v11
    s_cbranch_vccnz L_rh0
    s_branch L_oh0
L_xh0:
    s_mov_b32 s85, 0
    s_branch L_oh0
    s_nop 7
L_rh1:
    s_sub_u32 s85, s85, 1
    s_cbranch_scc1 L_xh1
    s_add_u32 m0, s97, 2048
    s_add_u32 s96, s68, s21
    buffer_load_dwordx4 v9, s[44:47], s96 offen sc1 lds
    buffer_load_dwordx4 v9, s[44:47], s96 offen offset:1024 sc1 lds
    s_add_u32 m0, s97, 4096
    s_add_u32 s96, s68, s22
    buffer_load_dwordx4 v9, s[44:47], s96 offen sc1 lds
    buffer_load_dwordx4 v9, s[44:47], s96 offen offset:1024 sc1 lds
    s_add_u32 m0, s97, 6144
    s_add_u32 s96, s68, s23
    buffer_load_dwordx4 v9, s[44:47], s96 offen sc1 lds
    buffer_load_dwordx4 v9, s[44:47], s96 offen offset:1024 sc1 lds
    s_add_u32 m0, s97, 8192
    s_add_u32 s96, s68, s24
    buffer_load_dwordx4 v9, s[44:47], s96 offen sc1 lds
    buffer_load_dwordx4 v9, s[44:47], s96 offen offset:1024 sc1 lds
    s_add_u32 m0, s97, 10240
    s_add_u32 s96, s68, s25
    buffer_load_dwordx4 v9, s[44:47], s96 offen sc1 lds
    buffer_load_dwordx4 v9, s[44:47], s96 offen offset:1024 sc1 lds
    s_add_u32 m0, s97, 0
    s_add_u32 s96, s68, s26
    buffer_load_dwordx4 v9, s[44:47], s96 offen sc1 lds
    buffer_load_dwordx4 v9, s[44:47], s96 offen offset:1024 sc1 lds
    s_waitcnt vmcnt(10)
    ds_read_b64 v[24:25], v14 offset:2048
    ds_read_b64 v[26:27], v14 offset:3072
    ds_read_b64 v[28:29], v14 offset:2056
    ds_read_b64 v[30:31], v14 offset:3080
    s_waitcnt lgkmcnt(0)
    v_max_u32 v11, v24, v26
    v_cmp_eq_u32 vcc, -1, v11
    s_cbranch_vccnz L_rh1
    s_branch L_oh1
L_xh1:
    s_mov_b32 s85, 0
    s_branch L_oh1
    s_nop 7
L_rh2:
    s_sub_u32 s85, s85, 1
    s_cbranch_scc1 L_xh2
    s_add_u32 m0, s97, 4096
    s_add_u32 s96, s68, s22
    buffer_load_dwordx4 v9, s[44:47], s96 offen sc1 lds
    buffer_load_dwordx4 v9, s[44:47], s96 offen offset:1024 sc1 lds
    s_add_u32 m0, s97, 6144
    s_add_u32 s96, s68, s23
    buffer_load_dwordx4 v9, s[44:47], s96 offen sc1 lds
    buffer_load_dwordx4 v9, s[44:47], s96 offen offset:1024 sc1 lds
    s_add_u32 m0, s97, 8192
    s_add_u32 s96, s68, s24
    buffer_load_dwordx4 v9, s[44:47], s96 offen sc1 lds
    buffer_load_dwordx4 v9, s[44:47], s96 offen offset:1024 sc1 lds
    s_add_u32 m0, s97, 10240
    s_add_u32 s96, s68, s25
    buffer_load_dwordx4 v9, s[44:47], s96 offen sc1 lds
    buffer_load_dwordx4 v9, s[44:47], s96 offen offset:1024 sc1 lds
    s_add_u32 m0, s97, 0
    s_add_u32 s96, s68, s26
    buffer_load_dwordx4 v9, s[44:47], s96 offen sc1 lds
    buffer_load_dwordx4 v9, s[44:47], s96 offen offset:1024 sc1 lds
    s_add_u32 m0, s97, 2048
    s_add_u32 s96, s68, s27
    buffer_load_dwordx4 v9, s[44:47], s96 offen sc1 lds
    buffer_load_dwordx4 v9, s[44:47], s96 offen offset:1024 sc1 lds
    s_waitcnt vmcnt(10)
    ds_read_b64 v[32:33], v14 offset:4096
    ds_read_b64 v[34:35], v14 offset:5120
    ds_read_b64 v[36:37], v14 offset:4104
    ds_read_b64 v[38:39], v14 offset:5128
    s_waitcnt lgkmcnt(0)
    v_max_u32 v11, v32, v34
    v_cmp_eq_u32 vcc, -1, v11
    s_cbranch_vccnz L_rh2
    s_branch L_oh2
L_xh2:
    s_mov_b32 s85, 0
    s_branch L_oh2
    s_nop 7
L_rh3:
    s_sub_u32 s85, s85, 1
    s_cbranch_scc1 L_xh3
    s_add_u32 m0, s97, 6144
    s_add_u32 s96, s68, s23
    buffer_load_dwordx4 v9, s[44:47], s96 offen sc1 lds
    buffer_load_dwordx4 v9, s[44:47], s96 offen offset:1024 sc1 lds
    s_add_u32 m0, s97, 8192
    s_add_u32 s96, s68, s24
    buffer_load_dwordx4 v9, s[44:47], s96 offen sc1 lds
    buffer_load_dwordx4 v9, s[44:47], s96 offen offset:1024 sc1 lds
    s_add_u32 m0, s97, 10240
    s_add_u32 s96, s68, s25
    buffer_load_dwordx4 v9, s[44:47], s96 offen sc1 lds
    buffer_load_dwordx4 v9, s[44:47], s96 offen offset:1024 sc1 lds
    s_add_u32 m0, s97, 0
    s_add_u32 s96, s68, s26
    buffer_load_dwordx4 v9, s[44:47], s96 offen sc1 lds
    buffer_load_dwordx4 v9, s[44:47], s96 offen offset:1024 sc1 lds
    s_add_u32 m0, s97, 2048
    s_add_u32 s96, s68, s27
    buffer_load_dwordx4 v9, s[44:47], s96 offen sc1 lds
    buffer_load_dwordx4 v9, s[44:47], s96 offen offset:1024 sc1 lds
    s_add_u32 m0, s97, 4096
    s_add_u32 s96, s68, s28
    buffer_load_dwordx4 v9, s[44:47], s96 offen sc1 lds
    buffer_load_dwordx4 v9, s[44:47], s96 offen offset:1024 sc1 lds
    s_waitcnt vmcnt(10)
    ds_read_b64 v[16:17], v14 offset:6144
    ds_read_b64 v[18:19], v14 offset:7168
    ds_read_b64 v[20:21], v14 offset:6152
    ds_read_b64 v[22:23], v14 offset:7176
    s_waitcnt lgkmcnt(0)
    v_max_u32 v11, v16, v18
    v_cmp_eq_u32 vcc, -1, v11
    s_cbranch_vccnz L_rh3
    s_branch L_oh3
L_xh3:
    s_mov_b32 s85, 0
    s_branch L_oh3
    s_nop 7
L_rh4:
    s_sub_u32 s85, s85, 1
    s_cbranch_scc1 L_xh4
    s_add_u32 m0, s97, 8192
    s_add_u32 s96, s68, s24
    buffer_load_dwordx4 v9, s[44:47], s96 offen sc1 lds
    buffer_load_dwordx4 v9, s[44:47], s96 offen offset:1024 sc1 lds
    s_add_u32 m0, s97, 10240
    s_add_u32 s96, s68, s25
    buffer_load_dwordx4 v9, s[44:47], s96 offen sc1 lds
    buffer_load_dwordx4 v9, s[44:47], s96 offen offset:1024 sc1 lds
    s_add_u32 m0, s97, 0
    s_add_u32 s96, s68, s26
    buffer_load_dwordx4 v9, s[44:47], s96 offen sc1 lds
    buffer_load_dwordx4 v9, s[44:47], s96 offen offset:1024 sc1 lds
    s_add_u32 m0, s97, 2048
    s_add_u32 s96, s68, s27
    buffer_load_dwordx4 v9, s[44:47], s96 offen sc1 lds
    buffer_load_dwordx4 v9, s[44:47], s96 offen offset:1024 sc1 lds
    s_add_u32 m0, s97, 4096
    s_add_u32 s96, s68, s28
    buffer_load_dwordx4 v9, s[44:47], s96 offen sc1 lds
    buffer_load_dwordx4 v9, s[44:47], s96 offen offset:1024 sc1 lds
    s_add_u32 m0, s97, 6144
    s_add_u32 s96, s68, s29
    buffer_load_dwordx4 v9, s[44:47], s96 offen sc1 lds
    buffer_load_dwordx4 v9, s[44:47], s96 offen offset:1024 sc1 lds
    s_waitcnt vmcnt(10)
    ds_read_b64 v[24:25], v14 offset:8192
    ds_read_b64 v[26:27], v14 offset:9216
    ds_read_b64 v[28:29], v14 offset:8200
    ds_read_b64 v[30:31], v14 offset:9224
    s_waitcnt lgkmcnt(0)
    v_max_u32 v11, v24, v26
    v_cmp_eq_u32 vcc, -1, v11
    s_cbranch_vccnz L_rh4
    s_branch L_oh4
L_xh4:
    s_mov_b32 s85, 0
    s_branch L_oh4
    s_nop 7
L_rh5:
    s_sub_u32 s85, s85, 1
    s_cbranch_scc1 L_xh5
    s_add_u32 m0, s97, 10240
    s_add_u32 s96, s68, s25
    buffer_load_dwordx4 v9, s[44:47], s96 offen sc1 lds
    buffer_load_dwordx4 v9, s[44:47], s96 offen offset:1024 sc1 lds
    s_add_u32 m0, s97, 0
    s_add_u32 s96, s68, s26
    buffer_load_dwordx4 v9, s[44:47], s96 offen sc1 lds
    buffer_load_dwordx4 v9, s[44:47], s96 offen offset:1024 sc1 lds
    s_add_u32 m0, s97, 2048
    s_add_u32 s96, s68, s27
    buffer_load_dwordx4 v9, s[44:47], s96 offen sc1 lds
    buffer_load_dwordx4 v9, s[44:47], s96 offen offset:1024 sc1 lds
    s_add_u32 m0, s97, 4096
    s_add_u32 s96, s68, s28
    buffer_load_dwordx4 v9, s[44:47], s96 offen sc1 lds
    buffer_load_dwordx4 v9, s[44:47], s96 offen offset:1024 sc1 lds
    s_add_u32 m0, s97, 6144
    s_add_u32 s96, s68, s29
    buffer_load_dwordx4 v9, s[44:47], s96 offen sc1 lds
    buffer_load_dwordx4 v9, s[44:47], s96 offen offset:1024 sc1 lds
    s_add_u32 m0, s97, 8192
    s_add_u32 s96, s68, s30
    buffer_load_dwordx4 v9, s[44:47], s96 offen sc1 lds
    buffer_load_dwordx4 v9, s[44:47], s96 offen offset:1024 sc1 lds
    s_waitcnt vmcnt(10)
    ds_read_b64 v[32:33], v14 offset:10240
    ds_read_b64 v[34:35], v14 offset:11264
    ds_read_b64 v[36:37], v14 offset:10248
    ds_read_b64 v[38:39], v14 offset:11272
    s_waitcnt lgkmcnt(0)
    v_max_u32 v11, v32, v34
    v_cmp_eq_u32 vcc, -1, v11
    s_cbranch_vccnz L_rh5
    s_branch L_oh5
L_xh5:
    s_mov_b32 s85, 0
    s_branch L_oh5
    s_nop 7
L_rh6:
    s_sub_u32 s85, s85, 1
    s_cbranch_scc1 L_xh6
    s_add_u32 m0, s97, 0
    s_add_u32 s96, s68, s26
    buffer_load_dwordx4 v9, s[44:47], s96 offen sc1 lds
    buffer_load_dwordx4 v9, s[44:47], s96 offen offset:1024 sc1 lds
    s_add_u32 m0, s97, 2048
    s_add_u32 s96, s68, s27
    buffer_load_dwordx4 v9, s[44:47], s96 offen sc1 lds
    buffer_load_dwordx4 v9, s[44:47], s96 offen offset:1024 sc1 lds
    s_add_u32 m0, s97, 4096
    s_add_u32 s96, s68, s28
    buffer_load_dwordx4 v9, s[44:47], s96 offen sc1 lds
    buffer_load_dwordx4 v9, s[44:47], s96 offen offset:1024 sc1 lds
    s_add_u32 m0, s97, 6144
    s_add_u32 s96, s68, s29
    buffer_load_dwordx4 v9, s[44:47], s96 offen sc1 lds
    buffer_load_dwordx4 v9, s[44:47], s96 offen offset:1024 sc1 lds
    s_add_u32 m0, s97, 8192
    s_add_u32 s96, s68, s30
    buffer_load_dwordx4 v9, s[44:47], s96 offen sc1 lds
    buffer_load_dwordx4 v9, s[44:47], s96 offen offset:1024 sc1 lds
    s_add_u32 m0, s97, 10240
    s_add_u32 s96, s69, s20
    buffer_load_dwordx4 v9, s[44:47], s96 offen sc1 lds
    buffer_load_dwordx4 v9, s[44:47], s96 offen offset:1024 sc1 lds
    s_waitcnt vmcnt(10)
    ds_read_b64 v[16:17], v14 offset:0
    ds_read_b64 v[18:19], v14 offset:1024
    ds_read_b64 v[20:21], v14 offset:8
    ds_read_b64 v[22:23], v14 offset:1032
    s_waitcnt lgkmcnt(0)
    v_max_u32 v11, v16, v18
    v_cmp_eq_u32 vcc, -1, v11
    s_cbranch_vccnz L_rh6
    s_branch L_oh6
L_xh6:
    s_mov_b32 s85, 0
    s_branch L_oh6
    s_nop 7
L_rh7:
    s_sub_u32 s85, s85, 1
    s_cbranch_scc1 L_xh7
    s_add_u32 m0, s97, 2048
    s_add_u32 s96, s68, s27
    buffer_load_dwordx4 v9, s[44:47], s96 offen sc1 lds
    buffer_load_dwordx4 v9, s[44:47], s96 offen offset:1024 sc1 lds
    s_add_u32 m0, s97, 4096
    s_add_u32 s96, s68, s28
    buffer_load_dwordx4 v9, s[44:47], s96 offen sc1 lds
    buffer_load_dwordx4 v9, s[44:47], s96 offen offset:1024 sc1 lds
    s_add_u32 m0, s97, 6144
    s_add_u32 s96, s68, s29
    buffer_load_dwordx4 v9, s[44:47], s96 offen sc1 lds
    buffer_load_dwordx4 v9, s[44:47], s96 offen offset:1024 sc1 lds
    s_add_u32 m0, s97, 8192
    s_add_u32 s96, s68, s30
    buffer_load_dwordx4 v9, s[44:47], s96 offen sc1 lds
    buffer_load_dwordx4 v9, s[44:47], s96 offen offset:1024 sc1 lds
    s_add_u32 m0, s97, 10240
    s_add_u32 s96, s69, s20
    buffer_load_dwordx4 v9, s[44:47], s96 offen sc1 lds
    buffer_load_dwordx4 v9, s[44:47], s96 offen offset:1024 sc1 lds
    s_add_u32 m0, s97, 0
    s_add_u32 s96, s69, s21
    buffer_load_dwordx4 v9, s[44:47], s96 offen sc1 lds
    buffer_load_dwordx4 v9, s[44:47], s96 offen offset:1024 sc1 lds
    s_waitcnt vmcnt(10)
    ds_read_b64 v[24:25], v14 offset:2048
    ds_read_b64 v[26:27], v14 offset:3072
    ds_read_b64 v[28:29], v14 offset:2056
    ds_read_b64 v[30:31], v14 offset:3080
    s_waitcnt lgkmcnt(0)
    v_max_u32 v11, v24, v26
    v_cmp_eq_u32 vcc, -1, v11
    s_cbranch_vccnz L_rh7
    s_branch L_oh7
L_xh7:
    s_mov_b32 s85, 0
    s_branch L_oh7
    s_nop 7
L_rh8:
    s_sub_u32 s85, s85, 1
    s_cbranch_scc1 L_xh8
    s_add_u32 m0, s97, 4096
    s_add_u32 s96, s68, s28
    buffer_load_dwordx4 v9, s[44:47], s96 offen sc1 lds
    buffer_load_dwordx4 v9, s[44:47], s96 offen offset:1024 sc1 lds
    s_add_u32 m0, s97, 6144
    s_add_u32 s96, s68, s29
    buffer_load_dwordx4 v9, s[44:47], s96 offen sc1 lds
    buffer_load_dwordx4 v9, s[44:47], s96 offen offset:1024 sc1 lds
    s_add_u32 m0, s97, 8192
    s_add_u32 s96, s68, s30
    buffer_load_dwordx4 v9, s[44:47], s96 offen sc1 lds
    buffer_load_dwordx4 v9, s[44:47], s96 offen offset:1024 sc1 lds
    s_add_u32 m0, s97, 10240
    s_add_u32 s96, s69, s20
    buffer_load_dwordx4 v9, s[44:47], s96 offen sc1 lds
    buffer_load_dwordx4 v9, s[44:47], s96 offen offset:1024 sc1 lds
    s_add_u32 m0, s97, 0
    s_add_u32 s96, s69, s21
    buffer_load_dwordx4 v9, s[44:47], s96 offen sc1 lds
    buffer_load_dwordx4 v9, s[44:47], s96 offen offset:1024 sc1 lds
    s_add_u32 m0, s97, 2048
    s_add_u32 s96, s69, s22
    buffer_load_dwordx4 v9, s[44:47], s96 offen sc1 lds
    buffer_load_dwordx4 v9, s[44:47], s96 offen offset:1024 sc1 lds
    s_waitcnt vmcnt(10)
    ds_read_b64 v[32:33], v14 offset:4096
    ds_read_b64 v[34:35], v14 offset:5120
    ds_read_b64 v[36:37], v14 offset:4104
    ds_read_b64 v[38:39], v14 offset:5128
    s_waitcnt lgkmcnt(0)
    v_max_u32 v11, v32, v34
    v_cmp_eq_u32 vcc, -1, v11
    s_cbranch_vccnz L_rh8
    s_branch L_oh8
L_xh8:
    s_mov_b32 s85, 0
    s_branch L_oh8
    s_nop 7
L_rh9:
    s_sub_u32 s85, s85, 1
    s_cbranch_scc1 L_xh9
    s_add_u32 m0, s97, 6144
    s_add_u32 s96, s68, s29
    buffer_load_dwordx4 v9, s[44:47], s96 offen sc1 lds
    buffer_load_dwordx4 v9, s[44:47], s96 offen offset:1024 sc1 lds
    s_add_u32 m0, s97, 8192
    s_add_u32 s96, s68, s30
    buffer_load_dwordx4 v9, s[44:47], s96 offen sc1 lds
    buffer_load_dwordx4 v9, s[44:47], s96 offen offset:1024 sc1 lds
    s_add_u32 m0, s97, 10240
    s_add_u32 s96, s69, s20
    buffer_load_dwordx4 v9, s[44:47], s96 offen sc1 lds
    buffer_load_dwordx4 v9, s[44:47], s96 offen offset:1024 sc1 lds
    s_add_u32 m0, s97, 0
    s_add_u32 s96, s69, s21
    buffer_load_dwordx4 v9, s[44:47], s96 offen sc1 lds
    buffer_load_dwordx4 v9, s[44:47], s96 offen offset:1024 sc1 lds
    s_add_u32 m0, s97, 2048
    s_add_u32 s96, s69, s22
    buffer_load_dwordx4 v9, s[44:47], s96 offen sc1 lds
    buffer_load_dwordx4 v9, s[44:47], s96 offen offset:1024 sc1 lds
    s_add_u32 m0, s97, 4096
    s_add_u32 s96, s69, s23
    buffer_load_dwordx4 v9, s[44:47], s96 offen sc1 lds
    buffer_load_dwordx4 v9, s[44:47], s96 offen offset:1024 sc1 lds
    s_waitcnt vmcnt(10)
    ds_read_b64 v[16:17], v14 offset:6144
    ds_read_b64 v[18:19], v14 offset:7168
    ds_read_b64 v[20:21], v14 offset:6152
    ds_read_b64 v[22:23], v14 offset:7176
    s_waitcnt lgkmcnt(0)
    v_max_u32 v11, v16, v18
    v_cmp_eq_u32 vcc, -1, v11
    s_cbranch_vccnz L_rh9
    s_branch L_oh9
L_xh9:
    s_mov_b32 s85, 0
    s_branch L_oh9
    s_nop 7
L_rh10:
    s_sub_u32 s85, s85, 1
    s_cbranch_scc1 L_xh10
    s_add_u32 m0, s97, 8192
    s_add_u32 s96, s68, s30
    buffer_load_dwordx4 v9, s[44:47], s96 offen sc1 lds
    buffer_load_dwordx4 v9, s[44:47], s96 offen offset:1024 sc1 lds
    s_add_u32 m0, s97, 10240
    s_add_u32 s96, s69, s20
    buffer_load_dwordx4 v9, s[44:47], s96 offen sc1 lds
    buffer_load_dwordx4 v9, s[44:47], s96 offen offset:1024 sc1 lds
    s_add_u32 m0, s97, 0
    s_add_u32 s96, s69, s21
    buffer_load_dwordx4 v9, s[44:47], s96 offen sc1 lds
    buffer_load_dwordx4 v9, s[44:47], s96 offen offset:1024 sc1 lds
    s_add_u32 m0, s97, 2048
    s_add_u32 s96, s69, s22
    buffer_load_dwordx4 v9, s[44:47], s96 offen sc1 lds
    buffer_load_dwordx4 v9, s[44:47], s96 offen offset:1024 sc1 lds
    s_add_u32 m0, s97, 4096
    s_add_u32 s96, s69, s23
    buffer_load_dwordx4 v9, s[44:47], s96 offen sc1 lds
    buffer_load_dwordx4 v9, s[44:47], s96 offen offset:1024 sc1 lds
    s_add_u32 m0, s97, 6144
    s_add_u32 s96, s69, s24
    buffer_load_dwordx4 v9, s[44:47], s96 offen sc1 lds
    buffer_load_dwordx4 v9, s[44:47], s96 offen offset:1024 sc1 lds
    s_waitcnt vmcnt(10)
    ds_read_b64 v[24:25], v14 offset:8192
    ds_read_b64 v[26:27], v14 offset:9216
    ds_read_b64 v[28:29], v14 offset:8200
    ds_read_b64 v[30:31], v14 offset:9224
    s_waitcnt lgkmcnt(0)
    v_max_u32 v11, v24, v26
    v_cmp_eq_u32 vcc, -1, v11
    s_cbranch_vccnz L_rh10
    s_branch L_oh10
L_xh10:
    s_mov_b32 s85, 0
    s_branch L_oh10
    s_nop 7
L_rh11:
    s_sub_u32 s85, s85, 1
    s_cbranch_scc1 L_xh11
    s_add_u32 m0, s97, 10240
    s_add_u32 s96, s69, s20
    buffer_load_dwordx4 v9, s[44:47], s96 offen sc1 lds
    buffer_load_dwordx4 v9, s[44:47], s96 offen offset:1024 sc1 lds
    s_add_u32 m0, s97, 0
    s_add_u32 s96, s69, s21
    buffer_load_dwordx4 v9, s[44:47], s96 offen sc1 lds
    buffer_load_dwordx4 v9, s[44:47], s96 offen offset:1024 sc1 lds
    s_add_u32 m0, s97, 2048
    s_add_u32 s96, s69, s22
    buffer_load_dwordx4 v9, s[44:47], s96 offen sc1 lds
    buffer_load_dwordx4 v9, s[44:47], s96 offen offset:1024 sc1 lds
    s_add_u32 m0, s97, 4096
    s_add_u32 s96, s69, s23
    buffer_load_dwordx4 v9, s[44:47], s96 offen sc1 lds
    buffer_load_dwordx4 v9, s[44:47], s96 offen offset:1024 sc1 lds
    s_add_u32 m0, s97, 6144
    s_add_u32 s96, s69, s24
    buffer_load_dwordx4 v9, s[44:47], s96 offen sc1 lds
    buffer_load_dwordx4 v9, s[44:47], s96 offen offset:1024 sc1 lds
    s_add_u32 m0, s97, 8192
    s_add_u32 s96, s69, s25
    buffer_load_dwordx4 v9, s[44:47], s96 offen sc1 lds
    buffer_load_dwordx4 v9, s[44:47], s96 offen offset:1024 sc1 lds
    s_waitcnt vmcnt(10)
    ds_read_b64 v[32:33], v14 offset:10240
    ds_read_b64 v[34:35], v14 offset:11264
    ds_read_b64 v[36:37], v14 offset:10248
    ds_read_b64 v[38:39], v14 offset:11272
    s_waitcnt lgkmcnt(0)
    v_max_u32 v11, v32, v34
    v_cmp_eq_u32 vcc, -1, v11
    s_cbranch_vccnz L_rh11
    s_branch L_oh11
L_xh11:
    s_mov_b32 s85, 0
    s_branch L_oh11
    s_nop 7
L_rh12:
    s_sub_u32 s85, s85, 1
    s_cbranch_scc1 L_xh12
    s_add_u32 m0, s97, 0
    s_add_u32 s96, s69, s21
    buffer_load_dwordx4 v9, s[44:47], s96 offen sc1 lds
    buffer_load_dwordx4 v9, s[44:47], s96 offen offset:1024 sc1 lds
    s_add_u32 m0, s97, 2048
    s_add_u32 s96, s69, s22
    buffer_load_dwordx4 v9, s[44:47], s96 offen sc1 lds
    buffer_load_dwordx4 v9, s[44:47], s96 offen offset:1024 sc1 lds
    s_add_u32 m0, s97, 4096
    s_add_u32 s96, s69, s23
    buffer_load_dwordx4 v9, s[44:47], s96 offen sc1 lds
    buffer_load_dwordx4 v9, s[44:47], s96 offen offset:1024 sc1 lds
    s_add_u32 m0, s97, 6144
    s_add_u32 s96, s69, s24
    buffer_load_dwordx4 v9, s[44:47], s96 offen sc1 lds
    buffer_load_dwordx4 v9, s[44:47], s96 offen offset:1024 sc1 lds
    s_add_u32 m0, s97, 8192
    s_add_u32 s96, s69, s25
    buffer_load_dwordx4 v9, s[44:47], s96 offen sc1 lds
    buffer_load_dwordx4 v9, s[44:47], s96 offen offset:1024 sc1 lds
    s_add_u32 m0, s97, 10240
    s_add_u32 s96, s69, s26
    buffer_load_dwordx4 v9, s[44:47], s96 offen sc1 lds
    buffer_load_dwordx4 v9, s[44:47], s96 offen offset:1024 sc1 lds
    s_waitcnt vmcnt(10)
    ds_read_b64 v[16:17], v14 offset:0
    ds_read_b64 v[18:19], v14 offset:1024
    ds_read_b64 v[20:21], v14 offset:8
    ds_read_b64 v[22:23], v14 offset:1032
    s_waitcnt lgkmcnt(0)
    v_max_u32 v11, v16, v18
    v_cmp_eq_u32 vcc, -1, v11
    s_cbranch_vccnz L_rh12
    s_branch L_oh12
L_xh12:
    s_mov_b32 s85, 0
    s_branch L_oh12
    s_nop 7
L_rh13:
    s_sub_u32 s85, s85, 1
    s_cbranch_scc1 L_xh13
    s_add_u32 m0, s97, 2048
    s_add_u32 s96, s69, s22
    buffer_load_dwordx4 v9, s[44:47], s96 offen sc1 lds
    buffer_load_dwordx4 v9, s[44:47], s96 offen offset:1024 sc1 lds
    s_add_u32 m0, s97, 4096
    s_add_u32 s96, s69, s23
    buffer_load_dwordx4 v9, s[44:47], s96 offen sc1 lds
    buffer_load_dwordx4 v9, s[44:47], s96 offen offset:1024 sc1 lds
    s_add_u32 m0, s97, 6144
    s_add_u32 s96, s69, s24
    buffer_load_dwordx4 v9, s[44:47], s96 offen sc1 lds
    buffer_load_dwordx4 v9, s[44:47], s96 offen offset:1024 sc1 lds
    s_add_u32 m0, s97, 8192
    s_add_u32 s96, s69, s25
    buffer_load_dwordx4 v9, s[44:47], s96 offen sc1 lds
    buffer_load_dwordx4 v9, s[44:47], s96 offen offset:1024 sc1 lds
    s_add_u32 m0, s97, 10240
    s_add_u32 s96, s69, s26
    buffer_load_dwordx4 v9, s[44:47], s96 offen sc1 lds
    buffer_load_dwordx4 v9, s[44:47], s96 offen offset:1024 sc1 lds
    s_add_u32 m0, s97, 0
    s_add_u32 s96, s69, s27
    buffer_load_dwordx4 v9, s[44:47], s96 offen sc1 lds
    buffer_load_dwordx4 v9, s[44:47], s96 offen offset:1024 sc1 lds
    s_waitcnt vmcnt(10)
    ds_read_b64 v[24:25], v14 offset:2048
    ds_read_b64 v[26:27], v14 offset:3072
    ds_read_b64 v[28:29], v14 offset:2056
    ds_read_b64 v[30:31], v14 offset:3080
    s_waitcnt lgkmcnt(0)
    v_max_u32 v11, v24, v26
    v_cmp_eq_u32 vcc, -1, v11
    s_cbranch_vccnz L_rh13
    s_branch L_oh13
L_xh13:
    s_mov_b32 s85, 0
    s_branch L_oh13
    s_nop 7
L_rh14:
    s_sub_u32 s85, s85, 1
    s_cbranch_scc1 L_xh14
    s_add_u32 m0, s97, 4096
    s_add_u32 s96, s69, s23
    buffer_load_dwordx4 v9, s[44:47], s96 offen sc1 lds
    buffer_load_dwordx4 v9, s[44:47], s96 offen offset:1024 sc1 lds
    s_add_u32 m0, s97, 6144
    s_add_u32 s96, s69, s24
    buffer_load_dwordx4 v9, s[44:47], s96 offen sc1 lds
    buffer_load_dwordx4 v9, s[44:47], s96 offen offset:1024 sc1 lds
    s_add_u32 m0, s97, 8192
    s_add_u32 s96, s69, s25
    buffer_load_dwordx4 v9, s[44:47], s96 offen sc1 lds
    buffer_load_dwordx4 v9, s[44:47], s96 offen offset:1024 sc1 lds
    s_add_u32 m0, s97, 10240
    s_add_u32 s96, s69, s26
    buffer_load_dwordx4 v9, s[44:47], s96 offen sc1 lds
    buffer_load_dwordx4 v9, s[44:47], s96 offen offset:1024 sc1 lds
    s_add_u32 m0, s97, 0
    s_add_u32 s96, s69, s27
    buffer_load_dwordx4 v9, s[44:47], s96 offen sc1 lds
    buffer_load_dwordx4 v9, s[44:47], s96 offen offset:1024 sc1 lds
    s_add_u32 m0, s97, 2048
    s_add_u32 s96, s69, s28
    buffer_load_dwordx4 v9, s[44:47], s96 offen sc1 lds
    buffer_load_dwordx4 v9, s[44:47], s96 offen offset:1024 sc1 lds
    s_waitcnt vmcnt(10)
    ds_read_b64 v[32:33], v14 offset:4096
    ds_read_b64 v[34:35], v14 offset:5120
    ds_read_b64 v[36:37], v14 offset:4104
    ds_read_b64 v[38:39], v14 offset:5128
    s_waitcnt lgkmcnt(0)
    v_max_u32 v11, v32, v34
    v_cmp_eq_u32 vcc, -1, v11
    s_cbranch_vccnz L_rh14
    s_branch L_oh14
L_xh14:
    s_mov_b32 s85, 0
    s_branch L_oh14
    s_nop 7
L_rh15:
    s_sub_u32 s85, s85, 1
    s_cbranch_scc1 L_xh15
    s_add_u32 m0, s97, 6144
    s_add_u32 s96, s69, s24
    buffer_load_dwordx4 v9, s[44:47], s96 offen sc1 lds
    buffer_load_dwordx4 v9, s[44:47], s96 offen offset:1024 sc1 lds
    s_add_u32 m0, s97, 8192
    s_add_u32 s96, s69, s25
    buffer_load_dwordx4 v9, s[44:47], s96 offen sc1 lds
    buffer_load_dwordx4 v9, s[44:47], s96 offen offset:1024 sc1 lds
    s_add_u32 m0, s97, 10240
    s_add_u32 s96, s69, s26
    buffer_load_dwordx4 v9, s[44:47], s96 offen sc1 lds
    buffer_load_dwordx4 v9, s[44:47], s96 offen offset:1024 sc1 lds
    s_add_u32 m0, s97, 0
    s_add_u32 s96, s69, s27
    buffer_load_dwordx4 v9, s[44:47], s96 offen sc1 lds
    buffer_load_dwordx4 v9, s[44:47], s96 offen offset:1024 sc1 lds
    s_add_u32 m0, s97, 2048
    s_add_u32 s96, s69, s28
    buffer_load_dwordx4 v9, s[44:47], s96 offen sc1 lds
    buffer_load_dwordx4 v9, s[44:47], s96 offen offset:1024 sc1 lds
    s_add_u32 m0, s97, 4096
    s_add_u32 s96, s69, s29
    buffer_load_dwordx4 v9, s[44:47], s96 offen sc1 lds
    buffer_load_dwordx4 v9, s[44:47], s96 offen offset:1024 sc1 lds
    s_waitcnt vmcnt(10)
    ds_read_b64 v[16:17], v14 offset:6144
    ds_read_b64 v[18:19], v14 offset:7168
    ds_read_b64 v[20:21], v14 offset:6152
    ds_read_b64 v[22:23], v14 offset:7176
    s_waitcnt lgkmcnt(0)
    v_max_u32 v11, v16, v18
    v_cmp_eq_u32 vcc, -1, v11
    s_cbranch_vccnz L_rh15
    s_branch L_oh15
L_xh15:
    s_mov_b32 s85, 0
    s_branch L_oh15
    s_nop 7
L_rh16:
    s_sub_u32 s85, s85, 1
    s_cbranch_scc1 L_xh16
    s_add_u32 m0, s97, 8192
    s_add_u32 s96, s69, s25
    buffer_load_dwordx4 v9, s[44:47], s96 offen sc1 lds
    buffer_load_dwordx4 v9, s[44:47], s96 offen offset:1024 sc1 lds
    s_add_u32 m0, s97, 10240
    s_add_u32 s96, s69, s26
    buffer_load_dwordx4 v9, s[44:47], s96 offen sc1 lds
    buffer_load_dwordx4 v9, s[44:47], s96 offen offset:1024 sc1 lds
    s_add_u32 m0, s97, 0
    s_add_u32 s96, s69, s27
    buffer_load_dwordx4 v9, s[44:47], s96 offen sc1 lds
    buffer_load_dwordx4 v9, s[44:47], s96 offen offset:1024 sc1 lds
    s_add_u32 m0, s97, 2048
    s_add_u32 s96, s69, s28
    buffer_load_dwordx4 v9, s[44:47], s96 offen sc1 lds
    buffer_load_dwordx4 v9, s[44:47], s96 offen offset:1024 sc1 lds
    s_add_u32 m0, s97, 4096
    s_add_u32 s96, s69, s29
    buffer_load_dwordx4 v9, s[44:47], s96 offen sc1 lds
    buffer_load_dwordx4 v9, s[44:47], s96 offen offset:1024 sc1 lds
    s_add_u32 m0, s97, 6144
    s_add_u32 s96, s69, s30
    buffer_load_dwordx4 v9, s[44:47], s96 offen sc1 lds
    buffer_load_dwordx4 v9, s[44:47], s96 offen offset:1024 sc1 lds
    s_waitcnt vmcnt(10)
    ds_read_b64 v[24:25], v14 offset:8192
    ds_read_b64 v[26:27], v14 offset:9216
    ds_read_b64 v[28:29], v14 offset:8200
    ds_read_b64 v[30:31], v14 offset:9224
    s_waitcnt lgkmcnt(0)
    v_max_u32 v11, v24, v26
    v_cmp_eq_u32 vcc, -1, v11
    s_cbranch_vccnz L_rh16
    s_branch L_oh16
L_xh16:
    s_mov_b32 s85, 0
    s_branch L_oh16
    s_nop 7
L_rh17:
    s_sub_u32 s85, s85, 1
    s_cbranch_scc1 L_xh17
    s_add_u32 m0, s97, 10240
    s_add_u32 s96, s69, s26
    buffer_load_dwordx4 v9, s[44:47], s96 offen sc1 lds
    buffer_load_dwordx4 v9, s[44:47], s96 offen offset:1024 sc1 lds
    s_add_u32 m0, s97, 0
    s_add_u32 s96, s69, s27
    buffer_load_dwordx4 v9, s[44:47], s96 offen sc1 lds
    buffer_load_dwordx4 v9, s[44:47], s96 offen offset:1024 sc1 lds
    s_add_u32 m0, s97, 2048
    s_add_u32 s96, s69, s28
    buffer_load_dwordx4 v9, s[44:47], s96 offen sc1 lds
    buffer_load_dwordx4 v9, s[44:47], s96 offen offset:1024 sc1 lds
    s_add_u32 m0, s97, 4096
    s_add_u32 s96, s69, s29
    buffer_load_dwordx4 v9, s[44:47], s96 offen sc1 lds
    buffer_load_dwordx4 v9, s[44:47], s96 offen offset:1024 sc1 lds
    s_add_u32 m0, s97, 6144
    s_add_u32 s96, s69, s30
    buffer_load_dwordx4 v9, s[44:47], s96 offen sc1 lds
    buffer_load_dwordx4 v9, s[44:47], s96 offen offset:1024 sc1 lds
    s_waitcnt vmcnt(0)
    ds_read_b64 v[32:33], v14 offset:10240
    ds_read_b64 v[34:35], v14 offset:11264
    ds_read_b64 v[36:37], v14 offset:10248
    ds_read_b64 v[38:39], v14 offset:11272
    s_waitcnt lgkmcnt(0)
    v_max_u32 v11, v32, v34
    v_cmp_eq_u32 vcc, -1, v11
    s_cbranch_vccnz L_rh17
    s_branch L_oh17
L_xh17:
    s_mov_b32 s85, 0
    s_branch L_oh17
    s_nop 7
L_rh18:
    s_sub_u32 s85, s85, 1
    s_cbranch_scc1 L_xh18
    s_add_u32 m0, s97, 0
    s_add_u32 s96, s69, s27
    buffer_load_dwordx4 v9, s[44:47], s96 offen sc1 lds
    buffer_load_dwordx4 v9, s[44:47], s96 offen offset:1024 sc1 lds
    s_add_u32 m0, s97, 2048
    s_add_u32 s96, s69, s28
    buffer_load_dwordx4 v9, s[44:47], s96 offen sc1 lds
    buffer_load_dwordx4 v9, s[44:47], s96 offen offset:1024 sc1 lds
    s_add_u32 m0, s97, 4096
    s_add_u32 s96, s69, s29
    buffer_load_dwordx4 v9, s[44:47], s96 offen sc1 lds
    buffer_load_dwordx4 v9, s[44:47], s96 offen offset:1024 sc1 lds
    s_add_u32 m0, s97, 6144
    s_add_u32 s96, s69, s30
    buffer_load_dwordx4 v9, s[44:47], s96 offen sc1 lds
    buffer_load_dwordx4 v9, s[44:47], s96 offen offset:1024 sc1 lds
    s_waitcnt vmcnt(0)
    ds_read_b64 v[16:17], v14 offset:0
    ds_read_b64 v[18:19], v14 offset:1024
    ds_read_b64 v[20:21], v14 offset:8
    ds_read_b64 v[22:23], v14 offset:1032
    s_waitcnt lgkmcnt(0)
    v_max_u32 v11, v16, v18
    v_cmp_eq_u32 vcc, -1, v11
    s_cbranch_vccnz L_rh18
    s_branch L_oh18
L_xh18:
    s_mov_b32 s85, 0
    s_branch L_oh18
    s_nop 7
L_rh19:
    s_sub_u32 s85, s85, 1
    s_cbranch_scc1 L_xh19
    s_add_u32 m0, s97, 2048
    s_add_u32 s96, s69, s28
    buffer_load_dwordx4 v9, s[44:47], s96 offen sc1 lds
    buffer_load_dwordx4 v9, s[44:47], s96 offen offset:1024 sc1 lds
    s_add_u32 m0, s97, 4096
    s_add_u32 s96, s69, s29
    buffer_load_dwordx4 v9, s[44:47], s96 offen sc1 lds
    buffer_load_dwordx4 v9, s[44:47], s96 offen offset:1024 sc1 lds
    s_add_u32 m0, s97, 6144
    s_add_u32 s96, s69, s30
    buffer_load_dwordx4 v9, s[44:47], s96 offen sc1 lds
    buffer_load_dwordx4 v9, s[44:47], s96 offen offset:1024 sc1 lds
    s_waitcnt vmcnt(0)
    ds_read_b64 v[24:25], v14 offset:2048
    ds_read_b64 v[26:27], v14 offset:3072
    ds_read_b64 v[28:29], v14 offset:2056
    ds_read_b64 v[30:31], v14 offset:3080
    s_waitcnt lgkmcnt(0)
    v_max_u32 v11, v24, v26
    v_cmp_eq_u32 vcc, -1, v11
    s_cbranch_vccnz L_rh19
    s_branch L_oh19
L_xh19:
    s_mov_b32 s85, 0
    s_branch L_oh19
    s_nop 7
L_rh20:
    s_sub_u32 s85, s85, 1
    s_cbranch_scc1 L_xh20
    s_add_u32 m0, s97, 4096
    s_add_u32 s96, s69, s29
    buffer_load_dwordx4 v9, s[44:47], s96 offen sc1 lds
    buffer_load_dwordx4 v9, s[44:47], s96 offen offset:1024 sc1 lds
    s_add_u32 m0, s97, 6144
    s_add_u32 s96, s69, s30
    buffer_load_dwordx4 v9, s[44:47], s96 offen sc1 lds
    buffer_load_dwordx4 v9, s[44:47], s96 offen offset:1024 sc1 lds
    s_waitcnt vmcnt(0)
    ds_read_b64 v[32:33], v14 offset:4096
    ds_read_b64 v[34:35], v14 offset:5120
    ds_read_b64 v[36:37], v14 offset:4104
    ds_read_b64 v[38:39], v14 offset:5128
    s_waitcnt lgkmcnt(0)
    v_max_u32 v11, v32, v34
    v_cmp_eq_u32 vcc, -1, v11
    s_cbranch_vccnz L_rh20
    s_branch L_oh20
L_xh20:
    s_mov_b32 s85, 0
    s_branch L_oh20
    s_nop 7
L_rh21:
    s_sub_u32 s85, s85, 1
    s_cbranch_scc1 L_xh21
    s_add_u32 m0, s97, 6144
    s_add_u32 s96, s69, s30
    buffer_load_dwordx4 v9, s[44:47], s96 offen sc1 lds
    buffer_load_dwordx4 v9, s[44:47], s96 offen offset:1024 sc1 lds
    s_waitcnt vmcnt(0)
    ds_read_b64 v[16:17], v14 offset:6144
    ds_read_b64 v[18:19], v14 offset:7168
    ds_read_b64 v[20:21], v14 offset:6152
    ds_read_b64 v[22:23], v14 offset:7176
    s_waitcnt lgkmcnt(0)
    v_max_u32 v11, v16, v18
    v_cmp_eq_u32 vcc, -1, v11
    s_cbranch_vccnz L_rh21
    s_branch L_oh21
L_xh21:
    s_mov_b32 s85, 0
    s_branch L_oh21
    s_nop 7
L_rr2:
    s_sub_u32 s85, s85, 1
    s_cbranch_scc1 L_xr2
    buffer_load_dwordx2 v[80:81], v12, s[44:47], s67 offen sc1
    s_waitcnt vmcnt(0)
    v_cmp_eq_u32 vcc, -1, v80
    s_cbranch_vccnz L_rr2
    s_branch L_or2
L_xr2:
    s_mov_b32 s85, 0
    s_branch L_or2
L_codeend:
    s_endpgm
.section .rodata,"a"
.p2align 6
.amdhsa_kernel sequential_preLN__ssm_conv_h3__glu_gated_reglu__prompt_kernel
  .amdhsa_next_free_vgpr 256
  .amdhsa_next_free_sgpr 102
  .amdhsa_accum_offset 184
  .amdhsa_group_segment_fixed_size 0
  .amdhsa_kernarg_size 104
  .amdhsa_user_sgpr_count 2
  .amdhsa_user_sgpr_kernarg_segment_ptr 1
  .amdhsa_system_sgpr_workgroup_id_x 1
  .amdhsa_float_denorm_mode_32 3
.end_amdhsa_kernel
```
